```python
import torch

def _softmax(x, axis=-1):
    return torch.softmax(x, dim=axis)
def _gelu(x):
    return torch.nn.functional.gelu(x, approximate="tanh")
def _silu(x):
    return torch.nn.functional.silu(x)
def _sigmoid(x):
    return torch.sigmoid(x)
def _layernorm(x, axis=-1, eps=1e-5):
    m = x.mean(dim=axis, keepdim=True)
    v = x.var(dim=axis, keepdim=True, unbiased=False)
    return (x - m) / torch.sqrt(v + eps)
def _scatter_add(tgt, idx, src, axis=0):
    return tgt.clone().index_add_(axis, idx, src)
def _segment_sum(src, seg, n):
    out = torch.zeros((n,) + src.shape[1:], dtype=src.dtype)
    return out.index_add_(0, seg, src)
def _pad(x, pw):
    flat = tuple(v for pair in reversed(pw) for v in pair)
    return torch.nn.functional.pad(x, flat)

kernel_name = 'concat_heads__compressed_kv_cla__spectral_gfnet__prompt'

def setup_inputs():

    _w = (lambda a: (lambda t: t.to(torch.bfloat16) if t.is_floating_point() else t)(torch.as_tensor(a)))
    def _A_setup():
        B, H, Sq, Sk, D, M = 1, 32, 2048, 2048, 128, 576
        Dc = 4 * D
        return {
            "x": _w((lambda *s: torch.randn(*s, dtype=torch.bfloat16) * 3.2)(B, Sq, M)),
            "c_kv": _w((lambda *s: torch.randn(*s, dtype=torch.bfloat16) * 0.05)(B, Sk, Dc)),
            "w_q": _w((lambda *s: torch.randn(*s, dtype=torch.bfloat16) * 3.2)(M, H, D) * (M ** -0.5)),
            "w_uk": _w((lambda *s: torch.randn(*s, dtype=torch.bfloat16) * 3.2)(Dc, H, D) * (Dc ** -0.5)),
            "w_uv": _w((lambda *s: torch.randn(*s, dtype=torch.bfloat16) * 0.05)(Dc, H, D) * (Dc ** -0.5)),
            "w_o": _w((lambda *s: torch.randn(*s, dtype=torch.bfloat16) * 0.05)(H, D, M) * ((H * D) ** -0.5)),
        }
    _A_in = _A_setup()

    def _B_setup():
        B, S, D = 1, 2048, 576
        Df = D // 2 + 1
        return {
            "x": _w((lambda *s: torch.randn(*s, dtype=torch.bfloat16) * 0.05)(B, S, D)),
            "w_r": _w((lambda *s: torch.randn(*s, dtype=torch.bfloat16) * 0.05)(S, Df) * 0.02),
            "w_i": _w((lambda *s: torch.randn(*s, dtype=torch.bfloat16) * 0.05)(S, Df) * 0.02),
        }
    _B_in = _B_setup()

    return {
        "A_x": _A_in["x"],
        "A_c_kv": _A_in["c_kv"],
        "A_w_q": _A_in["w_q"],
        "A_w_uk": _A_in["w_uk"],
        "A_w_uv": _A_in["w_uv"],
        "A_w_o": _A_in["w_o"],
        "B_x": _B_in["x"],
        "B_w_r": _B_in["w_r"],
        "B_w_i": _B_in["w_i"],
    }

def reference(A_x, A_c_kv, A_w_q, A_w_uk, A_w_uv, A_w_o, B_x, B_w_r, B_w_i):
    def _A_ref(x, c_kv, w_q, w_uk, w_uv, w_o):
        B, Sq, M = x.shape[0], x.shape[1], x.shape[2]
        Sk = c_kv.shape[1]
        H, D = w_q.shape[1], w_q.shape[2]
        q = torch.einsum("bqm,mhd->bhqd", x, w_q)
        k = torch.einsum("bkc,chd->bhkd", c_kv, w_uk)
        v = torch.einsum("bkc,chd->bhkd", c_kv, w_uv)
        scores = torch.einsum("bhqd,bhkd->bhqk", q, k) * (D ** -0.5)
        off = Sk - Sq
        qi = torch.arange(Sq)[:, None]
        kj = torch.arange(Sk)[None, :]
        cmask = kj <= (qi + off)
        scores = torch.where(cmask[None, None], scores, -1e9)
        p = _softmax(scores, axis=-1)
        ctx = torch.einsum("bhqk,bhkd->bhqd", p, v)
        return torch.einsum("bhqd,hdm->bqm", ctx, w_o)

    def _B_ref(x, w_r, w_i):
        B, S, D = x.shape
        X = (lambda x, axes=(-2,-1): torch.fft.rfft2(x.float(), dim=axes))(x, axes=(-2, -1))
        W = w_r + 1j * w_i
        X = X * W
        y = (lambda x, s, axes=(-2,-1): torch.fft.irfft2(x, s=s, dim=axes).to(torch.bfloat16))(X, (S, D), axes=(-2, -1))
        return y

    a = _A_ref(A_x, A_c_kv, A_w_q, A_w_uk, A_w_uv, A_w_o)
    b = _B_ref(B_x, B_w_r, B_w_i)
    return torch.concatenate([a, b], axis=-1)
```

```asm
; @launch kernel=l1_kernel grid=(464,1,1) block=(512,1,1) lds=163840
; @launch kernel=l2_kernel grid=(256,1,1) block=(512,1,1) lds=135168
; @launch kernel=l3_kernel grid=(240,1,1) block=(512,1,1) lds=147456
.amdgcn_target "amdgcn-amd-amdhsa--gfx950"
.text
.globl l1_kernel
.p2align 8
.type l1_kernel,@function
l1_kernel:
    s_cmp_lt_u32 s2, 256
    s_cbranch_scc1 Lm1_main
    s_sub_u32 s2, s2, 256
    s_cmp_lt_u32 s2, 144
    s_cbranch_scc1 Lm1_s1
    s_sub_u32 s2, s2, 144
    s_cmp_lt_u32 s2, 32
    s_cbranch_scc1 Lm1_wt
    s_sub_u32 s2, s2, 32
    s_cmp_ge_u32 s2, 32
    s_cbranch_scc1 Lm1_x
    s_load_dwordx2 s[40:41], s[0:1], 40
    v_lshrrev_b32 v1, 6, v0
    s_nop 0
    v_readfirstlane_b32 s24, v1
    s_waitcnt lgkmcnt(0)
    s_mov_b32 s8, s40
    s_mov_b32 s9, s41
    s_mov_b32 s10, 4718592
    s_mov_b32 s11, 0x00020000
    v_and_b32 v2, 63, v0
    v_lshlrev_b32 v2, 4, v2
    s_mul_i32 s3, s2, 147456
    s_mul_i32 s4, s24, 18432
    s_add_u32 s3, s3, s4
    s_mov_b32 m0, s4
    s_nop 0
    buffer_load_dwordx4 v2, s[8:11], s3 offen lds
    s_add_u32 s3, s3, 1024
    s_add_u32 m0, m0, 1024
    s_nop 0
    buffer_load_dwordx4 v2, s[8:11], s3 offen lds
    s_add_u32 s3, s3, 1024
    s_add_u32 m0, m0, 1024
    s_nop 0
    buffer_load_dwordx4 v2, s[8:11], s3 offen lds
    s_add_u32 s3, s3, 1024
    s_add_u32 m0, m0, 1024
    s_nop 0
    buffer_load_dwordx4 v2, s[8:11], s3 offen lds
    s_add_u32 s3, s3, 1024
    s_add_u32 m0, m0, 1024
    s_nop 0
    buffer_load_dwordx4 v2, s[8:11], s3 offen lds
    s_add_u32 s3, s3, 1024
    s_add_u32 m0, m0, 1024
    s_nop 0
    buffer_load_dwordx4 v2, s[8:11], s3 offen lds
    s_add_u32 s3, s3, 1024
    s_add_u32 m0, m0, 1024
    s_nop 0
    buffer_load_dwordx4 v2, s[8:11], s3 offen lds
    s_add_u32 s3, s3, 1024
    s_add_u32 m0, m0, 1024
    s_nop 0
    buffer_load_dwordx4 v2, s[8:11], s3 offen lds
    s_add_u32 s3, s3, 1024
    s_add_u32 m0, m0, 1024
    s_nop 0
    buffer_load_dwordx4 v2, s[8:11], s3 offen lds
    s_add_u32 s3, s3, 1024
    s_add_u32 m0, m0, 1024
    s_nop 0
    buffer_load_dwordx4 v2, s[8:11], s3 offen lds
    s_add_u32 s3, s3, 1024
    s_add_u32 m0, m0, 1024
    s_nop 0
    buffer_load_dwordx4 v2, s[8:11], s3 offen lds
    s_add_u32 s3, s3, 1024
    s_add_u32 m0, m0, 1024
    s_nop 0
    buffer_load_dwordx4 v2, s[8:11], s3 offen lds
    s_add_u32 s3, s3, 1024
    s_add_u32 m0, m0, 1024
    s_nop 0
    buffer_load_dwordx4 v2, s[8:11], s3 offen lds
    s_add_u32 s3, s3, 1024
    s_add_u32 m0, m0, 1024
    s_nop 0
    buffer_load_dwordx4 v2, s[8:11], s3 offen lds
    s_add_u32 s3, s3, 1024
    s_add_u32 m0, m0, 1024
    s_nop 0
    buffer_load_dwordx4 v2, s[8:11], s3 offen lds
    s_add_u32 s3, s3, 1024
    s_add_u32 m0, m0, 1024
    s_nop 0
    buffer_load_dwordx4 v2, s[8:11], s3 offen lds
    s_add_u32 s3, s3, 1024
    s_add_u32 m0, m0, 1024
    s_nop 0
    buffer_load_dwordx4 v2, s[8:11], s3 offen lds
    s_add_u32 s3, s3, 1024
    s_add_u32 m0, m0, 1024
    s_nop 0
    buffer_load_dwordx4 v2, s[8:11], s3 offen lds
    s_add_u32 s3, s3, 1024
    s_add_u32 m0, m0, 1024
    s_waitcnt vmcnt(0)
    s_endpgm
Lm1_wt:
    s_load_dwordx4 s[56:59], s[0:1], 56
    s_load_dwordx2 s[46:47], s[0:1], 88
    v_lshrrev_b32 v1, 6, v0
    s_nop 0
    v_readfirstlane_b32 s24, v1
    s_waitcnt lgkmcnt(0)
    s_mov_b32 s60, s56
    s_mov_b32 s61, s57
    s_mov_b32 s62, 1183744
    s_mov_b32 s63, 0x00020000
    s_mov_b32 s64, s58
    s_mov_b32 s65, s59
    s_mov_b32 s66, 1183744
    s_mov_b32 s67, 0x00020000
    s_add_u32 s68, s46, 75497472
    s_addc_u32 s69, s47, 0
    s_mov_b32 s70, 2367488
    s_mov_b32 s71, 0x00020000
    v_and_b32 v8, 63, v0
    v_lshlrev_b32 v9, 4, v8
    s_mul_i32 s5, s2, 36992
    s_lshl_b32 s3, s24, 10
    s_add_u32 s3, s3, 0
    s_add_u32 s4, s3, s5
    s_mov_b32 m0, s3
    s_nop 0
    buffer_load_dwordx4 v9, s[60:63], s4 offen lds
    s_add_u32 m0, s3, 40960
    s_nop 0
    buffer_load_dwordx4 v9, s[64:67], s4 offen lds
    s_lshl_b32 s3, s24, 10
    s_add_u32 s3, s3, 8192
    s_add_u32 s4, s3, s5
    s_mov_b32 m0, s3
    s_nop 0
    buffer_load_dwordx4 v9, s[60:63], s4 offen lds
    s_add_u32 m0, s3, 40960
    s_nop 0
    buffer_load_dwordx4 v9, s[64:67], s4 offen lds
    s_lshl_b32 s3, s24, 10
    s_add_u32 s3, s3, 16384
    s_add_u32 s4, s3, s5
    s_mov_b32 m0, s3
    s_nop 0
    buffer_load_dwordx4 v9, s[60:63], s4 offen lds
    s_add_u32 m0, s3, 40960
    s_nop 0
    buffer_load_dwordx4 v9, s[64:67], s4 offen lds
    s_lshl_b32 s3, s24, 10
    s_add_u32 s3, s3, 24576
    s_add_u32 s4, s3, s5
    s_mov_b32 m0, s3
    s_nop 0
    buffer_load_dwordx4 v9, s[60:63], s4 offen lds
    s_add_u32 m0, s3, 40960
    s_nop 0
    buffer_load_dwordx4 v9, s[64:67], s4 offen lds
    s_cmp_ge_u32 s24, 5
    s_cbranch_scc1 Lwt_l
    s_lshl_b32 s3, s24, 10
    s_add_u32 s3, s3, 32768
    s_add_u32 s4, s3, s5
    s_mov_b32 m0, s3
    s_nop 0
    buffer_load_dwordx4 v9, s[60:63], s4 offen lds
    s_add_u32 m0, s3, 40960
    s_nop 0
    buffer_load_dwordx4 v9, s[64:67], s4 offen lds
Lwt_l:
    v_mul_u32_u24 v10, 578, v8
    s_lshl_b32 s3, s24, 1
    v_add_u32 v10, s3, v10
    v_lshlrev_b32 v11, 2, v8
    s_lshl_b32 s6, s2, 8
    s_lshl_b32 s3, s24, 13
    s_add_u32 s6, s6, s3
    s_waitcnt vmcnt(0)
    s_barrier
    ds_read_u16 v16, v10 offset:0
    ds_read_u16 v17, v10 offset:40960
    ds_read_u16 v18, v10 offset:16
    ds_read_u16 v19, v10 offset:40976
    ds_read_u16 v20, v10 offset:32
    ds_read_u16 v21, v10 offset:40992
    ds_read_u16 v22, v10 offset:48
    ds_read_u16 v23, v10 offset:41008
    ds_read_u16 v24, v10 offset:64
    ds_read_u16 v25, v10 offset:41024
    ds_read_u16 v26, v10 offset:80
    ds_read_u16 v27, v10 offset:41040
    ds_read_u16 v28, v10 offset:96
    ds_read_u16 v29, v10 offset:41056
    s_waitcnt lgkmcnt(0)
    ds_read_u16 v30, v10 offset:112
    ds_read_u16 v31, v10 offset:41072
    ds_read_u16 v32, v10 offset:128
    ds_read_u16 v33, v10 offset:41088
    ds_read_u16 v34, v10 offset:144
    ds_read_u16 v35, v10 offset:41104
    ds_read_u16 v36, v10 offset:160
    ds_read_u16 v37, v10 offset:41120
    ds_read_u16 v38, v10 offset:176
    ds_read_u16 v39, v10 offset:41136
    ds_read_u16 v40, v10 offset:192
    ds_read_u16 v41, v10 offset:41152
    ds_read_u16 v42, v10 offset:208
    ds_read_u16 v43, v10 offset:41168
    s_waitcnt lgkmcnt(0)
    ds_read_u16 v44, v10 offset:224
    ds_read_u16 v45, v10 offset:41184
    ds_read_u16 v46, v10 offset:240
    ds_read_u16 v47, v10 offset:41200
    ds_read_u16 v48, v10 offset:256
    ds_read_u16 v49, v10 offset:41216
    ds_read_u16 v50, v10 offset:272
    ds_read_u16 v51, v10 offset:41232
    ds_read_u16 v52, v10 offset:288
    ds_read_u16 v53, v10 offset:41248
    ds_read_u16 v54, v10 offset:304
    ds_read_u16 v55, v10 offset:41264
    ds_read_u16 v56, v10 offset:320
    ds_read_u16 v57, v10 offset:41280
    s_waitcnt lgkmcnt(0)
    ds_read_u16 v58, v10 offset:336
    ds_read_u16 v59, v10 offset:41296
    ds_read_u16 v60, v10 offset:352
    ds_read_u16 v61, v10 offset:41312
    ds_read_u16 v62, v10 offset:368
    ds_read_u16 v63, v10 offset:41328
    ds_read_u16 v64, v10 offset:384
    ds_read_u16 v65, v10 offset:41344
    ds_read_u16 v66, v10 offset:400
    ds_read_u16 v67, v10 offset:41360
    ds_read_u16 v68, v10 offset:416
    ds_read_u16 v69, v10 offset:41376
    ds_read_u16 v70, v10 offset:432
    ds_read_u16 v71, v10 offset:41392
    s_waitcnt lgkmcnt(0)
    ds_read_u16 v72, v10 offset:448
    ds_read_u16 v73, v10 offset:41408
    ds_read_u16 v74, v10 offset:464
    ds_read_u16 v75, v10 offset:41424
    ds_read_u16 v76, v10 offset:480
    ds_read_u16 v77, v10 offset:41440
    ds_read_u16 v78, v10 offset:496
    ds_read_u16 v79, v10 offset:41456
    ds_read_u16 v80, v10 offset:512
    ds_read_u16 v81, v10 offset:41472
    ds_read_u16 v82, v10 offset:528
    ds_read_u16 v83, v10 offset:41488
    ds_read_u16 v84, v10 offset:544
    ds_read_u16 v85, v10 offset:41504
    s_waitcnt lgkmcnt(0)
    ds_read_u16 v86, v10 offset:560
    ds_read_u16 v87, v10 offset:41520
    ds_read_u16 v88, v10 offset:576
    ds_read_u16 v89, v10 offset:41536
    s_waitcnt lgkmcnt(0)
    v_lshl_or_b32 v16, v17, 16, v16
    buffer_store_dword v16, v11, s[68:71], s6 offen
    s_add_u32 s6, s6, 65536
    v_lshl_or_b32 v18, v19, 16, v18
    buffer_store_dword v18, v11, s[68:71], s6 offen
    s_add_u32 s6, s6, 65536
    v_lshl_or_b32 v20, v21, 16, v20
    buffer_store_dword v20, v11, s[68:71], s6 offen
    s_add_u32 s6, s6, 65536
    v_lshl_or_b32 v22, v23, 16, v22
    buffer_store_dword v22, v11, s[68:71], s6 offen
    s_add_u32 s6, s6, 65536
    v_lshl_or_b32 v24, v25, 16, v24
    buffer_store_dword v24, v11, s[68:71], s6 offen
    s_add_u32 s6, s6, 65536
    v_lshl_or_b32 v26, v27, 16, v26
    buffer_store_dword v26, v11, s[68:71], s6 offen
    s_add_u32 s6, s6, 65536
    v_lshl_or_b32 v28, v29, 16, v28
    buffer_store_dword v28, v11, s[68:71], s6 offen
    s_add_u32 s6, s6, 65536
    v_lshl_or_b32 v30, v31, 16, v30
    buffer_store_dword v30, v11, s[68:71], s6 offen
    s_add_u32 s6, s6, 65536
    v_lshl_or_b32 v32, v33, 16, v32
    buffer_store_dword v32, v11, s[68:71], s6 offen
    s_add_u32 s6, s6, 65536
    v_lshl_or_b32 v34, v35, 16, v34
    buffer_store_dword v34, v11, s[68:71], s6 offen
    s_add_u32 s6, s6, 65536
    v_lshl_or_b32 v36, v37, 16, v36
    buffer_store_dword v36, v11, s[68:71], s6 offen
    s_add_u32 s6, s6, 65536
    v_lshl_or_b32 v38, v39, 16, v38
    buffer_store_dword v38, v11, s[68:71], s6 offen
    s_add_u32 s6, s6, 65536
    v_lshl_or_b32 v40, v41, 16, v40
    buffer_store_dword v40, v11, s[68:71], s6 offen
    s_add_u32 s6, s6, 65536
    v_lshl_or_b32 v42, v43, 16, v42
    buffer_store_dword v42, v11, s[68:71], s6 offen
    s_add_u32 s6, s6, 65536
    v_lshl_or_b32 v44, v45, 16, v44
    buffer_store_dword v44, v11, s[68:71], s6 offen
    s_add_u32 s6, s6, 65536
    v_lshl_or_b32 v46, v47, 16, v46
    buffer_store_dword v46, v11, s[68:71], s6 offen
    s_add_u32 s6, s6, 65536
    v_lshl_or_b32 v48, v49, 16, v48
    buffer_store_dword v48, v11, s[68:71], s6 offen
    s_add_u32 s6, s6, 65536
    v_lshl_or_b32 v50, v51, 16, v50
    buffer_store_dword v50, v11, s[68:71], s6 offen
    s_add_u32 s6, s6, 65536
    v_lshl_or_b32 v52, v53, 16, v52
    buffer_store_dword v52, v11, s[68:71], s6 offen
    s_add_u32 s6, s6, 65536
    v_lshl_or_b32 v54, v55, 16, v54
    buffer_store_dword v54, v11, s[68:71], s6 offen
    s_add_u32 s6, s6, 65536
    v_lshl_or_b32 v56, v57, 16, v56
    buffer_store_dword v56, v11, s[68:71], s6 offen
    s_add_u32 s6, s6, 65536
    v_lshl_or_b32 v58, v59, 16, v58
    buffer_store_dword v58, v11, s[68:71], s6 offen
    s_add_u32 s6, s6, 65536
    v_lshl_or_b32 v60, v61, 16, v60
    buffer_store_dword v60, v11, s[68:71], s6 offen
    s_add_u32 s6, s6, 65536
    v_lshl_or_b32 v62, v63, 16, v62
    buffer_store_dword v62, v11, s[68:71], s6 offen
    s_add_u32 s6, s6, 65536
    v_lshl_or_b32 v64, v65, 16, v64
    buffer_store_dword v64, v11, s[68:71], s6 offen
    s_add_u32 s6, s6, 65536
    v_lshl_or_b32 v66, v67, 16, v66
    buffer_store_dword v66, v11, s[68:71], s6 offen
    s_add_u32 s6, s6, 65536
    v_lshl_or_b32 v68, v69, 16, v68
    buffer_store_dword v68, v11, s[68:71], s6 offen
    s_add_u32 s6, s6, 65536
    v_lshl_or_b32 v70, v71, 16, v70
    buffer_store_dword v70, v11, s[68:71], s6 offen
    s_add_u32 s6, s6, 65536
    v_lshl_or_b32 v72, v73, 16, v72
    buffer_store_dword v72, v11, s[68:71], s6 offen
    s_add_u32 s6, s6, 65536
    v_lshl_or_b32 v74, v75, 16, v74
    buffer_store_dword v74, v11, s[68:71], s6 offen
    s_add_u32 s6, s6, 65536
    v_lshl_or_b32 v76, v77, 16, v76
    buffer_store_dword v76, v11, s[68:71], s6 offen
    s_add_u32 s6, s6, 65536
    v_lshl_or_b32 v78, v79, 16, v78
    buffer_store_dword v78, v11, s[68:71], s6 offen
    s_add_u32 s6, s6, 65536
    v_lshl_or_b32 v80, v81, 16, v80
    buffer_store_dword v80, v11, s[68:71], s6 offen
    s_add_u32 s6, s6, 65536
    v_lshl_or_b32 v82, v83, 16, v82
    buffer_store_dword v82, v11, s[68:71], s6 offen
    s_add_u32 s6, s6, 65536
    v_lshl_or_b32 v84, v85, 16, v84
    buffer_store_dword v84, v11, s[68:71], s6 offen
    s_add_u32 s6, s6, 65536
    v_lshl_or_b32 v86, v87, 16, v86
    buffer_store_dword v86, v11, s[68:71], s6 offen
    s_add_u32 s6, s6, 65536
    s_cmp_ge_u32 s24, 1
    s_cbranch_scc1 Lwt_x
    v_lshl_or_b32 v88, v89, 16, v88
    buffer_store_dword v88, v11, s[68:71], s6 offen
    s_add_u32 s6, s6, 65536
Lwt_x:
    s_endpgm
Lm1_x:
    s_endpgm
Lm1_s1:
    s_load_dwordx2 s[40:41], s[0:1], 48
    s_load_dwordx2 s[46:47], s[0:1], 88
    v_lshrrev_b32 v1, 6, v0
    s_nop 0
    v_readfirstlane_b32 s24, v1
    s_waitcnt lgkmcnt(0)
    s_and_b32 s25, s2, 7
    s_lshr_b32 s26, s2, 3
    s_mov_b32 s8, s40
    s_mov_b32 s9, s41
    s_mov_b32 s10, 2359296
    s_mov_b32 s11, 0x00020000
    s_add_u32 s12, s46, 67108864
    s_addc_u32 s13, s47, 0
    s_mov_b32 s14, 2359296
    s_mov_b32 s15, 0x00020000
    v_and_b32 v48, 63, v0
    v_and_b32 v49, 31, v0
    v_bfe_u32 v50, v0, 5, 1
    v_lshrrev_b32 v53, 3, v48
    v_and_b32 v54, 7, v48
    s_lshl_b32 s3, s25, 3
    s_add_u32 s27, s3, s24
    s_movk_i32 s4, 1152
    v_add_u32 v55, 0, v53
    v_bfe_u32 v56, v55, 1, 3
    v_xor_b32 v56, v56, v54
    v_lshlrev_b32 v55, 6, v55
    v_add_u32 v55, s27, v55
    v_mul_lo_u32 v55, v55, s4
    v_lshl_add_u32 v36, v56, 4, v55
    v_add_u32 v55, 8, v53
    v_bfe_u32 v56, v55, 1, 3
    v_xor_b32 v56, v56, v54
    v_lshlrev_b32 v55, 6, v55
    v_add_u32 v55, s27, v55
    v_mul_lo_u32 v55, v55, s4
    v_lshl_add_u32 v37, v56, 4, v55
    v_add_u32 v55, 16, v53
    v_bfe_u32 v56, v55, 1, 3
    v_xor_b32 v56, v56, v54
    v_lshlrev_b32 v55, 6, v55
    v_add_u32 v55, s27, v55
    v_mul_lo_u32 v55, v55, s4
    v_lshl_add_u32 v38, v56, 4, v55
    v_add_u32 v55, 24, v53
    v_bfe_u32 v56, v55, 1, 3
    v_xor_b32 v56, v56, v54
    v_lshlrev_b32 v55, 6, v55
    v_add_u32 v55, s27, v55
    v_mul_lo_u32 v55, v55, s4
    v_lshl_add_u32 v39, v56, 4, v55
    s_mul_i32 s28, s24, 12288
    s_mov_b32 s30, 0
    s_add_u32 m0, s28, 0
    s_nop 0
    buffer_load_dwordx4 v36, s[8:11], s30 offen lds
    s_add_u32 m0, s28, 1024
    s_nop 0
    buffer_load_dwordx4 v37, s[8:11], s30 offen lds
    s_add_u32 m0, s28, 2048
    s_nop 0
    buffer_load_dwordx4 v38, s[8:11], s30 offen lds
    s_add_u32 m0, s28, 3072
    s_nop 0
    buffer_load_dwordx4 v39, s[8:11], s30 offen lds
    s_mov_b32 s30, 128
    s_add_u32 m0, s28, 4096
    s_nop 0
    buffer_load_dwordx4 v36, s[8:11], s30 offen lds
    s_add_u32 m0, s28, 5120
    s_nop 0
    buffer_load_dwordx4 v37, s[8:11], s30 offen lds
    s_add_u32 m0, s28, 6144
    s_nop 0
    buffer_load_dwordx4 v38, s[8:11], s30 offen lds
    s_add_u32 m0, s28, 7168
    s_nop 0
    buffer_load_dwordx4 v39, s[8:11], s30 offen lds
    s_mov_b32 s30, 256
    s_add_u32 m0, s28, 8192
    s_nop 0
    buffer_load_dwordx4 v36, s[8:11], s30 offen lds
    s_add_u32 m0, s28, 9216
    s_nop 0
    buffer_load_dwordx4 v37, s[8:11], s30 offen lds
    s_add_u32 m0, s28, 10240
    s_nop 0
    buffer_load_dwordx4 v38, s[8:11], s30 offen lds
    s_add_u32 m0, s28, 11264
    s_nop 0
    buffer_load_dwordx4 v39, s[8:11], s30 offen lds
    v_lshlrev_b32 v51, 7, v49
    v_add_u32 v51, s28, v51
    v_bfe_u32 v52, v0, 1, 3
    v_or_b32 v53, 0, v50
    v_xor_b32 v53, v53, v52
    v_lshl_add_u32 v32, v53, 4, v51
    v_or_b32 v53, 2, v50
    v_xor_b32 v53, v53, v52
    v_lshl_add_u32 v33, v53, 4, v51
    v_or_b32 v53, 4, v50
    v_xor_b32 v53, v53, v52
    v_lshl_add_u32 v34, v53, 4, v51
    v_or_b32 v53, 6, v50
    v_xor_b32 v53, v53, v52
    v_lshl_add_u32 v35, v53, 4, v51
    s_mov_b32 s36, 987991609
    s_movk_i32 s37, 576
    s_mov_b32 s38, 7456541
    v_lshlrev_b32 v68, 4, v48
    s_lshl_b32 s3, s26, 5
    v_add_u32 v51, s3, v49
    v_cmp_lt_u32 vcc, 288, v51
    v_subrev_u32 v52, 288, v51
    s_nop 0
    v_cndmask_b32 v57, v51, v52, vcc
    v_mov_b32 v53, 0
    v_mov_b32 v54, 0x3e800000
    v_cndmask_b32 v58, v53, v54, vcc
    s_lshl_b32 s6, s24, 4
    v_lshl_add_u32 v59, v50, 3, 0
    v_add_u32 v59, s6, v59
    v_mul_u32_u24 v59, v59, v57
    v_mul_hi_u32 v60, v59, s38
    v_mul_lo_u32 v60, v60, s37
    v_sub_u32 v59, v59, v60
    v_cvt_f32_u32 v59, v59
    v_fma_f32 v59, v59, s36, v58
    v_cos_f32 v72, v59
    v_sin_f32 v80, v59
    v_lshl_add_u32 v59, v50, 3, 1
    v_add_u32 v59, s6, v59
    v_mul_u32_u24 v59, v59, v57
    v_mul_hi_u32 v60, v59, s38
    v_mul_lo_u32 v60, v60, s37
    v_sub_u32 v59, v59, v60
    v_cvt_f32_u32 v59, v59
    v_fma_f32 v59, v59, s36, v58
    v_cos_f32 v73, v59
    v_sin_f32 v81, v59
    v_lshl_add_u32 v59, v50, 3, 2
    v_add_u32 v59, s6, v59
    v_mul_u32_u24 v59, v59, v57
    v_mul_hi_u32 v60, v59, s38
    v_mul_lo_u32 v60, v60, s37
    v_sub_u32 v59, v59, v60
    v_cvt_f32_u32 v59, v59
    v_fma_f32 v59, v59, s36, v58
    v_cos_f32 v74, v59
    v_sin_f32 v82, v59
    v_lshl_add_u32 v59, v50, 3, 3
    v_add_u32 v59, s6, v59
    v_mul_u32_u24 v59, v59, v57
    v_mul_hi_u32 v60, v59, s38
    v_mul_lo_u32 v60, v60, s37
    v_sub_u32 v59, v59, v60
    v_cvt_f32_u32 v59, v59
    v_fma_f32 v59, v59, s36, v58
    v_cos_f32 v75, v59
    v_sin_f32 v83, v59
    v_lshl_add_u32 v59, v50, 3, 4
    v_add_u32 v59, s6, v59
    v_mul_u32_u24 v59, v59, v57
    v_mul_hi_u32 v60, v59, s38
    v_mul_lo_u32 v60, v60, s37
    v_sub_u32 v59, v59, v60
    v_cvt_f32_u32 v59, v59
    v_fma_f32 v59, v59, s36, v58
    v_cos_f32 v76, v59
    v_sin_f32 v84, v59
    v_lshl_add_u32 v59, v50, 3, 5
    v_add_u32 v59, s6, v59
    v_mul_u32_u24 v59, v59, v57
    v_mul_hi_u32 v60, v59, s38
    v_mul_lo_u32 v60, v60, s37
    v_sub_u32 v59, v59, v60
    v_cvt_f32_u32 v59, v59
    v_fma_f32 v59, v59, s36, v58
    v_cos_f32 v77, v59
    v_sin_f32 v85, v59
    v_lshl_add_u32 v59, v50, 3, 6
    v_add_u32 v59, s6, v59
    v_mul_u32_u24 v59, v59, v57
    v_mul_hi_u32 v60, v59, s38
    v_mul_lo_u32 v60, v60, s37
    v_sub_u32 v59, v59, v60
    v_cvt_f32_u32 v59, v59
    v_fma_f32 v59, v59, s36, v58
    v_cos_f32 v78, v59
    v_sin_f32 v86, v59
    v_lshl_add_u32 v59, v50, 3, 7
    v_add_u32 v59, s6, v59
    v_mul_u32_u24 v59, v59, v57
    v_mul_hi_u32 v60, v59, s38
    v_mul_lo_u32 v60, v60, s37
    v_sub_u32 v59, v59, v60
    v_cvt_f32_u32 v59, v59
    v_fma_f32 v59, v59, s36, v58
    v_cos_f32 v79, v59
    v_sin_f32 v87, v59
    v_lshlrev_b32 v59, 7, v57
    v_mul_hi_u32 v60, v59, s38
    v_mul_lo_u32 v60, v60, s37
    v_sub_u32 v59, v59, v60
    v_cvt_f32_u32 v59, v59
    v_mul_f32 v59, s36, v59
    v_cos_f32 v69, v59
    v_sin_f32 v70, v59
    v_cvt_pk_bf16_f32 v88, v72, v73
    v_cvt_pk_bf16_f32 v89, v74, v75
    v_cvt_pk_bf16_f32 v90, v76, v77
    v_cvt_pk_bf16_f32 v91, v78, v79
    s_lshl_b32 s3, s24, 10
    s_add_u32 s3, s3, 98304
    v_add_u32 v59, s3, v68
    ds_write_b128 v59, v[88:91]
    v_mul_f32 v60, v72, v69
    v_mul_f32 v61, v80, v69
    v_fma_f32 v60, -v80, v70, v60
    v_fma_f32 v80, v72, v70, v61
    v_mov_b32 v72, v60
    v_mul_f32 v60, v73, v69
    v_mul_f32 v61, v81, v69
    v_fma_f32 v60, -v81, v70, v60
    v_fma_f32 v81, v73, v70, v61
    v_mov_b32 v73, v60
    v_mul_f32 v60, v74, v69
    v_mul_f32 v61, v82, v69
    v_fma_f32 v60, -v82, v70, v60
    v_fma_f32 v82, v74, v70, v61
    v_mov_b32 v74, v60
    v_mul_f32 v60, v75, v69
    v_mul_f32 v61, v83, v69
    v_fma_f32 v60, -v83, v70, v60
    v_fma_f32 v83, v75, v70, v61
    v_mov_b32 v75, v60
    v_mul_f32 v60, v76, v69
    v_mul_f32 v61, v84, v69
    v_fma_f32 v60, -v84, v70, v60
    v_fma_f32 v84, v76, v70, v61
    v_mov_b32 v76, v60
    v_mul_f32 v60, v77, v69
    v_mul_f32 v61, v85, v69
    v_fma_f32 v60, -v85, v70, v60
    v_fma_f32 v85, v77, v70, v61
    v_mov_b32 v77, v60
    v_mul_f32 v60, v78, v69
    v_mul_f32 v61, v86, v69
    v_fma_f32 v60, -v86, v70, v60
    v_fma_f32 v86, v78, v70, v61
    v_mov_b32 v78, v60
    v_mul_f32 v60, v79, v69
    v_mul_f32 v61, v87, v69
    v_fma_f32 v60, -v87, v70, v60
    v_fma_f32 v87, v79, v70, v61
    v_mov_b32 v79, v60
    v_cvt_pk_bf16_f32 v88, v72, v73
    v_cvt_pk_bf16_f32 v89, v74, v75
    v_cvt_pk_bf16_f32 v90, v76, v77
    v_cvt_pk_bf16_f32 v91, v78, v79
    s_lshl_b32 s3, s24, 10
    s_add_u32 s3, s3, 106496
    v_add_u32 v59, s3, v68
    ds_write_b128 v59, v[88:91]
    v_mul_f32 v60, v72, v69
    v_mul_f32 v61, v80, v69
    v_fma_f32 v60, -v80, v70, v60
    v_fma_f32 v80, v72, v70, v61
    v_mov_b32 v72, v60
    v_mul_f32 v60, v73, v69
    v_mul_f32 v61, v81, v69
    v_fma_f32 v60, -v81, v70, v60
    v_fma_f32 v81, v73, v70, v61
    v_mov_b32 v73, v60
    v_mul_f32 v60, v74, v69
    v_mul_f32 v61, v82, v69
    v_fma_f32 v60, -v82, v70, v60
    v_fma_f32 v82, v74, v70, v61
    v_mov_b32 v74, v60
    v_mul_f32 v60, v75, v69
    v_mul_f32 v61, v83, v69
    v_fma_f32 v60, -v83, v70, v60
    v_fma_f32 v83, v75, v70, v61
    v_mov_b32 v75, v60
    v_mul_f32 v60, v76, v69
    v_mul_f32 v61, v84, v69
    v_fma_f32 v60, -v84, v70, v60
    v_fma_f32 v84, v76, v70, v61
    v_mov_b32 v76, v60
    v_mul_f32 v60, v77, v69
    v_mul_f32 v61, v85, v69
    v_fma_f32 v60, -v85, v70, v60
    v_fma_f32 v85, v77, v70, v61
    v_mov_b32 v77, v60
    v_mul_f32 v60, v78, v69
    v_mul_f32 v61, v86, v69
    v_fma_f32 v60, -v86, v70, v60
    v_fma_f32 v86, v78, v70, v61
    v_mov_b32 v78, v60
    v_mul_f32 v60, v79, v69
    v_mul_f32 v61, v87, v69
    v_fma_f32 v60, -v87, v70, v60
    v_fma_f32 v87, v79, v70, v61
    v_mov_b32 v79, v60
    v_cvt_pk_bf16_f32 v88, v72, v73
    v_cvt_pk_bf16_f32 v89, v74, v75
    v_cvt_pk_bf16_f32 v90, v76, v77
    v_cvt_pk_bf16_f32 v91, v78, v79
    s_lshl_b32 s3, s24, 10
    s_add_u32 s3, s3, 114688
    v_add_u32 v59, s3, v68
    ds_write_b128 v59, v[88:91]
    v_mul_f32 v60, v72, v69
    v_mul_f32 v61, v80, v69
    v_fma_f32 v60, -v80, v70, v60
    v_fma_f32 v80, v72, v70, v61
    v_mov_b32 v72, v60
    v_mul_f32 v60, v73, v69
    v_mul_f32 v61, v81, v69
    v_fma_f32 v60, -v81, v70, v60
    v_fma_f32 v81, v73, v70, v61
    v_mov_b32 v73, v60
    v_mul_f32 v60, v74, v69
    v_mul_f32 v61, v82, v69
    v_fma_f32 v60, -v82, v70, v60
    v_fma_f32 v82, v74, v70, v61
    v_mov_b32 v74, v60
    v_mul_f32 v60, v75, v69
    v_mul_f32 v61, v83, v69
    v_fma_f32 v60, -v83, v70, v60
    v_fma_f32 v83, v75, v70, v61
    v_mov_b32 v75, v60
    v_mul_f32 v60, v76, v69
    v_mul_f32 v61, v84, v69
    v_fma_f32 v60, -v84, v70, v60
    v_fma_f32 v84, v76, v70, v61
    v_mov_b32 v76, v60
    v_mul_f32 v60, v77, v69
    v_mul_f32 v61, v85, v69
    v_fma_f32 v60, -v85, v70, v60
    v_fma_f32 v85, v77, v70, v61
    v_mov_b32 v77, v60
    v_mul_f32 v60, v78, v69
    v_mul_f32 v61, v86, v69
    v_fma_f32 v60, -v86, v70, v60
    v_fma_f32 v86, v78, v70, v61
    v_mov_b32 v78, v60
    v_mul_f32 v60, v79, v69
    v_mul_f32 v61, v87, v69
    v_fma_f32 v60, -v87, v70, v60
    v_fma_f32 v87, v79, v70, v61
    v_mov_b32 v79, v60
    v_cvt_pk_bf16_f32 v88, v72, v73
    v_cvt_pk_bf16_f32 v89, v74, v75
    v_cvt_pk_bf16_f32 v90, v76, v77
    v_cvt_pk_bf16_f32 v91, v78, v79
    s_lshl_b32 s3, s24, 10
    s_add_u32 s3, s3, 122880
    v_add_u32 v59, s3, v68
    ds_write_b128 v59, v[88:91]
    v_mul_f32 v60, v72, v69
    v_mul_f32 v61, v80, v69
    v_fma_f32 v60, -v80, v70, v60
    v_fma_f32 v80, v72, v70, v61
    v_mov_b32 v72, v60
    v_mul_f32 v60, v73, v69
    v_mul_f32 v61, v81, v69
    v_fma_f32 v60, -v81, v70, v60
    v_fma_f32 v81, v73, v70, v61
    v_mov_b32 v73, v60
    v_mul_f32 v60, v74, v69
    v_mul_f32 v61, v82, v69
    v_fma_f32 v60, -v82, v70, v60
    v_fma_f32 v82, v74, v70, v61
    v_mov_b32 v74, v60
    v_mul_f32 v60, v75, v69
    v_mul_f32 v61, v83, v69
    v_fma_f32 v60, -v83, v70, v60
    v_fma_f32 v83, v75, v70, v61
    v_mov_b32 v75, v60
    v_mul_f32 v60, v76, v69
    v_mul_f32 v61, v84, v69
    v_fma_f32 v60, -v84, v70, v60
    v_fma_f32 v84, v76, v70, v61
    v_mov_b32 v76, v60
    v_mul_f32 v60, v77, v69
    v_mul_f32 v61, v85, v69
    v_fma_f32 v60, -v85, v70, v60
    v_fma_f32 v85, v77, v70, v61
    v_mov_b32 v77, v60
    v_mul_f32 v60, v78, v69
    v_mul_f32 v61, v86, v69
    v_fma_f32 v60, -v86, v70, v60
    v_fma_f32 v86, v78, v70, v61
    v_mov_b32 v78, v60
    v_mul_f32 v60, v79, v69
    v_mul_f32 v61, v87, v69
    v_fma_f32 v60, -v87, v70, v60
    v_fma_f32 v87, v79, v70, v61
    v_mov_b32 v79, v60
    s_cmp_ge_u32 s24, 4
    s_cbranch_scc1 Ls1v_gd
    v_cvt_pk_bf16_f32 v88, v72, v73
    v_cvt_pk_bf16_f32 v89, v74, v75
    v_cvt_pk_bf16_f32 v90, v76, v77
    v_cvt_pk_bf16_f32 v91, v78, v79
    s_lshl_b32 s3, s24, 10
    s_add_u32 s3, s3, 131072
    v_add_u32 v59, s3, v68
    ds_write_b128 v59, v[88:91]
Ls1v_gd:
    v_add_u32 v69, 98304, v68
    s_waitcnt lgkmcnt(0)
    s_barrier
    s_waitcnt vmcnt(8)
    ds_read_b128 v[16:19], v32 offset:0
    ds_read_b128 v[24:27], v69 offset:0
    ds_read_b128 v[20:23], v33 offset:0
    ds_read_b128 v[28:31], v69 offset:1024
    s_waitcnt lgkmcnt(2)
    v_mfma_f32_32x32x16_bf16 v[0:15], v[16:19], v[24:27], 0
    ds_read_b128 v[16:19], v34 offset:0
    ds_read_b128 v[24:27], v69 offset:2048
    s_waitcnt lgkmcnt(2)
    v_mfma_f32_32x32x16_bf16 v[0:15], v[20:23], v[28:31], v[0:15]
    ds_read_b128 v[20:23], v35 offset:0
    ds_read_b128 v[28:31], v69 offset:3072
    s_waitcnt lgkmcnt(2)
    v_mfma_f32_32x32x16_bf16 v[0:15], v[16:19], v[24:27], v[0:15]
    s_waitcnt lgkmcnt(0)
    v_mfma_f32_32x32x16_bf16 v[0:15], v[20:23], v[28:31], v[0:15]
    s_mov_b32 s30, 384
    s_add_u32 m0, s28, 0
    s_nop 0
    buffer_load_dwordx4 v36, s[8:11], s30 offen lds
    s_add_u32 m0, s28, 1024
    s_nop 0
    buffer_load_dwordx4 v37, s[8:11], s30 offen lds
    s_add_u32 m0, s28, 2048
    s_nop 0
    buffer_load_dwordx4 v38, s[8:11], s30 offen lds
    s_add_u32 m0, s28, 3072
    s_nop 0
    buffer_load_dwordx4 v39, s[8:11], s30 offen lds
    s_waitcnt vmcnt(8)
    ds_read_b128 v[16:19], v32 offset:4096
    ds_read_b128 v[24:27], v69 offset:4096
    ds_read_b128 v[20:23], v33 offset:4096
    ds_read_b128 v[28:31], v69 offset:5120
    s_waitcnt lgkmcnt(2)
    v_mfma_f32_32x32x16_bf16 v[0:15], v[16:19], v[24:27], v[0:15]
    ds_read_b128 v[16:19], v34 offset:4096
    ds_read_b128 v[24:27], v69 offset:6144
    s_waitcnt lgkmcnt(2)
    v_mfma_f32_32x32x16_bf16 v[0:15], v[20:23], v[28:31], v[0:15]
    ds_read_b128 v[20:23], v35 offset:4096
    ds_read_b128 v[28:31], v69 offset:7168
    s_waitcnt lgkmcnt(2)
    v_mfma_f32_32x32x16_bf16 v[0:15], v[16:19], v[24:27], v[0:15]
    s_waitcnt lgkmcnt(0)
    v_mfma_f32_32x32x16_bf16 v[0:15], v[20:23], v[28:31], v[0:15]
    s_mov_b32 s30, 512
    s_add_u32 m0, s28, 4096
    s_nop 0
    buffer_load_dwordx4 v36, s[8:11], s30 offen lds
    s_add_u32 m0, s28, 5120
    s_nop 0
    buffer_load_dwordx4 v37, s[8:11], s30 offen lds
    s_add_u32 m0, s28, 6144
    s_nop 0
    buffer_load_dwordx4 v38, s[8:11], s30 offen lds
    s_add_u32 m0, s28, 7168
    s_nop 0
    buffer_load_dwordx4 v39, s[8:11], s30 offen lds
    s_waitcnt vmcnt(8)
    ds_read_b128 v[16:19], v32 offset:8192
    ds_read_b128 v[24:27], v69 offset:8192
    ds_read_b128 v[20:23], v33 offset:8192
    ds_read_b128 v[28:31], v69 offset:9216
    s_waitcnt lgkmcnt(2)
    v_mfma_f32_32x32x16_bf16 v[0:15], v[16:19], v[24:27], v[0:15]
    ds_read_b128 v[16:19], v34 offset:8192
    ds_read_b128 v[24:27], v69 offset:10240
    s_waitcnt lgkmcnt(2)
    v_mfma_f32_32x32x16_bf16 v[0:15], v[20:23], v[28:31], v[0:15]
    ds_read_b128 v[20:23], v35 offset:8192
    ds_read_b128 v[28:31], v69 offset:11264
    s_waitcnt lgkmcnt(2)
    v_mfma_f32_32x32x16_bf16 v[0:15], v[16:19], v[24:27], v[0:15]
    s_waitcnt lgkmcnt(0)
    v_mfma_f32_32x32x16_bf16 v[0:15], v[20:23], v[28:31], v[0:15]
    s_mov_b32 s30, 640
    s_add_u32 m0, s28, 8192
    s_nop 0
    buffer_load_dwordx4 v36, s[8:11], s30 offen lds
    s_add_u32 m0, s28, 9216
    s_nop 0
    buffer_load_dwordx4 v37, s[8:11], s30 offen lds
    s_add_u32 m0, s28, 10240
    s_nop 0
    buffer_load_dwordx4 v38, s[8:11], s30 offen lds
    s_add_u32 m0, s28, 11264
    s_nop 0
    buffer_load_dwordx4 v39, s[8:11], s30 offen lds
    s_waitcnt vmcnt(8)
    ds_read_b128 v[16:19], v32 offset:0
    ds_read_b128 v[24:27], v69 offset:12288
    ds_read_b128 v[20:23], v33 offset:0
    ds_read_b128 v[28:31], v69 offset:13312
    s_waitcnt lgkmcnt(2)
    v_mfma_f32_32x32x16_bf16 v[0:15], v[16:19], v[24:27], v[0:15]
    ds_read_b128 v[16:19], v34 offset:0
    ds_read_b128 v[24:27], v69 offset:14336
    s_waitcnt lgkmcnt(2)
    v_mfma_f32_32x32x16_bf16 v[0:15], v[20:23], v[28:31], v[0:15]
    ds_read_b128 v[20:23], v35 offset:0
    ds_read_b128 v[28:31], v69 offset:15360
    s_waitcnt lgkmcnt(2)
    v_mfma_f32_32x32x16_bf16 v[0:15], v[16:19], v[24:27], v[0:15]
    s_waitcnt lgkmcnt(0)
    v_mfma_f32_32x32x16_bf16 v[0:15], v[20:23], v[28:31], v[0:15]
    s_mov_b32 s30, 768
    s_add_u32 m0, s28, 0
    s_nop 0
    buffer_load_dwordx4 v36, s[8:11], s30 offen lds
    s_add_u32 m0, s28, 1024
    s_nop 0
    buffer_load_dwordx4 v37, s[8:11], s30 offen lds
    s_add_u32 m0, s28, 2048
    s_nop 0
    buffer_load_dwordx4 v38, s[8:11], s30 offen lds
    s_add_u32 m0, s28, 3072
    s_nop 0
    buffer_load_dwordx4 v39, s[8:11], s30 offen lds
    s_waitcnt vmcnt(8)
    ds_read_b128 v[16:19], v32 offset:4096
    ds_read_b128 v[24:27], v69 offset:16384
    ds_read_b128 v[20:23], v33 offset:4096
    ds_read_b128 v[28:31], v69 offset:17408
    s_waitcnt lgkmcnt(2)
    v_mfma_f32_32x32x16_bf16 v[0:15], v[16:19], v[24:27], v[0:15]
    ds_read_b128 v[16:19], v34 offset:4096
    ds_read_b128 v[24:27], v69 offset:18432
    s_waitcnt lgkmcnt(2)
    v_mfma_f32_32x32x16_bf16 v[0:15], v[20:23], v[28:31], v[0:15]
    ds_read_b128 v[20:23], v35 offset:4096
    ds_read_b128 v[28:31], v69 offset:19456
    s_waitcnt lgkmcnt(2)
    v_mfma_f32_32x32x16_bf16 v[0:15], v[16:19], v[24:27], v[0:15]
    s_waitcnt lgkmcnt(0)
    v_mfma_f32_32x32x16_bf16 v[0:15], v[20:23], v[28:31], v[0:15]
    s_mov_b32 s30, 896
    s_add_u32 m0, s28, 4096
    s_nop 0
    buffer_load_dwordx4 v36, s[8:11], s30 offen lds
    s_add_u32 m0, s28, 5120
    s_nop 0
    buffer_load_dwordx4 v37, s[8:11], s30 offen lds
    s_add_u32 m0, s28, 6144
    s_nop 0
    buffer_load_dwordx4 v38, s[8:11], s30 offen lds
    s_add_u32 m0, s28, 7168
    s_nop 0
    buffer_load_dwordx4 v39, s[8:11], s30 offen lds
    s_waitcnt vmcnt(8)
    ds_read_b128 v[16:19], v32 offset:8192
    ds_read_b128 v[24:27], v69 offset:20480
    ds_read_b128 v[20:23], v33 offset:8192
    ds_read_b128 v[28:31], v69 offset:21504
    s_waitcnt lgkmcnt(2)
    v_mfma_f32_32x32x16_bf16 v[0:15], v[16:19], v[24:27], v[0:15]
    ds_read_b128 v[16:19], v34 offset:8192
    ds_read_b128 v[24:27], v69 offset:22528
    s_waitcnt lgkmcnt(2)
    v_mfma_f32_32x32x16_bf16 v[0:15], v[20:23], v[28:31], v[0:15]
    ds_read_b128 v[20:23], v35 offset:8192
    ds_read_b128 v[28:31], v69 offset:23552
    s_waitcnt lgkmcnt(2)
    v_mfma_f32_32x32x16_bf16 v[0:15], v[16:19], v[24:27], v[0:15]
    s_waitcnt lgkmcnt(0)
    v_mfma_f32_32x32x16_bf16 v[0:15], v[20:23], v[28:31], v[0:15]
    s_mov_b32 s30, 1024
    s_add_u32 m0, s28, 8192
    s_nop 0
    buffer_load_dwordx4 v36, s[8:11], s30 offen lds
    s_add_u32 m0, s28, 9216
    s_nop 0
    buffer_load_dwordx4 v37, s[8:11], s30 offen lds
    s_add_u32 m0, s28, 10240
    s_nop 0
    buffer_load_dwordx4 v38, s[8:11], s30 offen lds
    s_add_u32 m0, s28, 11264
    s_nop 0
    buffer_load_dwordx4 v39, s[8:11], s30 offen lds
    s_waitcnt vmcnt(8)
    ds_read_b128 v[16:19], v32 offset:0
    ds_read_b128 v[24:27], v69 offset:24576
    ds_read_b128 v[20:23], v33 offset:0
    ds_read_b128 v[28:31], v69 offset:25600
    s_waitcnt lgkmcnt(2)
    v_mfma_f32_32x32x16_bf16 v[0:15], v[16:19], v[24:27], v[0:15]
    ds_read_b128 v[16:19], v34 offset:0
    ds_read_b128 v[24:27], v69 offset:26624
    s_waitcnt lgkmcnt(2)
    v_mfma_f32_32x32x16_bf16 v[0:15], v[20:23], v[28:31], v[0:15]
    ds_read_b128 v[20:23], v35 offset:0
    ds_read_b128 v[28:31], v69 offset:27648
    s_waitcnt lgkmcnt(2)
    v_mfma_f32_32x32x16_bf16 v[0:15], v[16:19], v[24:27], v[0:15]
    s_waitcnt lgkmcnt(0)
    v_mfma_f32_32x32x16_bf16 v[0:15], v[20:23], v[28:31], v[0:15]
    s_waitcnt vmcnt(4)
    ds_read_b128 v[16:19], v32 offset:4096
    ds_read_b128 v[24:27], v69 offset:28672
    ds_read_b128 v[20:23], v33 offset:4096
    ds_read_b128 v[28:31], v69 offset:29696
    s_waitcnt lgkmcnt(2)
    v_mfma_f32_32x32x16_bf16 v[0:15], v[16:19], v[24:27], v[0:15]
    ds_read_b128 v[16:19], v34 offset:4096
    ds_read_b128 v[24:27], v69 offset:30720
    s_waitcnt lgkmcnt(2)
    v_mfma_f32_32x32x16_bf16 v[0:15], v[20:23], v[28:31], v[0:15]
    ds_read_b128 v[20:23], v35 offset:4096
    ds_read_b128 v[28:31], v69 offset:31744
    s_waitcnt lgkmcnt(2)
    v_mfma_f32_32x32x16_bf16 v[0:15], v[16:19], v[24:27], v[0:15]
    s_waitcnt lgkmcnt(0)
    v_mfma_f32_32x32x16_bf16 v[0:15], v[20:23], v[28:31], v[0:15]
    s_waitcnt vmcnt(0)
    ds_read_b128 v[16:19], v32 offset:8192
    ds_read_b128 v[24:27], v69 offset:32768
    ds_read_b128 v[20:23], v33 offset:8192
    ds_read_b128 v[28:31], v69 offset:33792
    s_waitcnt lgkmcnt(2)
    v_mfma_f32_32x32x16_bf16 v[0:15], v[16:19], v[24:27], v[0:15]
    ds_read_b128 v[16:19], v34 offset:8192
    ds_read_b128 v[24:27], v69 offset:34816
    s_waitcnt lgkmcnt(2)
    v_mfma_f32_32x32x16_bf16 v[0:15], v[20:23], v[28:31], v[0:15]
    ds_read_b128 v[20:23], v35 offset:8192
    ds_read_b128 v[28:31], v69 offset:35840
    s_waitcnt lgkmcnt(2)
    v_mfma_f32_32x32x16_bf16 v[0:15], v[16:19], v[24:27], v[0:15]
    s_waitcnt lgkmcnt(0)
    v_mfma_f32_32x32x16_bf16 v[0:15], v[20:23], v[28:31], v[0:15]
    s_lshr_b32 s4, s27, 5
    s_lshl_b32 s4, s4, 11
    s_and_b32 s3, s27, 31
    s_lshl_b32 s3, s3, 4
    s_add_u32 s3, s3, s4
    s_lshl_b32 s4, s26, 5
    v_add_u32 v51, s4, v49
    v_lshlrev_b32 v51, 12, v51
    v_lshl_add_u32 v51, v50, 9, v51
    s_nop 2
    v_cvt_pk_bf16_f32 v60, v0, v1
    v_cvt_pk_bf16_f32 v61, v2, v3
    v_cvt_pk_bf16_f32 v62, v4, v5
    v_cvt_pk_bf16_f32 v63, v6, v7
    v_cvt_pk_bf16_f32 v64, v8, v9
    v_cvt_pk_bf16_f32 v65, v10, v11
    v_cvt_pk_bf16_f32 v66, v12, v13
    v_cvt_pk_bf16_f32 v67, v14, v15
    buffer_store_dwordx4 v[60:63], v51, s[12:15], s3 offen
    buffer_store_dwordx4 v[64:67], v51, s[12:15], s3 offen offset:1024
    s_endpgm
Lm1_main:
    s_mov_b32 s99, 0x7f000000
    s_load_dwordx4 s[36:39], s[0:1], 0
    s_load_dwordx4 s[40:43], s[0:1], 16
    s_load_dwordx2 s[44:45], s[0:1], 32
    s_load_dwordx2 s[46:47], s[0:1], 88
    v_lshrrev_b32 v1, 6, v0
    s_nop 0
    v_readfirstlane_b32 s22, v1
    s_cmp_ge_u32 s2, 256
    s_cbranch_scc1 Lproj_exit
    s_waitcnt lgkmcnt(0)
    s_and_b32 s4, s2, 7
    s_lshr_b32 s5, s2, 3
    s_and_b32 s6, s5, 7
    s_lshr_b32 s5, s5, 3
    s_lshl_b32 s4, s4, 2
    s_add_u32 s7, s4, s5
    s_lshl_b32 s20, s6, 8
    s_lshl_b32 s68, s7, 7
    s_mov_b32 s64, s46
    s_mov_b32 s65, s47
    s_mov_b32 s66, 16777216
    s_mov_b32 s67, 0x00020000
    s_lshl_b32 s25, s2, 3
    s_add_u32 s25, s25, s22
    v_and_b32 v200, 63, v0
    v_lshlrev_b32 v200, 4, v200
    s_load_dwordx4 s[76:79], s[0:1], 48
    s_load_dwordx2 s[88:89], s[0:1], 64
    s_waitcnt lgkmcnt(0)
    s_mov_b32 s72, s38
    s_mov_b32 s73, s39
    s_mov_b32 s74, 2097152
    s_mov_b32 s75, 0x00020000
    s_mul_i32 s26, s25, 1024
    buffer_load_dwordx4 v[204:207], v200, s[72:75], s26 offen offset:0
    s_mov_b32 s72, s42
    s_mov_b32 s73, s43
    s_mov_b32 s74, 4194304
    s_mov_b32 s75, 0x00020000
    s_mul_i32 s26, s25, 2048
    buffer_load_dwordx4 v[208:211], v200, s[72:75], s26 offen offset:0
    buffer_load_dwordx4 v[212:215], v200, s[72:75], s26 offen offset:1024
    s_mov_b32 s72, s44
    s_mov_b32 s73, s45
    s_mov_b32 s74, 4194304
    s_mov_b32 s75, 0x00020000
    s_mul_i32 s26, s25, 2048
    buffer_load_dwordx4 v[216:219], v200, s[72:75], s26 offen offset:0
    buffer_load_dwordx4 v[220:223], v200, s[72:75], s26 offen offset:1024
    s_mov_b32 s72, s36
    s_mov_b32 s73, s37
    s_mov_b32 s74, 2359296
    s_mov_b32 s75, 0x00020000
    s_mul_i32 s26, s25, 1152
    buffer_load_dwordx4 v[224:227], v200, s[72:75], s26 offen offset:0
    buffer_load_dwordx4 v[228:231], v200, s[72:75], s26 offen offset:1024
    s_mov_b32 s72, s40
    s_mov_b32 s73, s41
    s_mov_b32 s74, 4718592
    s_mov_b32 s75, 0x00020000
    s_mul_i32 s26, s25, 2304
    buffer_load_dwordx4 v[232:235], v200, s[72:75], s26 offen offset:0
    buffer_load_dwordx4 v[236:239], v200, s[72:75], s26 offen offset:1024
    buffer_load_dwordx4 v[240:243], v200, s[72:75], s26 offen offset:2048
    s_mov_b32 s72, s76
    s_mov_b32 s73, s77
    s_mov_b32 s74, 2359296
    s_mov_b32 s75, 0x00020000
    s_mul_i32 s26, s25, 1152
    buffer_load_dwordx4 v[244:247], v200, s[72:75], s26 offen offset:0
    buffer_load_dwordx4 v[248:251], v200, s[72:75], s26 offen offset:1024
    s_mov_b32 s72, s78
    s_mov_b32 s73, s79
    s_mov_b32 s74, 1183744
    s_mov_b32 s75, 0x00020000
    s_mul_i32 s26, s25, 578
    buffer_load_dwordx4 v[204:207], v200, s[72:75], s26 offen offset:0
    s_mov_b32 s72, s88
    s_mov_b32 s73, s89
    s_mov_b32 s74, 1183744
    s_mov_b32 s75, 0x00020000
    s_mul_i32 s26, s25, 578
    buffer_load_dwordx4 v[208:211], v200, s[72:75], s26 offen offset:0
    s_mov_b32 s8, s38
    s_mov_b32 s9, s39
    s_mov_b32 s10, 2097152
    s_mov_b32 s11, 0x00020000
    s_cmp_ge_u32 s7, 16
    s_cbranch_scc1 Lproj_v
    s_mov_b32 s12, s42
    s_mov_b32 s13, s43
    s_mov_b32 s14, 4194304
    s_mov_b32 s15, 0x00020000
    s_add_u32 s16, s46, 16777216
    s_addc_u32 s17, s47, 0
    s_mov_b32 s18, 16777216
    s_mov_b32 s19, 0x00020000
    s_lshl_b32 s21, s7, 8
    v_mbcnt_lo_u32_b32 v192, -1, 0
    v_mbcnt_hi_u32_b32 v192, -1, v192
    v_and_b32 v193, 31, v192
    v_bfe_u32 v194, v192, 5, 1
    s_and_b32 s23, s22, 1
    s_lshr_b32 s24, s22, 1
    s_mul_i32 s25, s23, 8192
    v_lshlrev_b32 v195, 6, v193
    v_add_u32 v195, s25, v195
    v_bfe_u32 v196, v192, 2, 2
    v_or_b32 v197, 0, v194
    v_xor_b32 v197, v197, v196
    v_lshl_add_u32 v180, v197, 4, v195
    v_or_b32 v197, 2, v194
    v_xor_b32 v197, v197, v196
    v_lshl_add_u32 v181, v197, 4, v195
    v_bfe_u32 v197, v192, 2, 2
    v_and_b32 v198, 3, v192
    v_bfe_u32 v199, v192, 4, 1
    v_lshl_add_u32 v200, v194, 3, v197
    v_mul_u32_u24 v200, 512, v200
    v_add_u32 v200, 16384, v200
    v_and_b32 v201, 1, v198
    v_lshl_add_u32 v200, v201, 3, v200
    v_lshrrev_b32 v201, 1, v198
    v_lshl_add_u32 v201, v199, 1, v201
    s_lshl_b32 s25, s24, 1
    s_add_u32 s25, s25, 0
    s_lshl_b32 s25, s25, 2
    v_add_u32 v202, s25, v201
    v_lshlrev_b32 v203, 2, v197
    v_xor_b32 v202, v202, v203
    v_lshl_add_u32 v182, v202, 4, v200
    s_lshl_b32 s25, s24, 1
    s_add_u32 s25, s25, 1
    s_lshl_b32 s25, s25, 2
    v_add_u32 v202, s25, v201
    v_lshlrev_b32 v203, 2, v197
    v_xor_b32 v202, v202, v203
    v_lshl_add_u32 v183, v202, 4, v200
    v_lshrrev_b32 v197, 2, v192
    v_and_b32 v198, 3, v192
    v_bfe_u32 v200, v192, 4, 2
    v_xor_b32 v200, v200, v198
    s_lshl_b32 s25, s22, 5
    s_add_u32 s25, s25, s20
    s_mov_b32 s26, 1024
    v_add_u32 v199, 0, v197
    v_add_u32 v199, s25, v199
    v_mul_lo_u32 v199, v199, s26
    v_lshl_add_u32 v188, v200, 4, v199
    v_add_u32 v199, 16, v197
    v_add_u32 v199, s25, v199
    v_mul_lo_u32 v199, v199, s26
    v_lshl_add_u32 v189, v200, 4, v199
    s_lshl_b32 s25, s21, 1
    v_lshrrev_b32 v197, 5, v192
    v_and_b32 v198, 31, v192
    v_add_u32 v199, 0, v197
    v_lshlrev_b32 v200, 2, v199
    v_xor_b32 v200, v200, v198
    s_lshl_b32 s26, s22, 2
    v_add_u32 v199, s26, v199
    v_lshlrev_b32 v199, 13, v199
    v_lshl_add_u32 v199, v200, 4, v199
    v_add_u32 v190, s25, v199
    v_add_u32 v199, 2, v197
    v_lshlrev_b32 v200, 2, v199
    v_xor_b32 v200, v200, v198
    s_lshl_b32 s26, s22, 2
    v_add_u32 v199, s26, v199
    v_lshlrev_b32 v199, 13, v199
    v_lshl_add_u32 v199, v200, 4, v199
    v_add_u32 v191, s25, v199
    s_lshl_b32 s28, s22, 11
    s_mul_i32 s29, s22, 2048
    s_add_u32 s29, s29, 16384
    s_mov_b32 s30, 0
    s_mov_b32 s31, 0
    s_mov_b32 s32, 0
    s_mov_b32 s33, 0
    s_add_u32 m0, s28, s32
    s_nop 0
    buffer_load_dwordx4 v188, s[8:11], s30 offen lds
    s_add_u32 m0, s28, s32
    s_add_u32 m0, m0, 1024
    s_nop 0
    buffer_load_dwordx4 v189, s[8:11], s30 offen lds
    s_add_u32 m0, s29, s32
    s_nop 0
    buffer_load_dwordx4 v190, s[12:15], s31 offen lds
    s_add_u32 m0, s29, s32
    s_add_u32 m0, m0, 1024
    s_nop 0
    buffer_load_dwordx4 v191, s[12:15], s31 offen lds
    s_add_u32 s30, s30, 64
    s_add_u32 s31, s31, 0x40000
    s_add_u32 s32, s32, 32768
    s_cmp_eq_u32 s32, 163840
    s_cselect_b32 s32, 0, s32
    s_add_u32 m0, s28, s32
    s_nop 0
    buffer_load_dwordx4 v188, s[8:11], s30 offen lds
    s_add_u32 m0, s28, s32
    s_add_u32 m0, m0, 1024
    s_nop 0
    buffer_load_dwordx4 v189, s[8:11], s30 offen lds
    s_add_u32 m0, s29, s32
    s_nop 0
    buffer_load_dwordx4 v190, s[12:15], s31 offen lds
    s_add_u32 m0, s29, s32
    s_add_u32 m0, m0, 1024
    s_nop 0
    buffer_load_dwordx4 v191, s[12:15], s31 offen lds
    s_add_u32 s30, s30, 64
    s_add_u32 s31, s31, 0x40000
    s_add_u32 s32, s32, 32768
    s_cmp_eq_u32 s32, 163840
    s_cselect_b32 s32, 0, s32
    s_add_u32 m0, s28, s32
    s_nop 0
    buffer_load_dwordx4 v188, s[8:11], s30 offen lds
    s_add_u32 m0, s28, s32
    s_add_u32 m0, m0, 1024
    s_nop 0
    buffer_load_dwordx4 v189, s[8:11], s30 offen lds
    s_add_u32 m0, s29, s32
    s_nop 0
    buffer_load_dwordx4 v190, s[12:15], s31 offen lds
    s_add_u32 m0, s29, s32
    s_add_u32 m0, m0, 1024
    s_nop 0
    buffer_load_dwordx4 v191, s[12:15], s31 offen lds
    s_add_u32 s30, s30, 64
    s_add_u32 s31, s31, 0x40000
    s_add_u32 s32, s32, 32768
    s_cmp_eq_u32 s32, 163840
    s_cselect_b32 s32, 0, s32
    s_add_u32 m0, s28, s32
    s_nop 0
    buffer_load_dwordx4 v188, s[8:11], s30 offen lds
    s_add_u32 m0, s28, s32
    s_add_u32 m0, m0, 1024
    s_nop 0
    buffer_load_dwordx4 v189, s[8:11], s30 offen lds
    s_add_u32 m0, s29, s32
    s_nop 0
    buffer_load_dwordx4 v190, s[12:15], s31 offen lds
    s_add_u32 m0, s29, s32
    s_add_u32 m0, m0, 1024
    s_nop 0
    buffer_load_dwordx4 v191, s[12:15], s31 offen lds
    s_add_u32 s30, s30, 64
    s_add_u32 s31, s31, 0x40000
    s_add_u32 s32, s32, 32768
    s_cmp_eq_u32 s32, 163840
    s_cselect_b32 s32, 0, s32
    s_waitcnt vmcnt(12)
    s_barrier
    v_add_u32 v184, s33, v180
    v_add_u32 v185, s33, v181
    v_add_u32 v186, s33, v182
    v_add_u32 v187, s33, v183
    s_add_u32 s33, s33, 32768
    s_cmp_eq_u32 s33, 163840
    s_cselect_b32 s33, 0, s33
    ds_read_b128 v[128:131], v184 offset:0
    ds_read_b128 v[132:135], v184 offset:2048
    ds_read_b128 v[136:139], v184 offset:4096
    ds_read_b128 v[140:143], v184 offset:6144
    ds_read_b64_tr_b16 v[144:145], v186 offset:0
    ds_read_b64_tr_b16 v[146:147], v186 offset:2048
    ds_read_b64_tr_b16 v[148:149], v187 offset:0
    ds_read_b64_tr_b16 v[150:151], v187 offset:2048
    ds_read_b128 v[152:155], v185 offset:0
    ds_read_b128 v[156:159], v185 offset:2048
    ds_read_b128 v[160:163], v185 offset:4096
    ds_read_b128 v[164:167], v185 offset:6144
    ds_read_b64_tr_b16 v[168:169], v186 offset:8192
    ds_read_b64_tr_b16 v[170:171], v186 offset:10240
    ds_read_b64_tr_b16 v[172:173], v187 offset:8192
    ds_read_b64_tr_b16 v[174:175], v187 offset:10240
    s_waitcnt lgkmcnt(8)
    v_mfma_f32_32x32x16_bf16 v[0:15], v[144:147], v[128:131], 0
    v_mfma_f32_32x32x16_bf16 v[16:31], v[148:151], v[128:131], 0
    v_mfma_f32_32x32x16_bf16 v[32:47], v[144:147], v[132:135], 0
    v_mfma_f32_32x32x16_bf16 v[48:63], v[148:151], v[132:135], 0
    v_mfma_f32_32x32x16_bf16 v[64:79], v[144:147], v[136:139], 0
    v_mfma_f32_32x32x16_bf16 v[80:95], v[148:151], v[136:139], 0
    v_mfma_f32_32x32x16_bf16 v[96:111], v[144:147], v[140:143], 0
    v_mfma_f32_32x32x16_bf16 v[112:127], v[148:151], v[140:143], 0
    s_waitcnt vmcnt(8) lgkmcnt(0)
    s_barrier
    v_add_u32 v184, s33, v180
    v_add_u32 v185, s33, v181
    v_add_u32 v186, s33, v182
    v_add_u32 v187, s33, v183
    s_add_u32 s33, s33, 32768
    s_cmp_eq_u32 s33, 163840
    s_cselect_b32 s33, 0, s33
    v_mfma_f32_32x32x16_bf16 v[0:15], v[168:171], v[152:155], v[0:15]
    ds_read_b128 v[128:131], v184 offset:0
    ds_read_b128 v[132:135], v184 offset:2048
    v_mfma_f32_32x32x16_bf16 v[16:31], v[172:175], v[152:155], v[16:31]
    ds_read_b128 v[136:139], v184 offset:4096
    ds_read_b128 v[140:143], v184 offset:6144
    ds_read_b64_tr_b16 v[144:145], v186 offset:0
    v_mfma_f32_32x32x16_bf16 v[32:47], v[168:171], v[156:159], v[32:47]
    ds_read_b64_tr_b16 v[146:147], v186 offset:2048
    ds_read_b64_tr_b16 v[148:149], v187 offset:0
    ds_read_b64_tr_b16 v[150:151], v187 offset:2048
    v_mfma_f32_32x32x16_bf16 v[48:63], v[172:175], v[156:159], v[48:63]
    s_add_u32 m0, s28, s32
    s_nop 0
    buffer_load_dwordx4 v188, s[8:11], s30 offen lds
    s_add_u32 m0, s28, s32
    v_mfma_f32_32x32x16_bf16 v[64:79], v[168:171], v[160:163], v[64:79]
    s_add_u32 m0, m0, 1024
    s_nop 0
    buffer_load_dwordx4 v189, s[8:11], s30 offen lds
    s_add_u32 m0, s29, s32
    v_mfma_f32_32x32x16_bf16 v[80:95], v[172:175], v[160:163], v[80:95]
    buffer_load_dwordx4 v190, s[12:15], s31 offen lds
    s_add_u32 m0, s29, s32
    s_add_u32 m0, m0, 1024
    v_mfma_f32_32x32x16_bf16 v[96:111], v[168:171], v[164:167], v[96:111]
    buffer_load_dwordx4 v191, s[12:15], s31 offen lds
    s_add_u32 s30, s30, 64
    s_add_u32 s31, s31, 0x40000
    v_mfma_f32_32x32x16_bf16 v[112:127], v[172:175], v[164:167], v[112:127]
    s_add_u32 s32, s32, 32768
    s_cmp_eq_u32 s32, 163840
    s_cselect_b32 s32, 0, s32
    s_mov_b32 s27, 11
Lk_loop:
    ds_read_b128 v[152:155], v185 offset:0
    ds_read_b128 v[156:159], v185 offset:2048
    ds_read_b128 v[160:163], v185 offset:4096
    ds_read_b128 v[164:167], v185 offset:6144
    ds_read_b64_tr_b16 v[168:169], v186 offset:8192
    ds_read_b64_tr_b16 v[170:171], v186 offset:10240
    ds_read_b64_tr_b16 v[172:173], v187 offset:8192
    ds_read_b64_tr_b16 v[174:175], v187 offset:10240
    s_waitcnt lgkmcnt(8)
    v_mfma_f32_32x32x16_bf16 v[0:15], v[144:147], v[128:131], v[0:15]
    v_mfma_f32_32x32x16_bf16 v[16:31], v[148:151], v[128:131], v[16:31]
    v_mfma_f32_32x32x16_bf16 v[32:47], v[144:147], v[132:135], v[32:47]
    v_mfma_f32_32x32x16_bf16 v[48:63], v[148:151], v[132:135], v[48:63]
    v_mfma_f32_32x32x16_bf16 v[64:79], v[144:147], v[136:139], v[64:79]
    v_mfma_f32_32x32x16_bf16 v[80:95], v[148:151], v[136:139], v[80:95]
    v_mfma_f32_32x32x16_bf16 v[96:111], v[144:147], v[140:143], v[96:111]
    v_mfma_f32_32x32x16_bf16 v[112:127], v[148:151], v[140:143], v[112:127]
    s_waitcnt vmcnt(8) lgkmcnt(0)
    s_barrier
    v_add_u32 v184, s33, v180
    v_add_u32 v185, s33, v181
    v_add_u32 v186, s33, v182
    v_add_u32 v187, s33, v183
    s_add_u32 s33, s33, 32768
    s_cmp_eq_u32 s33, 163840
    s_cselect_b32 s33, 0, s33
    v_mfma_f32_32x32x16_bf16 v[0:15], v[168:171], v[152:155], v[0:15]
    ds_read_b128 v[128:131], v184 offset:0
    ds_read_b128 v[132:135], v184 offset:2048
    v_mfma_f32_32x32x16_bf16 v[16:31], v[172:175], v[152:155], v[16:31]
    ds_read_b128 v[136:139], v184 offset:4096
    ds_read_b128 v[140:143], v184 offset:6144
    ds_read_b64_tr_b16 v[144:145], v186 offset:0
    v_mfma_f32_32x32x16_bf16 v[32:47], v[168:171], v[156:159], v[32:47]
    ds_read_b64_tr_b16 v[146:147], v186 offset:2048
    ds_read_b64_tr_b16 v[148:149], v187 offset:0
    ds_read_b64_tr_b16 v[150:151], v187 offset:2048
    v_mfma_f32_32x32x16_bf16 v[48:63], v[172:175], v[156:159], v[48:63]
    s_add_u32 m0, s28, s32
    s_nop 0
    buffer_load_dwordx4 v188, s[8:11], s30 offen lds
    s_add_u32 m0, s28, s32
    v_mfma_f32_32x32x16_bf16 v[64:79], v[168:171], v[160:163], v[64:79]
    s_add_u32 m0, m0, 1024
    s_nop 0
    buffer_load_dwordx4 v189, s[8:11], s30 offen lds
    s_add_u32 m0, s29, s32
    v_mfma_f32_32x32x16_bf16 v[80:95], v[172:175], v[160:163], v[80:95]
    buffer_load_dwordx4 v190, s[12:15], s31 offen lds
    s_add_u32 m0, s29, s32
    s_add_u32 m0, m0, 1024
    v_mfma_f32_32x32x16_bf16 v[96:111], v[168:171], v[164:167], v[96:111]
    buffer_load_dwordx4 v191, s[12:15], s31 offen lds
    s_add_u32 s30, s30, 64
    s_add_u32 s31, s31, 0x40000
    v_mfma_f32_32x32x16_bf16 v[112:127], v[172:175], v[164:167], v[112:127]
    s_add_u32 s32, s32, 32768
    s_cmp_eq_u32 s32, 163840
    s_cselect_b32 s32, 0, s32
    s_sub_u32 s27, s27, 1
    s_cmp_lg_u32 s27, 0
    s_cbranch_scc1 Lk_loop
    ds_read_b128 v[152:155], v185 offset:0
    ds_read_b128 v[156:159], v185 offset:2048
    ds_read_b128 v[160:163], v185 offset:4096
    ds_read_b128 v[164:167], v185 offset:6144
    ds_read_b64_tr_b16 v[168:169], v186 offset:8192
    ds_read_b64_tr_b16 v[170:171], v186 offset:10240
    ds_read_b64_tr_b16 v[172:173], v187 offset:8192
    ds_read_b64_tr_b16 v[174:175], v187 offset:10240
    s_waitcnt lgkmcnt(8)
    v_mfma_f32_32x32x16_bf16 v[0:15], v[144:147], v[128:131], v[0:15]
    v_mfma_f32_32x32x16_bf16 v[16:31], v[148:151], v[128:131], v[16:31]
    v_mfma_f32_32x32x16_bf16 v[32:47], v[144:147], v[132:135], v[32:47]
    v_mfma_f32_32x32x16_bf16 v[48:63], v[148:151], v[132:135], v[48:63]
    v_mfma_f32_32x32x16_bf16 v[64:79], v[144:147], v[136:139], v[64:79]
    v_mfma_f32_32x32x16_bf16 v[80:95], v[148:151], v[136:139], v[80:95]
    v_mfma_f32_32x32x16_bf16 v[96:111], v[144:147], v[140:143], v[96:111]
    v_mfma_f32_32x32x16_bf16 v[112:127], v[148:151], v[140:143], v[112:127]
    s_waitcnt vmcnt(8) lgkmcnt(0)
    s_barrier
    v_add_u32 v184, s33, v180
    v_add_u32 v185, s33, v181
    v_add_u32 v186, s33, v182
    v_add_u32 v187, s33, v183
    s_add_u32 s33, s33, 32768
    s_cmp_eq_u32 s33, 163840
    s_cselect_b32 s33, 0, s33
    v_mfma_f32_32x32x16_bf16 v[0:15], v[168:171], v[152:155], v[0:15]
    ds_read_b128 v[128:131], v184 offset:0
    v_mfma_f32_32x32x16_bf16 v[16:31], v[172:175], v[152:155], v[16:31]
    ds_read_b128 v[132:135], v184 offset:2048
    v_mfma_f32_32x32x16_bf16 v[32:47], v[168:171], v[156:159], v[32:47]
    ds_read_b128 v[136:139], v184 offset:4096
    v_mfma_f32_32x32x16_bf16 v[48:63], v[172:175], v[156:159], v[48:63]
    ds_read_b128 v[140:143], v184 offset:6144
    v_mfma_f32_32x32x16_bf16 v[64:79], v[168:171], v[160:163], v[64:79]
    ds_read_b64_tr_b16 v[144:145], v186 offset:0
    v_mfma_f32_32x32x16_bf16 v[80:95], v[172:175], v[160:163], v[80:95]
    ds_read_b64_tr_b16 v[146:147], v186 offset:2048
    v_mfma_f32_32x32x16_bf16 v[96:111], v[168:171], v[164:167], v[96:111]
    ds_read_b64_tr_b16 v[148:149], v187 offset:0
    v_mfma_f32_32x32x16_bf16 v[112:127], v[172:175], v[164:167], v[112:127]
    ds_read_b64_tr_b16 v[150:151], v187 offset:2048
    ds_read_b128 v[152:155], v185 offset:0
    ds_read_b128 v[156:159], v185 offset:2048
    ds_read_b128 v[160:163], v185 offset:4096
    ds_read_b128 v[164:167], v185 offset:6144
    ds_read_b64_tr_b16 v[168:169], v186 offset:8192
    ds_read_b64_tr_b16 v[170:171], v186 offset:10240
    ds_read_b64_tr_b16 v[172:173], v187 offset:8192
    ds_read_b64_tr_b16 v[174:175], v187 offset:10240
    s_waitcnt lgkmcnt(8)
    v_mfma_f32_32x32x16_bf16 v[0:15], v[144:147], v[128:131], v[0:15]
    v_mfma_f32_32x32x16_bf16 v[16:31], v[148:151], v[128:131], v[16:31]
    v_mfma_f32_32x32x16_bf16 v[32:47], v[144:147], v[132:135], v[32:47]
    v_mfma_f32_32x32x16_bf16 v[48:63], v[148:151], v[132:135], v[48:63]
    v_mfma_f32_32x32x16_bf16 v[64:79], v[144:147], v[136:139], v[64:79]
    v_mfma_f32_32x32x16_bf16 v[80:95], v[148:151], v[136:139], v[80:95]
    v_mfma_f32_32x32x16_bf16 v[96:111], v[144:147], v[140:143], v[96:111]
    v_mfma_f32_32x32x16_bf16 v[112:127], v[148:151], v[140:143], v[112:127]
    s_waitcnt vmcnt(4) lgkmcnt(0)
    s_barrier
    v_add_u32 v184, s33, v180
    v_add_u32 v185, s33, v181
    v_add_u32 v186, s33, v182
    v_add_u32 v187, s33, v183
    s_add_u32 s33, s33, 32768
    s_cmp_eq_u32 s33, 163840
    s_cselect_b32 s33, 0, s33
    v_mfma_f32_32x32x16_bf16 v[0:15], v[168:171], v[152:155], v[0:15]
    ds_read_b128 v[128:131], v184 offset:0
    v_mfma_f32_32x32x16_bf16 v[16:31], v[172:175], v[152:155], v[16:31]
    ds_read_b128 v[132:135], v184 offset:2048
    v_mfma_f32_32x32x16_bf16 v[32:47], v[168:171], v[156:159], v[32:47]
    ds_read_b128 v[136:139], v184 offset:4096
    v_mfma_f32_32x32x16_bf16 v[48:63], v[172:175], v[156:159], v[48:63]
    ds_read_b128 v[140:143], v184 offset:6144
    v_mfma_f32_32x32x16_bf16 v[64:79], v[168:171], v[160:163], v[64:79]
    ds_read_b64_tr_b16 v[144:145], v186 offset:0
    v_mfma_f32_32x32x16_bf16 v[80:95], v[172:175], v[160:163], v[80:95]
    ds_read_b64_tr_b16 v[146:147], v186 offset:2048
    v_mfma_f32_32x32x16_bf16 v[96:111], v[168:171], v[164:167], v[96:111]
    ds_read_b64_tr_b16 v[148:149], v187 offset:0
    v_mfma_f32_32x32x16_bf16 v[112:127], v[172:175], v[164:167], v[112:127]
    ds_read_b64_tr_b16 v[150:151], v187 offset:2048
    ds_read_b128 v[152:155], v185 offset:0
    ds_read_b128 v[156:159], v185 offset:2048
    ds_read_b128 v[160:163], v185 offset:4096
    ds_read_b128 v[164:167], v185 offset:6144
    ds_read_b64_tr_b16 v[168:169], v186 offset:8192
    ds_read_b64_tr_b16 v[170:171], v186 offset:10240
    ds_read_b64_tr_b16 v[172:173], v187 offset:8192
    ds_read_b64_tr_b16 v[174:175], v187 offset:10240
    s_waitcnt lgkmcnt(8)
    v_mfma_f32_32x32x16_bf16 v[0:15], v[144:147], v[128:131], v[0:15]
    v_mfma_f32_32x32x16_bf16 v[16:31], v[148:151], v[128:131], v[16:31]
    v_mfma_f32_32x32x16_bf16 v[32:47], v[144:147], v[132:135], v[32:47]
    v_mfma_f32_32x32x16_bf16 v[48:63], v[148:151], v[132:135], v[48:63]
    v_mfma_f32_32x32x16_bf16 v[64:79], v[144:147], v[136:139], v[64:79]
    v_mfma_f32_32x32x16_bf16 v[80:95], v[148:151], v[136:139], v[80:95]
    v_mfma_f32_32x32x16_bf16 v[96:111], v[144:147], v[140:143], v[96:111]
    v_mfma_f32_32x32x16_bf16 v[112:127], v[148:151], v[140:143], v[112:127]
    s_waitcnt vmcnt(0) lgkmcnt(0)
    s_barrier
    v_add_u32 v184, s33, v180
    v_add_u32 v185, s33, v181
    v_add_u32 v186, s33, v182
    v_add_u32 v187, s33, v183
    s_add_u32 s33, s33, 32768
    s_cmp_eq_u32 s33, 163840
    s_cselect_b32 s33, 0, s33
    v_mfma_f32_32x32x16_bf16 v[0:15], v[168:171], v[152:155], v[0:15]
    ds_read_b128 v[128:131], v184 offset:0
    v_mfma_f32_32x32x16_bf16 v[16:31], v[172:175], v[152:155], v[16:31]
    ds_read_b128 v[132:135], v184 offset:2048
    v_mfma_f32_32x32x16_bf16 v[32:47], v[168:171], v[156:159], v[32:47]
    ds_read_b128 v[136:139], v184 offset:4096
    v_mfma_f32_32x32x16_bf16 v[48:63], v[172:175], v[156:159], v[48:63]
    ds_read_b128 v[140:143], v184 offset:6144
    v_mfma_f32_32x32x16_bf16 v[64:79], v[168:171], v[160:163], v[64:79]
    ds_read_b64_tr_b16 v[144:145], v186 offset:0
    v_mfma_f32_32x32x16_bf16 v[80:95], v[172:175], v[160:163], v[80:95]
    ds_read_b64_tr_b16 v[146:147], v186 offset:2048
    v_mfma_f32_32x32x16_bf16 v[96:111], v[168:171], v[164:167], v[96:111]
    ds_read_b64_tr_b16 v[148:149], v187 offset:0
    v_mfma_f32_32x32x16_bf16 v[112:127], v[172:175], v[164:167], v[112:127]
    ds_read_b64_tr_b16 v[150:151], v187 offset:2048
    ds_read_b128 v[152:155], v185 offset:0
    ds_read_b128 v[156:159], v185 offset:2048
    ds_read_b128 v[160:163], v185 offset:4096
    ds_read_b128 v[164:167], v185 offset:6144
    ds_read_b64_tr_b16 v[168:169], v186 offset:8192
    ds_read_b64_tr_b16 v[170:171], v186 offset:10240
    ds_read_b64_tr_b16 v[172:173], v187 offset:8192
    ds_read_b64_tr_b16 v[174:175], v187 offset:10240
    s_waitcnt lgkmcnt(8)
    v_mfma_f32_32x32x16_bf16 v[0:15], v[144:147], v[128:131], v[0:15]
    v_mfma_f32_32x32x16_bf16 v[16:31], v[148:151], v[128:131], v[16:31]
    v_mfma_f32_32x32x16_bf16 v[32:47], v[144:147], v[132:135], v[32:47]
    v_mfma_f32_32x32x16_bf16 v[48:63], v[148:151], v[132:135], v[48:63]
    v_mfma_f32_32x32x16_bf16 v[64:79], v[144:147], v[136:139], v[64:79]
    v_mfma_f32_32x32x16_bf16 v[80:95], v[148:151], v[136:139], v[80:95]
    v_mfma_f32_32x32x16_bf16 v[96:111], v[144:147], v[140:143], v[96:111]
    v_mfma_f32_32x32x16_bf16 v[112:127], v[148:151], v[140:143], v[112:127]
    s_waitcnt lgkmcnt(0)
    v_mfma_f32_32x32x16_bf16 v[0:15], v[168:171], v[152:155], v[0:15]
    v_mfma_f32_32x32x16_bf16 v[16:31], v[172:175], v[152:155], v[16:31]
    v_mfma_f32_32x32x16_bf16 v[32:47], v[168:171], v[156:159], v[32:47]
    v_mfma_f32_32x32x16_bf16 v[48:63], v[172:175], v[156:159], v[48:63]
    v_mfma_f32_32x32x16_bf16 v[64:79], v[168:171], v[160:163], v[64:79]
    v_mfma_f32_32x32x16_bf16 v[80:95], v[172:175], v[160:163], v[80:95]
    v_mfma_f32_32x32x16_bf16 v[96:111], v[168:171], v[164:167], v[96:111]
    v_mfma_f32_32x32x16_bf16 v[112:127], v[172:175], v[164:167], v[112:127]
    s_barrier
    s_mov_b32 s8, s36
    s_mov_b32 s9, s37
    s_mov_b32 s10, 2359296
    s_mov_b32 s11, 0x00020000
    s_mov_b32 s12, s40
    s_mov_b32 s13, s41
    s_mov_b32 s14, 4718592
    s_mov_b32 s15, 0x00020000
    v_mbcnt_lo_u32_b32 v192, -1, 0
    v_mbcnt_hi_u32_b32 v192, -1, v192
    v_and_b32 v193, 31, v192
    v_bfe_u32 v194, v192, 5, 1
    s_and_b32 s69, s22, 3
    s_lshr_b32 s70, s22, 2
    s_mul_i32 s25, s69, 4096
    v_lshlrev_b32 v195, 6, v193
    v_add_u32 v195, s25, v195
    v_bfe_u32 v196, v192, 2, 2
    v_or_b32 v197, 0, v194
    v_xor_b32 v197, v197, v196
    v_lshl_add_u32 v180, v197, 4, v195
    v_or_b32 v197, 2, v194
    v_xor_b32 v197, v197, v196
    v_lshl_add_u32 v181, v197, 4, v195
    v_bfe_u32 v197, v192, 2, 2
    v_and_b32 v198, 3, v192
    v_bfe_u32 v199, v192, 4, 1
    v_lshl_add_u32 v200, v194, 3, v197
    v_mul_u32_u24 v200, 256, v200
    v_add_u32 v200, 16384, v200
    v_and_b32 v201, 1, v198
    v_lshl_add_u32 v200, v201, 3, v200
    v_lshrrev_b32 v201, 1, v198
    v_lshl_add_u32 v201, v199, 1, v201
    s_lshl_b32 s25, s70, 1
    s_add_u32 s25, s25, 0
    s_lshl_b32 s25, s25, 2
    v_add_u32 v202, s25, v201
    v_lshlrev_b32 v203, 2, v197
    v_xor_b32 v202, v202, v203
    v_lshl_add_u32 v182, v202, 4, v200
    s_lshl_b32 s25, s70, 1
    s_add_u32 s25, s25, 1
    s_lshl_b32 s25, s25, 2
    v_add_u32 v202, s25, v201
    v_lshlrev_b32 v203, 2, v197
    v_xor_b32 v202, v202, v203
    v_lshl_add_u32 v183, v202, 4, v200
    v_lshrrev_b32 v197, 2, v192
    v_and_b32 v198, 3, v192
    v_bfe_u32 v200, v192, 4, 2
    v_xor_b32 v200, v200, v198
    s_lshl_b32 s25, s22, 5
    s_add_u32 s25, s25, s20
    s_mov_b32 s26, 1152
    v_add_u32 v199, 0, v197
    v_add_u32 v199, s25, v199
    v_mul_lo_u32 v199, v199, s26
    v_lshl_add_u32 v188, v200, 4, v199
    v_add_u32 v199, 16, v197
    v_add_u32 v199, s25, v199
    v_mul_lo_u32 v199, v199, s26
    v_lshl_add_u32 v189, v200, 4, v199
    s_lshl_b32 s25, s68, 1
    v_lshrrev_b32 v197, 4, v192
    v_and_b32 v198, 15, v192
    v_lshlrev_b32 v200, 2, v197
    v_xor_b32 v200, v200, v198
    s_lshl_b32 s26, s22, 2
    v_add_u32 v199, s26, v197
    v_lshlrev_b32 v199, 13, v199
    v_lshl_add_u32 v199, v200, 4, v199
    v_add_u32 v190, s25, v199
    s_lshl_b32 s28, s22, 11
    s_mul_i32 s29, s22, 1024
    s_add_u32 s29, s29, 16384
    s_mov_b32 s30, 0
    s_mov_b32 s31, 0
    s_mov_b32 s32, 0
    s_mov_b32 s33, 0
    s_add_u32 m0, s28, s32
    s_nop 0
    buffer_load_dwordx4 v188, s[8:11], s30 offen lds
    s_add_u32 m0, s28, s32
    s_add_u32 m0, m0, 1024
    s_nop 0
    buffer_load_dwordx4 v189, s[8:11], s30 offen lds
    s_add_u32 m0, s29, s32
    s_nop 0
    buffer_load_dwordx4 v190, s[12:15], s31 offen lds
    s_add_u32 s30, s30, 64
    s_add_u32 s31, s31, 0x40000
    s_add_u32 s32, s32, 24576
    s_cmp_eq_u32 s32, 147456
    s_cselect_b32 s32, 0, s32
    s_add_u32 m0, s28, s32
    s_nop 0
    buffer_load_dwordx4 v188, s[8:11], s30 offen lds
    s_add_u32 m0, s28, s32
    s_add_u32 m0, m0, 1024
    s_nop 0
    buffer_load_dwordx4 v189, s[8:11], s30 offen lds
    s_add_u32 m0, s29, s32
    s_nop 0
    buffer_load_dwordx4 v190, s[12:15], s31 offen lds
    s_add_u32 s30, s30, 64
    s_add_u32 s31, s31, 0x40000
    s_add_u32 s32, s32, 24576
    s_cmp_eq_u32 s32, 147456
    s_cselect_b32 s32, 0, s32
    s_add_u32 m0, s28, s32
    s_nop 0
    buffer_load_dwordx4 v188, s[8:11], s30 offen lds
    s_add_u32 m0, s28, s32
    s_add_u32 m0, m0, 1024
    s_nop 0
    buffer_load_dwordx4 v189, s[8:11], s30 offen lds
    s_add_u32 m0, s29, s32
    s_nop 0
    buffer_load_dwordx4 v190, s[12:15], s31 offen lds
    s_add_u32 s30, s30, 64
    s_add_u32 s31, s31, 0x40000
    s_add_u32 s32, s32, 24576
    s_cmp_eq_u32 s32, 147456
    s_cselect_b32 s32, 0, s32
    s_add_u32 m0, s28, s32
    s_nop 0
    buffer_load_dwordx4 v188, s[8:11], s30 offen lds
    s_add_u32 m0, s28, s32
    s_add_u32 m0, m0, 1024
    s_nop 0
    buffer_load_dwordx4 v189, s[8:11], s30 offen lds
    s_add_u32 m0, s29, s32
    s_nop 0
    buffer_load_dwordx4 v190, s[12:15], s31 offen lds
    s_add_u32 s30, s30, 64
    s_add_u32 s31, s31, 0x40000
    s_add_u32 s32, s32, 24576
    s_cmp_eq_u32 s32, 147456
    s_cselect_b32 s32, 0, s32
    s_add_u32 m0, s28, s32
    s_nop 0
    buffer_load_dwordx4 v188, s[8:11], s30 offen lds
    s_add_u32 m0, s28, s32
    s_add_u32 m0, m0, 1024
    s_nop 0
    buffer_load_dwordx4 v189, s[8:11], s30 offen lds
    s_add_u32 m0, s29, s32
    s_nop 0
    buffer_load_dwordx4 v190, s[12:15], s31 offen lds
    s_add_u32 s30, s30, 64
    s_add_u32 s31, s31, 0x40000
    s_add_u32 s32, s32, 24576
    s_cmp_eq_u32 s32, 147456
    s_cselect_b32 s32, 0, s32
    v_cvt_pk_bf16_f32 v127, v126, v127
    v_cvt_pk_bf16_f32 v126, v124, v125
    v_cvt_pk_bf16_f32 v125, v122, v123
    v_cvt_pk_bf16_f32 v124, v120, v121
    v_cvt_pk_bf16_f32 v123, v118, v119
    v_cvt_pk_bf16_f32 v122, v116, v117
    v_cvt_pk_bf16_f32 v121, v114, v115
    v_cvt_pk_bf16_f32 v120, v112, v113
    v_cvt_pk_bf16_f32 v119, v110, v111
    v_cvt_pk_bf16_f32 v118, v108, v109
    v_cvt_pk_bf16_f32 v117, v106, v107
    v_cvt_pk_bf16_f32 v116, v104, v105
    v_cvt_pk_bf16_f32 v115, v102, v103
    v_cvt_pk_bf16_f32 v114, v100, v101
    v_cvt_pk_bf16_f32 v113, v98, v99
    v_cvt_pk_bf16_f32 v112, v96, v97
    v_cvt_pk_bf16_f32 v111, v94, v95
    v_cvt_pk_bf16_f32 v110, v92, v93
    v_cvt_pk_bf16_f32 v109, v90, v91
    v_cvt_pk_bf16_f32 v108, v88, v89
    v_cvt_pk_bf16_f32 v107, v86, v87
    v_cvt_pk_bf16_f32 v106, v84, v85
    v_cvt_pk_bf16_f32 v105, v82, v83
    v_cvt_pk_bf16_f32 v104, v80, v81
    v_cvt_pk_bf16_f32 v103, v78, v79
    v_cvt_pk_bf16_f32 v102, v76, v77
    v_cvt_pk_bf16_f32 v101, v74, v75
    v_cvt_pk_bf16_f32 v100, v72, v73
    v_cvt_pk_bf16_f32 v99, v70, v71
    v_cvt_pk_bf16_f32 v98, v68, v69
    v_cvt_pk_bf16_f32 v97, v66, v67
    v_cvt_pk_bf16_f32 v96, v64, v65
    v_cvt_pk_bf16_f32 v95, v62, v63
    v_cvt_pk_bf16_f32 v94, v60, v61
    v_cvt_pk_bf16_f32 v93, v58, v59
    v_cvt_pk_bf16_f32 v92, v56, v57
    v_cvt_pk_bf16_f32 v91, v54, v55
    v_cvt_pk_bf16_f32 v90, v52, v53
    v_cvt_pk_bf16_f32 v89, v50, v51
    v_cvt_pk_bf16_f32 v88, v48, v49
    v_cvt_pk_bf16_f32 v87, v46, v47
    v_cvt_pk_bf16_f32 v86, v44, v45
    v_cvt_pk_bf16_f32 v85, v42, v43
    v_cvt_pk_bf16_f32 v84, v40, v41
    v_cvt_pk_bf16_f32 v83, v38, v39
    v_cvt_pk_bf16_f32 v82, v36, v37
    v_cvt_pk_bf16_f32 v81, v34, v35
    v_cvt_pk_bf16_f32 v80, v32, v33
    v_cvt_pk_bf16_f32 v79, v30, v31
    v_cvt_pk_bf16_f32 v78, v28, v29
    v_cvt_pk_bf16_f32 v77, v26, v27
    v_cvt_pk_bf16_f32 v76, v24, v25
    v_cvt_pk_bf16_f32 v75, v22, v23
    v_cvt_pk_bf16_f32 v74, v20, v21
    v_cvt_pk_bf16_f32 v73, v18, v19
    v_cvt_pk_bf16_f32 v72, v16, v17
    v_cvt_pk_bf16_f32 v71, v14, v15
    v_cvt_pk_bf16_f32 v70, v12, v13
    v_cvt_pk_bf16_f32 v69, v10, v11
    v_cvt_pk_bf16_f32 v68, v8, v9
    v_cvt_pk_bf16_f32 v67, v6, v7
    v_cvt_pk_bf16_f32 v66, v4, v5
    v_cvt_pk_bf16_f32 v65, v2, v3
    v_cvt_pk_bf16_f32 v64, v0, v1
    s_mul_i32 s25, s23, 4
    s_add_u32 s25, s25, 0
    s_lshr_b32 s26, s20, 5
    s_add_u32 s25, s25, s26
    s_lshl_b32 s26, s24, 1
    s_add_u32 s26, s26, 0
    s_lshr_b32 s27, s21, 5
    s_add_u32 s26, s26, s27
    s_lshr_b32 s27, s26, 2
    s_lshl_b32 s27, s27, 6
    s_add_u32 s27, s27, s25
    s_lshl_b32 s27, s27, 13
    s_and_b32 s26, s26, 3
    s_lshl_b32 s26, s26, 11
    s_add_u32 s80, s27, s26
    s_mul_i32 s25, s23, 4
    s_add_u32 s25, s25, 0
    s_lshr_b32 s26, s20, 5
    s_add_u32 s25, s25, s26
    s_lshl_b32 s26, s24, 1
    s_add_u32 s26, s26, 1
    s_lshr_b32 s27, s21, 5
    s_add_u32 s26, s26, s27
    s_lshr_b32 s27, s26, 2
    s_lshl_b32 s27, s27, 6
    s_add_u32 s27, s27, s25
    s_lshl_b32 s27, s27, 13
    s_and_b32 s26, s26, 3
    s_lshl_b32 s26, s26, 11
    s_add_u32 s81, s27, s26
    s_mul_i32 s25, s23, 4
    s_add_u32 s25, s25, 1
    s_lshr_b32 s26, s20, 5
    s_add_u32 s25, s25, s26
    s_lshl_b32 s26, s24, 1
    s_add_u32 s26, s26, 0
    s_lshr_b32 s27, s21, 5
    s_add_u32 s26, s26, s27
    s_lshr_b32 s27, s26, 2
    s_lshl_b32 s27, s27, 6
    s_add_u32 s27, s27, s25
    s_lshl_b32 s27, s27, 13
    s_and_b32 s26, s26, 3
    s_lshl_b32 s26, s26, 11
    s_add_u32 s82, s27, s26
    s_mul_i32 s25, s23, 4
    s_add_u32 s25, s25, 1
    s_lshr_b32 s26, s20, 5
    s_add_u32 s25, s25, s26
    s_lshl_b32 s26, s24, 1
    s_add_u32 s26, s26, 1
    s_lshr_b32 s27, s21, 5
    s_add_u32 s26, s26, s27
    s_lshr_b32 s27, s26, 2
    s_lshl_b32 s27, s27, 6
    s_add_u32 s27, s27, s25
    s_lshl_b32 s27, s27, 13
    s_and_b32 s26, s26, 3
    s_lshl_b32 s26, s26, 11
    s_add_u32 s83, s27, s26
    s_mul_i32 s25, s23, 4
    s_add_u32 s25, s25, 2
    s_lshr_b32 s26, s20, 5
    s_add_u32 s25, s25, s26
    s_lshl_b32 s26, s24, 1
    s_add_u32 s26, s26, 0
    s_lshr_b32 s27, s21, 5
    s_add_u32 s26, s26, s27
    s_lshr_b32 s27, s26, 2
    s_lshl_b32 s27, s27, 6
    s_add_u32 s27, s27, s25
    s_lshl_b32 s27, s27, 13
    s_and_b32 s26, s26, 3
    s_lshl_b32 s26, s26, 11
    s_add_u32 s84, s27, s26
    s_mul_i32 s25, s23, 4
    s_add_u32 s25, s25, 2
    s_lshr_b32 s26, s20, 5
    s_add_u32 s25, s25, s26
    s_lshl_b32 s26, s24, 1
    s_add_u32 s26, s26, 1
    s_lshr_b32 s27, s21, 5
    s_add_u32 s26, s26, s27
    s_lshr_b32 s27, s26, 2
    s_lshl_b32 s27, s27, 6
    s_add_u32 s27, s27, s25
    s_lshl_b32 s27, s27, 13
    s_and_b32 s26, s26, 3
    s_lshl_b32 s26, s26, 11
    s_add_u32 s85, s27, s26
    s_mul_i32 s25, s23, 4
    s_add_u32 s25, s25, 3
    s_lshr_b32 s26, s20, 5
    s_add_u32 s25, s25, s26
    s_lshl_b32 s26, s24, 1
    s_add_u32 s26, s26, 0
    s_lshr_b32 s27, s21, 5
    s_add_u32 s26, s26, s27
    s_lshr_b32 s27, s26, 2
    s_lshl_b32 s27, s27, 6
    s_add_u32 s27, s27, s25
    s_lshl_b32 s27, s27, 13
    s_and_b32 s26, s26, 3
    s_lshl_b32 s26, s26, 11
    s_add_u32 s86, s27, s26
    s_mul_i32 s25, s23, 4
    s_add_u32 s25, s25, 3
    s_lshr_b32 s26, s20, 5
    s_add_u32 s25, s25, s26
    s_lshl_b32 s26, s24, 1
    s_add_u32 s26, s26, 1
    s_lshr_b32 s27, s21, 5
    s_add_u32 s26, s26, s27
    s_lshr_b32 s27, s26, 2
    s_lshl_b32 s27, s27, 6
    s_add_u32 s27, s27, s25
    s_lshl_b32 s27, s27, 13
    s_and_b32 s26, s26, 3
    s_lshl_b32 s26, s26, 11
    s_add_u32 s87, s27, s26
    v_mbcnt_lo_u32_b32 v192, -1, 0
    v_mbcnt_hi_u32_b32 v192, -1, v192
    v_and_b32 v193, 31, v192
    v_bfe_u32 v194, v192, 5, 1
    v_lshlrev_b32 v176, 4, v192
    s_branch Lproj_qmain
Lproj_v:
    s_mov_b32 s12, s44
    s_mov_b32 s13, s45
    s_mov_b32 s14, 4194304
    s_mov_b32 s15, 0x00020000
    s_add_u32 s16, s46, 33554432
    s_addc_u32 s17, s47, 0
    s_mov_b32 s18, 16777216
    s_mov_b32 s19, 0x00020000
    s_sub_u32 s21, s7, 16
    s_lshl_b32 s21, s21, 8
    v_mbcnt_lo_u32_b32 v192, -1, 0
    v_mbcnt_hi_u32_b32 v192, -1, v192
    v_and_b32 v193, 31, v192
    v_bfe_u32 v194, v192, 5, 1
    s_and_b32 s23, s22, 1
    s_lshr_b32 s24, s22, 1
    s_mul_i32 s25, s23, 8192
    v_lshlrev_b32 v195, 6, v193
    v_add_u32 v195, s25, v195
    v_bfe_u32 v196, v192, 2, 2
    v_or_b32 v197, 0, v194
    v_xor_b32 v197, v197, v196
    v_lshl_add_u32 v180, v197, 4, v195
    v_or_b32 v197, 2, v194
    v_xor_b32 v197, v197, v196
    v_lshl_add_u32 v181, v197, 4, v195
    v_bfe_u32 v197, v192, 2, 2
    v_and_b32 v198, 3, v192
    v_bfe_u32 v199, v192, 4, 1
    v_lshl_add_u32 v200, v194, 3, v197
    v_mul_u32_u24 v200, 512, v200
    v_add_u32 v200, 16384, v200
    v_and_b32 v201, 1, v198
    v_lshl_add_u32 v200, v201, 3, v200
    v_lshrrev_b32 v201, 1, v198
    v_lshl_add_u32 v201, v199, 1, v201
    s_lshl_b32 s25, s24, 1
    s_add_u32 s25, s25, 0
    s_lshl_b32 s25, s25, 2
    v_add_u32 v202, s25, v201
    v_lshlrev_b32 v203, 2, v197
    v_xor_b32 v202, v202, v203
    v_lshl_add_u32 v182, v202, 4, v200
    s_lshl_b32 s25, s24, 1
    s_add_u32 s25, s25, 1
    s_lshl_b32 s25, s25, 2
    v_add_u32 v202, s25, v201
    v_lshlrev_b32 v203, 2, v197
    v_xor_b32 v202, v202, v203
    v_lshl_add_u32 v183, v202, 4, v200
    v_lshrrev_b32 v197, 2, v192
    v_and_b32 v198, 3, v192
    v_bfe_u32 v200, v192, 4, 2
    v_xor_b32 v200, v200, v198
    s_lshl_b32 s25, s22, 5
    s_add_u32 s25, s25, s20
    s_mov_b32 s26, 1024
    v_add_u32 v199, 0, v197
    v_add_u32 v199, s25, v199
    v_mul_lo_u32 v199, v199, s26
    v_lshl_add_u32 v188, v200, 4, v199
    v_add_u32 v199, 16, v197
    v_add_u32 v199, s25, v199
    v_mul_lo_u32 v199, v199, s26
    v_lshl_add_u32 v189, v200, 4, v199
    s_lshl_b32 s25, s21, 1
    v_lshrrev_b32 v197, 5, v192
    v_and_b32 v198, 31, v192
    v_add_u32 v199, 0, v197
    v_lshlrev_b32 v200, 2, v199
    v_xor_b32 v200, v200, v198
    s_lshl_b32 s26, s22, 2
    v_add_u32 v199, s26, v199
    v_lshlrev_b32 v199, 13, v199
    v_lshl_add_u32 v199, v200, 4, v199
    v_add_u32 v190, s25, v199
    v_add_u32 v199, 2, v197
    v_lshlrev_b32 v200, 2, v199
    v_xor_b32 v200, v200, v198
    s_lshl_b32 s26, s22, 2
    v_add_u32 v199, s26, v199
    v_lshlrev_b32 v199, 13, v199
    v_lshl_add_u32 v199, v200, 4, v199
    v_add_u32 v191, s25, v199
    s_lshl_b32 s28, s22, 11
    s_mul_i32 s29, s22, 2048
    s_add_u32 s29, s29, 16384
    s_mov_b32 s30, 0
    s_mov_b32 s31, 0
    s_mov_b32 s32, 0
    s_mov_b32 s33, 0
    s_add_u32 m0, s28, s32
    s_nop 0
    buffer_load_dwordx4 v188, s[8:11], s30 offen lds
    s_add_u32 m0, s28, s32
    s_add_u32 m0, m0, 1024
    s_nop 0
    buffer_load_dwordx4 v189, s[8:11], s30 offen lds
    s_add_u32 m0, s29, s32
    s_nop 0
    buffer_load_dwordx4 v190, s[12:15], s31 offen lds
    s_add_u32 m0, s29, s32
    s_add_u32 m0, m0, 1024
    s_nop 0
    buffer_load_dwordx4 v191, s[12:15], s31 offen lds
    s_add_u32 s30, s30, 64
    s_add_u32 s31, s31, 0x40000
    s_add_u32 s32, s32, 32768
    s_cmp_eq_u32 s32, 163840
    s_cselect_b32 s32, 0, s32
    s_add_u32 m0, s28, s32
    s_nop 0
    buffer_load_dwordx4 v188, s[8:11], s30 offen lds
    s_add_u32 m0, s28, s32
    s_add_u32 m0, m0, 1024
    s_nop 0
    buffer_load_dwordx4 v189, s[8:11], s30 offen lds
    s_add_u32 m0, s29, s32
    s_nop 0
    buffer_load_dwordx4 v190, s[12:15], s31 offen lds
    s_add_u32 m0, s29, s32
    s_add_u32 m0, m0, 1024
    s_nop 0
    buffer_load_dwordx4 v191, s[12:15], s31 offen lds
    s_add_u32 s30, s30, 64
    s_add_u32 s31, s31, 0x40000
    s_add_u32 s32, s32, 32768
    s_cmp_eq_u32 s32, 163840
    s_cselect_b32 s32, 0, s32
    s_add_u32 m0, s28, s32
    s_nop 0
    buffer_load_dwordx4 v188, s[8:11], s30 offen lds
    s_add_u32 m0, s28, s32
    s_add_u32 m0, m0, 1024
    s_nop 0
    buffer_load_dwordx4 v189, s[8:11], s30 offen lds
    s_add_u32 m0, s29, s32
    s_nop 0
    buffer_load_dwordx4 v190, s[12:15], s31 offen lds
    s_add_u32 m0, s29, s32
    s_add_u32 m0, m0, 1024
    s_nop 0
    buffer_load_dwordx4 v191, s[12:15], s31 offen lds
    s_add_u32 s30, s30, 64
    s_add_u32 s31, s31, 0x40000
    s_add_u32 s32, s32, 32768
    s_cmp_eq_u32 s32, 163840
    s_cselect_b32 s32, 0, s32
    s_add_u32 m0, s28, s32
    s_nop 0
    buffer_load_dwordx4 v188, s[8:11], s30 offen lds
    s_add_u32 m0, s28, s32
    s_add_u32 m0, m0, 1024
    s_nop 0
    buffer_load_dwordx4 v189, s[8:11], s30 offen lds
    s_add_u32 m0, s29, s32
    s_nop 0
    buffer_load_dwordx4 v190, s[12:15], s31 offen lds
    s_add_u32 m0, s29, s32
    s_add_u32 m0, m0, 1024
    s_nop 0
    buffer_load_dwordx4 v191, s[12:15], s31 offen lds
    s_add_u32 s30, s30, 64
    s_add_u32 s31, s31, 0x40000
    s_add_u32 s32, s32, 32768
    s_cmp_eq_u32 s32, 163840
    s_cselect_b32 s32, 0, s32
    s_waitcnt vmcnt(12)
    s_barrier
    v_add_u32 v184, s33, v180
    v_add_u32 v185, s33, v181
    v_add_u32 v186, s33, v182
    v_add_u32 v187, s33, v183
    s_add_u32 s33, s33, 32768
    s_cmp_eq_u32 s33, 163840
    s_cselect_b32 s33, 0, s33
    ds_read_b128 v[128:131], v184 offset:0
    ds_read_b128 v[132:135], v184 offset:2048
    ds_read_b128 v[136:139], v184 offset:4096
    ds_read_b128 v[140:143], v184 offset:6144
    ds_read_b64_tr_b16 v[144:145], v186 offset:0
    ds_read_b64_tr_b16 v[146:147], v186 offset:2048
    ds_read_b64_tr_b16 v[148:149], v187 offset:0
    ds_read_b64_tr_b16 v[150:151], v187 offset:2048
    ds_read_b128 v[152:155], v185 offset:0
    ds_read_b128 v[156:159], v185 offset:2048
    ds_read_b128 v[160:163], v185 offset:4096
    ds_read_b128 v[164:167], v185 offset:6144
    ds_read_b64_tr_b16 v[168:169], v186 offset:8192
    ds_read_b64_tr_b16 v[170:171], v186 offset:10240
    ds_read_b64_tr_b16 v[172:173], v187 offset:8192
    ds_read_b64_tr_b16 v[174:175], v187 offset:10240
    s_waitcnt lgkmcnt(8)
    v_mfma_f32_32x32x16_bf16 v[0:15], v[128:131], v[144:147], 0
    v_mfma_f32_32x32x16_bf16 v[16:31], v[128:131], v[148:151], 0
    v_mfma_f32_32x32x16_bf16 v[32:47], v[132:135], v[144:147], 0
    v_mfma_f32_32x32x16_bf16 v[48:63], v[132:135], v[148:151], 0
    v_mfma_f32_32x32x16_bf16 v[64:79], v[136:139], v[144:147], 0
    v_mfma_f32_32x32x16_bf16 v[80:95], v[136:139], v[148:151], 0
    v_mfma_f32_32x32x16_bf16 v[96:111], v[140:143], v[144:147], 0
    v_mfma_f32_32x32x16_bf16 v[112:127], v[140:143], v[148:151], 0
    s_waitcnt vmcnt(8) lgkmcnt(0)
    s_barrier
    v_add_u32 v184, s33, v180
    v_add_u32 v185, s33, v181
    v_add_u32 v186, s33, v182
    v_add_u32 v187, s33, v183
    s_add_u32 s33, s33, 32768
    s_cmp_eq_u32 s33, 163840
    s_cselect_b32 s33, 0, s33
    v_mfma_f32_32x32x16_bf16 v[0:15], v[152:155], v[168:171], v[0:15]
    ds_read_b128 v[128:131], v184 offset:0
    ds_read_b128 v[132:135], v184 offset:2048
    v_mfma_f32_32x32x16_bf16 v[16:31], v[152:155], v[172:175], v[16:31]
    ds_read_b128 v[136:139], v184 offset:4096
    ds_read_b128 v[140:143], v184 offset:6144
    ds_read_b64_tr_b16 v[144:145], v186 offset:0
    v_mfma_f32_32x32x16_bf16 v[32:47], v[156:159], v[168:171], v[32:47]
    ds_read_b64_tr_b16 v[146:147], v186 offset:2048
    ds_read_b64_tr_b16 v[148:149], v187 offset:0
    ds_read_b64_tr_b16 v[150:151], v187 offset:2048
    v_mfma_f32_32x32x16_bf16 v[48:63], v[156:159], v[172:175], v[48:63]
    s_add_u32 m0, s28, s32
    s_nop 0
    buffer_load_dwordx4 v188, s[8:11], s30 offen lds
    s_add_u32 m0, s28, s32
    v_mfma_f32_32x32x16_bf16 v[64:79], v[160:163], v[168:171], v[64:79]
    s_add_u32 m0, m0, 1024
    s_nop 0
    buffer_load_dwordx4 v189, s[8:11], s30 offen lds
    s_add_u32 m0, s29, s32
    v_mfma_f32_32x32x16_bf16 v[80:95], v[160:163], v[172:175], v[80:95]
    buffer_load_dwordx4 v190, s[12:15], s31 offen lds
    s_add_u32 m0, s29, s32
    s_add_u32 m0, m0, 1024
    v_mfma_f32_32x32x16_bf16 v[96:111], v[164:167], v[168:171], v[96:111]
    buffer_load_dwordx4 v191, s[12:15], s31 offen lds
    s_add_u32 s30, s30, 64
    s_add_u32 s31, s31, 0x40000
    v_mfma_f32_32x32x16_bf16 v[112:127], v[164:167], v[172:175], v[112:127]
    s_add_u32 s32, s32, 32768
    s_cmp_eq_u32 s32, 163840
    s_cselect_b32 s32, 0, s32
    s_mov_b32 s27, 11
Lv_loop:
    ds_read_b128 v[152:155], v185 offset:0
    ds_read_b128 v[156:159], v185 offset:2048
    ds_read_b128 v[160:163], v185 offset:4096
    ds_read_b128 v[164:167], v185 offset:6144
    ds_read_b64_tr_b16 v[168:169], v186 offset:8192
    ds_read_b64_tr_b16 v[170:171], v186 offset:10240
    ds_read_b64_tr_b16 v[172:173], v187 offset:8192
    ds_read_b64_tr_b16 v[174:175], v187 offset:10240
    s_waitcnt lgkmcnt(8)
    v_mfma_f32_32x32x16_bf16 v[0:15], v[128:131], v[144:147], v[0:15]
    v_mfma_f32_32x32x16_bf16 v[16:31], v[128:131], v[148:151], v[16:31]
    v_mfma_f32_32x32x16_bf16 v[32:47], v[132:135], v[144:147], v[32:47]
    v_mfma_f32_32x32x16_bf16 v[48:63], v[132:135], v[148:151], v[48:63]
    v_mfma_f32_32x32x16_bf16 v[64:79], v[136:139], v[144:147], v[64:79]
    v_mfma_f32_32x32x16_bf16 v[80:95], v[136:139], v[148:151], v[80:95]
    v_mfma_f32_32x32x16_bf16 v[96:111], v[140:143], v[144:147], v[96:111]
    v_mfma_f32_32x32x16_bf16 v[112:127], v[140:143], v[148:151], v[112:127]
    s_waitcnt vmcnt(8) lgkmcnt(0)
    s_barrier
    v_add_u32 v184, s33, v180
    v_add_u32 v185, s33, v181
    v_add_u32 v186, s33, v182
    v_add_u32 v187, s33, v183
    s_add_u32 s33, s33, 32768
    s_cmp_eq_u32 s33, 163840
    s_cselect_b32 s33, 0, s33
    v_mfma_f32_32x32x16_bf16 v[0:15], v[152:155], v[168:171], v[0:15]
    ds_read_b128 v[128:131], v184 offset:0
    ds_read_b128 v[132:135], v184 offset:2048
    v_mfma_f32_32x32x16_bf16 v[16:31], v[152:155], v[172:175], v[16:31]
    ds_read_b128 v[136:139], v184 offset:4096
    ds_read_b128 v[140:143], v184 offset:6144
    ds_read_b64_tr_b16 v[144:145], v186 offset:0
    v_mfma_f32_32x32x16_bf16 v[32:47], v[156:159], v[168:171], v[32:47]
    ds_read_b64_tr_b16 v[146:147], v186 offset:2048
    ds_read_b64_tr_b16 v[148:149], v187 offset:0
    ds_read_b64_tr_b16 v[150:151], v187 offset:2048
    v_mfma_f32_32x32x16_bf16 v[48:63], v[156:159], v[172:175], v[48:63]
    s_add_u32 m0, s28, s32
    s_nop 0
    buffer_load_dwordx4 v188, s[8:11], s30 offen lds
    s_add_u32 m0, s28, s32
    v_mfma_f32_32x32x16_bf16 v[64:79], v[160:163], v[168:171], v[64:79]
    s_add_u32 m0, m0, 1024
    s_nop 0
    buffer_load_dwordx4 v189, s[8:11], s30 offen lds
    s_add_u32 m0, s29, s32
    v_mfma_f32_32x32x16_bf16 v[80:95], v[160:163], v[172:175], v[80:95]
    buffer_load_dwordx4 v190, s[12:15], s31 offen lds
    s_add_u32 m0, s29, s32
    s_add_u32 m0, m0, 1024
    v_mfma_f32_32x32x16_bf16 v[96:111], v[164:167], v[168:171], v[96:111]
    buffer_load_dwordx4 v191, s[12:15], s31 offen lds
    s_add_u32 s30, s30, 64
    s_add_u32 s31, s31, 0x40000
    v_mfma_f32_32x32x16_bf16 v[112:127], v[164:167], v[172:175], v[112:127]
    s_add_u32 s32, s32, 32768
    s_cmp_eq_u32 s32, 163840
    s_cselect_b32 s32, 0, s32
    s_sub_u32 s27, s27, 1
    s_cmp_lg_u32 s27, 0
    s_cbranch_scc1 Lv_loop
    ds_read_b128 v[152:155], v185 offset:0
    ds_read_b128 v[156:159], v185 offset:2048
    ds_read_b128 v[160:163], v185 offset:4096
    ds_read_b128 v[164:167], v185 offset:6144
    ds_read_b64_tr_b16 v[168:169], v186 offset:8192
    ds_read_b64_tr_b16 v[170:171], v186 offset:10240
    ds_read_b64_tr_b16 v[172:173], v187 offset:8192
    ds_read_b64_tr_b16 v[174:175], v187 offset:10240
    s_waitcnt lgkmcnt(8)
    v_mfma_f32_32x32x16_bf16 v[0:15], v[128:131], v[144:147], v[0:15]
    v_mfma_f32_32x32x16_bf16 v[16:31], v[128:131], v[148:151], v[16:31]
    v_mfma_f32_32x32x16_bf16 v[32:47], v[132:135], v[144:147], v[32:47]
    v_mfma_f32_32x32x16_bf16 v[48:63], v[132:135], v[148:151], v[48:63]
    v_mfma_f32_32x32x16_bf16 v[64:79], v[136:139], v[144:147], v[64:79]
    v_mfma_f32_32x32x16_bf16 v[80:95], v[136:139], v[148:151], v[80:95]
    v_mfma_f32_32x32x16_bf16 v[96:111], v[140:143], v[144:147], v[96:111]
    v_mfma_f32_32x32x16_bf16 v[112:127], v[140:143], v[148:151], v[112:127]
    s_waitcnt vmcnt(8) lgkmcnt(0)
    s_barrier
    v_add_u32 v184, s33, v180
    v_add_u32 v185, s33, v181
    v_add_u32 v186, s33, v182
    v_add_u32 v187, s33, v183
    s_add_u32 s33, s33, 32768
    s_cmp_eq_u32 s33, 163840
    s_cselect_b32 s33, 0, s33
    v_mfma_f32_32x32x16_bf16 v[0:15], v[152:155], v[168:171], v[0:15]
    ds_read_b128 v[128:131], v184 offset:0
    v_mfma_f32_32x32x16_bf16 v[16:31], v[152:155], v[172:175], v[16:31]
    ds_read_b128 v[132:135], v184 offset:2048
    v_mfma_f32_32x32x16_bf16 v[32:47], v[156:159], v[168:171], v[32:47]
    ds_read_b128 v[136:139], v184 offset:4096
    v_mfma_f32_32x32x16_bf16 v[48:63], v[156:159], v[172:175], v[48:63]
    ds_read_b128 v[140:143], v184 offset:6144
    v_mfma_f32_32x32x16_bf16 v[64:79], v[160:163], v[168:171], v[64:79]
    ds_read_b64_tr_b16 v[144:145], v186 offset:0
    v_mfma_f32_32x32x16_bf16 v[80:95], v[160:163], v[172:175], v[80:95]
    ds_read_b64_tr_b16 v[146:147], v186 offset:2048
    v_mfma_f32_32x32x16_bf16 v[96:111], v[164:167], v[168:171], v[96:111]
    ds_read_b64_tr_b16 v[148:149], v187 offset:0
    v_mfma_f32_32x32x16_bf16 v[112:127], v[164:167], v[172:175], v[112:127]
    ds_read_b64_tr_b16 v[150:151], v187 offset:2048
    ds_read_b128 v[152:155], v185 offset:0
    ds_read_b128 v[156:159], v185 offset:2048
    ds_read_b128 v[160:163], v185 offset:4096
    ds_read_b128 v[164:167], v185 offset:6144
    ds_read_b64_tr_b16 v[168:169], v186 offset:8192
    ds_read_b64_tr_b16 v[170:171], v186 offset:10240
    ds_read_b64_tr_b16 v[172:173], v187 offset:8192
    ds_read_b64_tr_b16 v[174:175], v187 offset:10240
    s_waitcnt lgkmcnt(8)
    v_mfma_f32_32x32x16_bf16 v[0:15], v[128:131], v[144:147], v[0:15]
    v_mfma_f32_32x32x16_bf16 v[16:31], v[128:131], v[148:151], v[16:31]
    v_mfma_f32_32x32x16_bf16 v[32:47], v[132:135], v[144:147], v[32:47]
    v_mfma_f32_32x32x16_bf16 v[48:63], v[132:135], v[148:151], v[48:63]
    v_mfma_f32_32x32x16_bf16 v[64:79], v[136:139], v[144:147], v[64:79]
    v_mfma_f32_32x32x16_bf16 v[80:95], v[136:139], v[148:151], v[80:95]
    v_mfma_f32_32x32x16_bf16 v[96:111], v[140:143], v[144:147], v[96:111]
    v_mfma_f32_32x32x16_bf16 v[112:127], v[140:143], v[148:151], v[112:127]
    s_waitcnt vmcnt(4) lgkmcnt(0)
    s_barrier
    v_add_u32 v184, s33, v180
    v_add_u32 v185, s33, v181
    v_add_u32 v186, s33, v182
    v_add_u32 v187, s33, v183
    s_add_u32 s33, s33, 32768
    s_cmp_eq_u32 s33, 163840
    s_cselect_b32 s33, 0, s33
    v_mfma_f32_32x32x16_bf16 v[0:15], v[152:155], v[168:171], v[0:15]
    ds_read_b128 v[128:131], v184 offset:0
    v_mfma_f32_32x32x16_bf16 v[16:31], v[152:155], v[172:175], v[16:31]
    ds_read_b128 v[132:135], v184 offset:2048
    v_mfma_f32_32x32x16_bf16 v[32:47], v[156:159], v[168:171], v[32:47]
    ds_read_b128 v[136:139], v184 offset:4096
    v_mfma_f32_32x32x16_bf16 v[48:63], v[156:159], v[172:175], v[48:63]
    ds_read_b128 v[140:143], v184 offset:6144
    v_mfma_f32_32x32x16_bf16 v[64:79], v[160:163], v[168:171], v[64:79]
    ds_read_b64_tr_b16 v[144:145], v186 offset:0
    v_mfma_f32_32x32x16_bf16 v[80:95], v[160:163], v[172:175], v[80:95]
    ds_read_b64_tr_b16 v[146:147], v186 offset:2048
    v_mfma_f32_32x32x16_bf16 v[96:111], v[164:167], v[168:171], v[96:111]
    ds_read_b64_tr_b16 v[148:149], v187 offset:0
    v_mfma_f32_32x32x16_bf16 v[112:127], v[164:167], v[172:175], v[112:127]
    ds_read_b64_tr_b16 v[150:151], v187 offset:2048
    ds_read_b128 v[152:155], v185 offset:0
    ds_read_b128 v[156:159], v185 offset:2048
    ds_read_b128 v[160:163], v185 offset:4096
    ds_read_b128 v[164:167], v185 offset:6144
    ds_read_b64_tr_b16 v[168:169], v186 offset:8192
    ds_read_b64_tr_b16 v[170:171], v186 offset:10240
    ds_read_b64_tr_b16 v[172:173], v187 offset:8192
    ds_read_b64_tr_b16 v[174:175], v187 offset:10240
    s_waitcnt lgkmcnt(8)
    v_mfma_f32_32x32x16_bf16 v[0:15], v[128:131], v[144:147], v[0:15]
    v_mfma_f32_32x32x16_bf16 v[16:31], v[128:131], v[148:151], v[16:31]
    v_mfma_f32_32x32x16_bf16 v[32:47], v[132:135], v[144:147], v[32:47]
    v_mfma_f32_32x32x16_bf16 v[48:63], v[132:135], v[148:151], v[48:63]
    v_mfma_f32_32x32x16_bf16 v[64:79], v[136:139], v[144:147], v[64:79]
    v_mfma_f32_32x32x16_bf16 v[80:95], v[136:139], v[148:151], v[80:95]
    v_mfma_f32_32x32x16_bf16 v[96:111], v[140:143], v[144:147], v[96:111]
    v_mfma_f32_32x32x16_bf16 v[112:127], v[140:143], v[148:151], v[112:127]
    s_waitcnt vmcnt(0) lgkmcnt(0)
    s_barrier
    v_add_u32 v184, s33, v180
    v_add_u32 v185, s33, v181
    v_add_u32 v186, s33, v182
    v_add_u32 v187, s33, v183
    s_add_u32 s33, s33, 32768
    s_cmp_eq_u32 s33, 163840
    s_cselect_b32 s33, 0, s33
    v_mfma_f32_32x32x16_bf16 v[0:15], v[152:155], v[168:171], v[0:15]
    ds_read_b128 v[128:131], v184 offset:0
    v_mfma_f32_32x32x16_bf16 v[16:31], v[152:155], v[172:175], v[16:31]
    ds_read_b128 v[132:135], v184 offset:2048
    v_mfma_f32_32x32x16_bf16 v[32:47], v[156:159], v[168:171], v[32:47]
    ds_read_b128 v[136:139], v184 offset:4096
    v_mfma_f32_32x32x16_bf16 v[48:63], v[156:159], v[172:175], v[48:63]
    ds_read_b128 v[140:143], v184 offset:6144
    v_mfma_f32_32x32x16_bf16 v[64:79], v[160:163], v[168:171], v[64:79]
    ds_read_b64_tr_b16 v[144:145], v186 offset:0
    v_mfma_f32_32x32x16_bf16 v[80:95], v[160:163], v[172:175], v[80:95]
    ds_read_b64_tr_b16 v[146:147], v186 offset:2048
    v_mfma_f32_32x32x16_bf16 v[96:111], v[164:167], v[168:171], v[96:111]
    ds_read_b64_tr_b16 v[148:149], v187 offset:0
    v_mfma_f32_32x32x16_bf16 v[112:127], v[164:167], v[172:175], v[112:127]
    ds_read_b64_tr_b16 v[150:151], v187 offset:2048
    ds_read_b128 v[152:155], v185 offset:0
    ds_read_b128 v[156:159], v185 offset:2048
    ds_read_b128 v[160:163], v185 offset:4096
    ds_read_b128 v[164:167], v185 offset:6144
    ds_read_b64_tr_b16 v[168:169], v186 offset:8192
    ds_read_b64_tr_b16 v[170:171], v186 offset:10240
    ds_read_b64_tr_b16 v[172:173], v187 offset:8192
    ds_read_b64_tr_b16 v[174:175], v187 offset:10240
    s_waitcnt lgkmcnt(8)
    v_mfma_f32_32x32x16_bf16 v[0:15], v[128:131], v[144:147], v[0:15]
    v_mfma_f32_32x32x16_bf16 v[16:31], v[128:131], v[148:151], v[16:31]
    v_mfma_f32_32x32x16_bf16 v[32:47], v[132:135], v[144:147], v[32:47]
    v_mfma_f32_32x32x16_bf16 v[48:63], v[132:135], v[148:151], v[48:63]
    v_mfma_f32_32x32x16_bf16 v[64:79], v[136:139], v[144:147], v[64:79]
    v_mfma_f32_32x32x16_bf16 v[80:95], v[136:139], v[148:151], v[80:95]
    v_mfma_f32_32x32x16_bf16 v[96:111], v[140:143], v[144:147], v[96:111]
    v_mfma_f32_32x32x16_bf16 v[112:127], v[140:143], v[148:151], v[112:127]
    s_waitcnt lgkmcnt(0)
    v_mfma_f32_32x32x16_bf16 v[0:15], v[152:155], v[168:171], v[0:15]
    v_mfma_f32_32x32x16_bf16 v[16:31], v[152:155], v[172:175], v[16:31]
    v_mfma_f32_32x32x16_bf16 v[32:47], v[156:159], v[168:171], v[32:47]
    v_mfma_f32_32x32x16_bf16 v[48:63], v[156:159], v[172:175], v[48:63]
    v_mfma_f32_32x32x16_bf16 v[64:79], v[160:163], v[168:171], v[64:79]
    v_mfma_f32_32x32x16_bf16 v[80:95], v[160:163], v[172:175], v[80:95]
    v_mfma_f32_32x32x16_bf16 v[96:111], v[164:167], v[168:171], v[96:111]
    v_mfma_f32_32x32x16_bf16 v[112:127], v[164:167], v[172:175], v[112:127]
    s_barrier
    s_mov_b32 s8, s36
    s_mov_b32 s9, s37
    s_mov_b32 s10, 2359296
    s_mov_b32 s11, 0x00020000
    s_mov_b32 s12, s40
    s_mov_b32 s13, s41
    s_mov_b32 s14, 4718592
    s_mov_b32 s15, 0x00020000
    v_mbcnt_lo_u32_b32 v192, -1, 0
    v_mbcnt_hi_u32_b32 v192, -1, v192
    v_and_b32 v193, 31, v192
    v_bfe_u32 v194, v192, 5, 1
    s_and_b32 s69, s22, 3
    s_lshr_b32 s70, s22, 2
    s_mul_i32 s25, s69, 4096
    v_lshlrev_b32 v195, 6, v193
    v_add_u32 v195, s25, v195
    v_bfe_u32 v196, v192, 2, 2
    v_or_b32 v197, 0, v194
    v_xor_b32 v197, v197, v196
    v_lshl_add_u32 v180, v197, 4, v195
    v_or_b32 v197, 2, v194
    v_xor_b32 v197, v197, v196
    v_lshl_add_u32 v181, v197, 4, v195
    v_bfe_u32 v197, v192, 2, 2
    v_and_b32 v198, 3, v192
    v_bfe_u32 v199, v192, 4, 1
    v_lshl_add_u32 v200, v194, 3, v197
    v_mul_u32_u24 v200, 256, v200
    v_add_u32 v200, 16384, v200
    v_and_b32 v201, 1, v198
    v_lshl_add_u32 v200, v201, 3, v200
    v_lshrrev_b32 v201, 1, v198
    v_lshl_add_u32 v201, v199, 1, v201
    s_lshl_b32 s25, s70, 1
    s_add_u32 s25, s25, 0
    s_lshl_b32 s25, s25, 2
    v_add_u32 v202, s25, v201
    v_lshlrev_b32 v203, 2, v197
    v_xor_b32 v202, v202, v203
    v_lshl_add_u32 v182, v202, 4, v200
    s_lshl_b32 s25, s70, 1
    s_add_u32 s25, s25, 1
    s_lshl_b32 s25, s25, 2
    v_add_u32 v202, s25, v201
    v_lshlrev_b32 v203, 2, v197
    v_xor_b32 v202, v202, v203
    v_lshl_add_u32 v183, v202, 4, v200
    v_lshrrev_b32 v197, 2, v192
    v_and_b32 v198, 3, v192
    v_bfe_u32 v200, v192, 4, 2
    v_xor_b32 v200, v200, v198
    s_lshl_b32 s25, s22, 5
    s_add_u32 s25, s25, s20
    s_mov_b32 s26, 1152
    v_add_u32 v199, 0, v197
    v_add_u32 v199, s25, v199
    v_mul_lo_u32 v199, v199, s26
    v_lshl_add_u32 v188, v200, 4, v199
    v_add_u32 v199, 16, v197
    v_add_u32 v199, s25, v199
    v_mul_lo_u32 v199, v199, s26
    v_lshl_add_u32 v189, v200, 4, v199
    s_lshl_b32 s25, s68, 1
    v_lshrrev_b32 v197, 4, v192
    v_and_b32 v198, 15, v192
    v_lshlrev_b32 v200, 2, v197
    v_xor_b32 v200, v200, v198
    s_lshl_b32 s26, s22, 2
    v_add_u32 v199, s26, v197
    v_lshlrev_b32 v199, 13, v199
    v_lshl_add_u32 v199, v200, 4, v199
    v_add_u32 v190, s25, v199
    s_lshl_b32 s28, s22, 11
    s_mul_i32 s29, s22, 1024
    s_add_u32 s29, s29, 16384
    s_mov_b32 s30, 0
    s_mov_b32 s31, 0
    s_mov_b32 s32, 0
    s_mov_b32 s33, 0
    s_add_u32 m0, s28, s32
    s_nop 0
    buffer_load_dwordx4 v188, s[8:11], s30 offen lds
    s_add_u32 m0, s28, s32
    s_add_u32 m0, m0, 1024
    s_nop 0
    buffer_load_dwordx4 v189, s[8:11], s30 offen lds
    s_add_u32 m0, s29, s32
    s_nop 0
    buffer_load_dwordx4 v190, s[12:15], s31 offen lds
    s_add_u32 s30, s30, 64
    s_add_u32 s31, s31, 0x40000
    s_add_u32 s32, s32, 24576
    s_cmp_eq_u32 s32, 147456
    s_cselect_b32 s32, 0, s32
    s_add_u32 m0, s28, s32
    s_nop 0
    buffer_load_dwordx4 v188, s[8:11], s30 offen lds
    s_add_u32 m0, s28, s32
    s_add_u32 m0, m0, 1024
    s_nop 0
    buffer_load_dwordx4 v189, s[8:11], s30 offen lds
    s_add_u32 m0, s29, s32
    s_nop 0
    buffer_load_dwordx4 v190, s[12:15], s31 offen lds
    s_add_u32 s30, s30, 64
    s_add_u32 s31, s31, 0x40000
    s_add_u32 s32, s32, 24576
    s_cmp_eq_u32 s32, 147456
    s_cselect_b32 s32, 0, s32
    s_add_u32 m0, s28, s32
    s_nop 0
    buffer_load_dwordx4 v188, s[8:11], s30 offen lds
    s_add_u32 m0, s28, s32
    s_add_u32 m0, m0, 1024
    s_nop 0
    buffer_load_dwordx4 v189, s[8:11], s30 offen lds
    s_add_u32 m0, s29, s32
    s_nop 0
    buffer_load_dwordx4 v190, s[12:15], s31 offen lds
    s_add_u32 s30, s30, 64
    s_add_u32 s31, s31, 0x40000
    s_add_u32 s32, s32, 24576
    s_cmp_eq_u32 s32, 147456
    s_cselect_b32 s32, 0, s32
    s_add_u32 m0, s28, s32
    s_nop 0
    buffer_load_dwordx4 v188, s[8:11], s30 offen lds
    s_add_u32 m0, s28, s32
    s_add_u32 m0, m0, 1024
    s_nop 0
    buffer_load_dwordx4 v189, s[8:11], s30 offen lds
    s_add_u32 m0, s29, s32
    s_nop 0
    buffer_load_dwordx4 v190, s[12:15], s31 offen lds
    s_add_u32 s30, s30, 64
    s_add_u32 s31, s31, 0x40000
    s_add_u32 s32, s32, 24576
    s_cmp_eq_u32 s32, 147456
    s_cselect_b32 s32, 0, s32
    s_add_u32 m0, s28, s32
    s_nop 0
    buffer_load_dwordx4 v188, s[8:11], s30 offen lds
    s_add_u32 m0, s28, s32
    s_add_u32 m0, m0, 1024
    s_nop 0
    buffer_load_dwordx4 v189, s[8:11], s30 offen lds
    s_add_u32 m0, s29, s32
    s_nop 0
    buffer_load_dwordx4 v190, s[12:15], s31 offen lds
    s_add_u32 s30, s30, 64
    s_add_u32 s31, s31, 0x40000
    s_add_u32 s32, s32, 24576
    s_cmp_eq_u32 s32, 147456
    s_cselect_b32 s32, 0, s32
    v_cvt_pk_bf16_f32 v127, v126, v127
    v_cvt_pk_bf16_f32 v126, v124, v125
    v_cvt_pk_bf16_f32 v125, v122, v123
    v_cvt_pk_bf16_f32 v124, v120, v121
    v_cvt_pk_bf16_f32 v123, v118, v119
    v_cvt_pk_bf16_f32 v122, v116, v117
    v_cvt_pk_bf16_f32 v121, v114, v115
    v_cvt_pk_bf16_f32 v120, v112, v113
    v_cvt_pk_bf16_f32 v119, v110, v111
    v_cvt_pk_bf16_f32 v118, v108, v109
    v_cvt_pk_bf16_f32 v117, v106, v107
    v_cvt_pk_bf16_f32 v116, v104, v105
    v_cvt_pk_bf16_f32 v115, v102, v103
    v_cvt_pk_bf16_f32 v114, v100, v101
    v_cvt_pk_bf16_f32 v113, v98, v99
    v_cvt_pk_bf16_f32 v112, v96, v97
    v_cvt_pk_bf16_f32 v111, v94, v95
    v_cvt_pk_bf16_f32 v110, v92, v93
    v_cvt_pk_bf16_f32 v109, v90, v91
    v_cvt_pk_bf16_f32 v108, v88, v89
    v_cvt_pk_bf16_f32 v107, v86, v87
    v_cvt_pk_bf16_f32 v106, v84, v85
    v_cvt_pk_bf16_f32 v105, v82, v83
    v_cvt_pk_bf16_f32 v104, v80, v81
    v_cvt_pk_bf16_f32 v103, v78, v79
    v_cvt_pk_bf16_f32 v102, v76, v77
    v_cvt_pk_bf16_f32 v101, v74, v75
    v_cvt_pk_bf16_f32 v100, v72, v73
    v_cvt_pk_bf16_f32 v99, v70, v71
    v_cvt_pk_bf16_f32 v98, v68, v69
    v_cvt_pk_bf16_f32 v97, v66, v67
    v_cvt_pk_bf16_f32 v96, v64, v65
    v_cvt_pk_bf16_f32 v95, v62, v63
    v_cvt_pk_bf16_f32 v94, v60, v61
    v_cvt_pk_bf16_f32 v93, v58, v59
    v_cvt_pk_bf16_f32 v92, v56, v57
    v_cvt_pk_bf16_f32 v91, v54, v55
    v_cvt_pk_bf16_f32 v90, v52, v53
    v_cvt_pk_bf16_f32 v89, v50, v51
    v_cvt_pk_bf16_f32 v88, v48, v49
    v_cvt_pk_bf16_f32 v87, v46, v47
    v_cvt_pk_bf16_f32 v86, v44, v45
    v_cvt_pk_bf16_f32 v85, v42, v43
    v_cvt_pk_bf16_f32 v84, v40, v41
    v_cvt_pk_bf16_f32 v83, v38, v39
    v_cvt_pk_bf16_f32 v82, v36, v37
    v_cvt_pk_bf16_f32 v81, v34, v35
    v_cvt_pk_bf16_f32 v80, v32, v33
    v_cvt_pk_bf16_f32 v79, v30, v31
    v_cvt_pk_bf16_f32 v78, v28, v29
    v_cvt_pk_bf16_f32 v77, v26, v27
    v_cvt_pk_bf16_f32 v76, v24, v25
    v_cvt_pk_bf16_f32 v75, v22, v23
    v_cvt_pk_bf16_f32 v74, v20, v21
    v_cvt_pk_bf16_f32 v73, v18, v19
    v_cvt_pk_bf16_f32 v72, v16, v17
    v_cvt_pk_bf16_f32 v71, v14, v15
    v_cvt_pk_bf16_f32 v70, v12, v13
    v_cvt_pk_bf16_f32 v69, v10, v11
    v_cvt_pk_bf16_f32 v68, v8, v9
    v_cvt_pk_bf16_f32 v67, v6, v7
    v_cvt_pk_bf16_f32 v66, v4, v5
    v_cvt_pk_bf16_f32 v65, v2, v3
    v_cvt_pk_bf16_f32 v64, v0, v1
    s_mul_i32 s25, s23, 4
    s_add_u32 s25, s25, 0
    s_lshr_b32 s26, s20, 5
    s_add_u32 s25, s25, s26
    s_lshl_b32 s26, s24, 1
    s_add_u32 s26, s26, 0
    s_lshr_b32 s27, s21, 5
    s_add_u32 s26, s26, s27
    s_lshr_b32 s27, s26, 2
    s_lshl_b32 s27, s27, 6
    s_add_u32 s27, s27, s25
    s_lshl_b32 s27, s27, 13
    s_and_b32 s26, s26, 3
    s_lshl_b32 s26, s26, 11
    s_add_u32 s80, s27, s26
    s_mul_i32 s25, s23, 4
    s_add_u32 s25, s25, 0
    s_lshr_b32 s26, s20, 5
    s_add_u32 s25, s25, s26
    s_lshl_b32 s26, s24, 1
    s_add_u32 s26, s26, 1
    s_lshr_b32 s27, s21, 5
    s_add_u32 s26, s26, s27
    s_lshr_b32 s27, s26, 2
    s_lshl_b32 s27, s27, 6
    s_add_u32 s27, s27, s25
    s_lshl_b32 s27, s27, 13
    s_and_b32 s26, s26, 3
    s_lshl_b32 s26, s26, 11
    s_add_u32 s81, s27, s26
    s_mul_i32 s25, s23, 4
    s_add_u32 s25, s25, 1
    s_lshr_b32 s26, s20, 5
    s_add_u32 s25, s25, s26
    s_lshl_b32 s26, s24, 1
    s_add_u32 s26, s26, 0
    s_lshr_b32 s27, s21, 5
    s_add_u32 s26, s26, s27
    s_lshr_b32 s27, s26, 2
    s_lshl_b32 s27, s27, 6
    s_add_u32 s27, s27, s25
    s_lshl_b32 s27, s27, 13
    s_and_b32 s26, s26, 3
    s_lshl_b32 s26, s26, 11
    s_add_u32 s82, s27, s26
    s_mul_i32 s25, s23, 4
    s_add_u32 s25, s25, 1
    s_lshr_b32 s26, s20, 5
    s_add_u32 s25, s25, s26
    s_lshl_b32 s26, s24, 1
    s_add_u32 s26, s26, 1
    s_lshr_b32 s27, s21, 5
    s_add_u32 s26, s26, s27
    s_lshr_b32 s27, s26, 2
    s_lshl_b32 s27, s27, 6
    s_add_u32 s27, s27, s25
    s_lshl_b32 s27, s27, 13
    s_and_b32 s26, s26, 3
    s_lshl_b32 s26, s26, 11
    s_add_u32 s83, s27, s26
    s_mul_i32 s25, s23, 4
    s_add_u32 s25, s25, 2
    s_lshr_b32 s26, s20, 5
    s_add_u32 s25, s25, s26
    s_lshl_b32 s26, s24, 1
    s_add_u32 s26, s26, 0
    s_lshr_b32 s27, s21, 5
    s_add_u32 s26, s26, s27
    s_lshr_b32 s27, s26, 2
    s_lshl_b32 s27, s27, 6
    s_add_u32 s27, s27, s25
    s_lshl_b32 s27, s27, 13
    s_and_b32 s26, s26, 3
    s_lshl_b32 s26, s26, 11
    s_add_u32 s84, s27, s26
    s_mul_i32 s25, s23, 4
    s_add_u32 s25, s25, 2
    s_lshr_b32 s26, s20, 5
    s_add_u32 s25, s25, s26
    s_lshl_b32 s26, s24, 1
    s_add_u32 s26, s26, 1
    s_lshr_b32 s27, s21, 5
    s_add_u32 s26, s26, s27
    s_lshr_b32 s27, s26, 2
    s_lshl_b32 s27, s27, 6
    s_add_u32 s27, s27, s25
    s_lshl_b32 s27, s27, 13
    s_and_b32 s26, s26, 3
    s_lshl_b32 s26, s26, 11
    s_add_u32 s85, s27, s26
    s_mul_i32 s25, s23, 4
    s_add_u32 s25, s25, 3
    s_lshr_b32 s26, s20, 5
    s_add_u32 s25, s25, s26
    s_lshl_b32 s26, s24, 1
    s_add_u32 s26, s26, 0
    s_lshr_b32 s27, s21, 5
    s_add_u32 s26, s26, s27
    s_lshr_b32 s27, s26, 2
    s_lshl_b32 s27, s27, 6
    s_add_u32 s27, s27, s25
    s_lshl_b32 s27, s27, 13
    s_and_b32 s26, s26, 3
    s_lshl_b32 s26, s26, 11
    s_add_u32 s86, s27, s26
    s_mul_i32 s25, s23, 4
    s_add_u32 s25, s25, 3
    s_lshr_b32 s26, s20, 5
    s_add_u32 s25, s25, s26
    s_lshl_b32 s26, s24, 1
    s_add_u32 s26, s26, 1
    s_lshr_b32 s27, s21, 5
    s_add_u32 s26, s26, s27
    s_lshr_b32 s27, s26, 2
    s_lshl_b32 s27, s27, 6
    s_add_u32 s27, s27, s25
    s_lshl_b32 s27, s27, 13
    s_and_b32 s26, s26, 3
    s_lshl_b32 s26, s26, 11
    s_add_u32 s87, s27, s26
    v_mbcnt_lo_u32_b32 v192, -1, 0
    v_mbcnt_hi_u32_b32 v192, -1, v192
    v_and_b32 v193, 31, v192
    v_bfe_u32 v194, v192, 5, 1
    v_lshlrev_b32 v176, 4, v192
    s_branch Lproj_qmain
Lproj_qmain:
    s_waitcnt vmcnt(12)
    s_barrier
    v_add_u32 v184, s33, v180
    v_add_u32 v185, s33, v181
    v_add_u32 v186, s33, v182
    v_add_u32 v187, s33, v183
    s_add_u32 s33, s33, 24576
    s_cmp_eq_u32 s33, 147456
    s_cselect_b32 s33, 0, s33
    ds_read_b128 v[128:131], v184 offset:0
    ds_read_b128 v[132:135], v184 offset:2048
    ds_read_b64_tr_b16 v[136:137], v186 offset:0
    ds_read_b64_tr_b16 v[138:139], v186 offset:1024
    ds_read_b64_tr_b16 v[140:141], v187 offset:0
    ds_read_b64_tr_b16 v[142:143], v187 offset:1024
    ds_read_b128 v[144:147], v185 offset:0
    ds_read_b128 v[148:151], v185 offset:2048
    ds_read_b64_tr_b16 v[152:153], v186 offset:4096
    ds_read_b64_tr_b16 v[154:155], v186 offset:5120
    ds_read_b64_tr_b16 v[156:157], v187 offset:4096
    ds_read_b64_tr_b16 v[158:159], v187 offset:5120
    s_waitcnt lgkmcnt(6)
    v_mfma_f32_32x32x16_bf16 v[0:15], v[136:139], v[128:131], 0
    v_mfma_f32_32x32x16_bf16 v[16:31], v[140:143], v[128:131], 0
    v_mfma_f32_32x32x16_bf16 v[32:47], v[136:139], v[132:135], 0
    v_mfma_f32_32x32x16_bf16 v[48:63], v[140:143], v[132:135], 0
    s_waitcnt vmcnt(9) lgkmcnt(0)
    s_barrier
    v_add_u32 v184, s33, v180
    v_add_u32 v185, s33, v181
    v_add_u32 v186, s33, v182
    v_add_u32 v187, s33, v183
    s_add_u32 s33, s33, 24576
    s_cmp_eq_u32 s33, 147456
    s_cselect_b32 s33, 0, s33
    v_mfma_f32_32x32x16_bf16 v[0:15], v[152:155], v[144:147], v[0:15]
    ds_read_b128 v[128:131], v184 offset:0
    ds_read_b128 v[132:135], v184 offset:2048
    ds_read_b64_tr_b16 v[136:137], v186 offset:0
    ds_read_b64_tr_b16 v[138:139], v186 offset:1024
    v_mfma_f32_32x32x16_bf16 v[16:31], v[156:159], v[144:147], v[16:31]
    ds_read_b64_tr_b16 v[140:141], v187 offset:0
    ds_read_b64_tr_b16 v[142:143], v187 offset:1024
    s_add_u32 m0, s28, s32
    s_nop 0
    buffer_load_dwordx4 v188, s[8:11], s30 offen lds
    s_add_u32 m0, s28, s32
    v_mfma_f32_32x32x16_bf16 v[32:47], v[152:155], v[148:151], v[32:47]
    s_add_u32 m0, m0, 1024
    s_nop 0
    buffer_load_dwordx4 v189, s[8:11], s30 offen lds
    s_add_u32 m0, s29, s32
    s_nop 0
    buffer_load_dwordx4 v190, s[12:15], s31 offen lds
    s_add_u32 s30, s30, 64
    v_mfma_f32_32x32x16_bf16 v[48:63], v[156:159], v[148:151], v[48:63]
    s_add_u32 s31, s31, 0x40000
    s_add_u32 s32, s32, 24576
    s_cmp_eq_u32 s32, 147456
    s_cselect_b32 s32, 0, s32
    buffer_store_dwordx4 v[64:67], v176, s[16:19], s80 offen offset:0
    ds_read_b128 v[144:147], v185 offset:0
    ds_read_b128 v[148:151], v185 offset:2048
    ds_read_b64_tr_b16 v[152:153], v186 offset:4096
    ds_read_b64_tr_b16 v[154:155], v186 offset:5120
    ds_read_b64_tr_b16 v[156:157], v187 offset:4096
    ds_read_b64_tr_b16 v[158:159], v187 offset:5120
    s_waitcnt lgkmcnt(6)
    v_mfma_f32_32x32x16_bf16 v[0:15], v[136:139], v[128:131], v[0:15]
    v_mfma_f32_32x32x16_bf16 v[16:31], v[140:143], v[128:131], v[16:31]
    v_mfma_f32_32x32x16_bf16 v[32:47], v[136:139], v[132:135], v[32:47]
    v_mfma_f32_32x32x16_bf16 v[48:63], v[140:143], v[132:135], v[48:63]
    s_waitcnt vmcnt(10) lgkmcnt(0)
    s_barrier
    v_add_u32 v184, s33, v180
    v_add_u32 v185, s33, v181
    v_add_u32 v186, s33, v182
    v_add_u32 v187, s33, v183
    s_add_u32 s33, s33, 24576
    s_cmp_eq_u32 s33, 147456
    s_cselect_b32 s33, 0, s33
    v_mfma_f32_32x32x16_bf16 v[0:15], v[152:155], v[144:147], v[0:15]
    ds_read_b128 v[128:131], v184 offset:0
    ds_read_b128 v[132:135], v184 offset:2048
    ds_read_b64_tr_b16 v[136:137], v186 offset:0
    ds_read_b64_tr_b16 v[138:139], v186 offset:1024
    v_mfma_f32_32x32x16_bf16 v[16:31], v[156:159], v[144:147], v[16:31]
    ds_read_b64_tr_b16 v[140:141], v187 offset:0
    ds_read_b64_tr_b16 v[142:143], v187 offset:1024
    s_add_u32 m0, s28, s32
    s_nop 0
    buffer_load_dwordx4 v188, s[8:11], s30 offen lds
    s_add_u32 m0, s28, s32
    v_mfma_f32_32x32x16_bf16 v[32:47], v[152:155], v[148:151], v[32:47]
    s_add_u32 m0, m0, 1024
    s_nop 0
    buffer_load_dwordx4 v189, s[8:11], s30 offen lds
    s_add_u32 m0, s29, s32
    s_nop 0
    buffer_load_dwordx4 v190, s[12:15], s31 offen lds
    s_add_u32 s30, s30, 64
    v_mfma_f32_32x32x16_bf16 v[48:63], v[156:159], v[148:151], v[48:63]
    s_add_u32 s31, s31, 0x40000
    s_add_u32 s32, s32, 24576
    s_cmp_eq_u32 s32, 147456
    s_cselect_b32 s32, 0, s32
    buffer_store_dwordx4 v[68:71], v176, s[16:19], s80 offen offset:1024
    ds_read_b128 v[144:147], v185 offset:0
    ds_read_b128 v[148:151], v185 offset:2048
    ds_read_b64_tr_b16 v[152:153], v186 offset:4096
    ds_read_b64_tr_b16 v[154:155], v186 offset:5120
    ds_read_b64_tr_b16 v[156:157], v187 offset:4096
    ds_read_b64_tr_b16 v[158:159], v187 offset:5120
    s_waitcnt lgkmcnt(6)
    v_mfma_f32_32x32x16_bf16 v[0:15], v[136:139], v[128:131], v[0:15]
    v_mfma_f32_32x32x16_bf16 v[16:31], v[140:143], v[128:131], v[16:31]
    v_mfma_f32_32x32x16_bf16 v[32:47], v[136:139], v[132:135], v[32:47]
    v_mfma_f32_32x32x16_bf16 v[48:63], v[140:143], v[132:135], v[48:63]
    s_waitcnt vmcnt(11) lgkmcnt(0)
    s_barrier
    v_add_u32 v184, s33, v180
    v_add_u32 v185, s33, v181
    v_add_u32 v186, s33, v182
    v_add_u32 v187, s33, v183
    s_add_u32 s33, s33, 24576
    s_cmp_eq_u32 s33, 147456
    s_cselect_b32 s33, 0, s33
    v_mfma_f32_32x32x16_bf16 v[0:15], v[152:155], v[144:147], v[0:15]
    ds_read_b128 v[128:131], v184 offset:0
    ds_read_b128 v[132:135], v184 offset:2048
    ds_read_b64_tr_b16 v[136:137], v186 offset:0
    ds_read_b64_tr_b16 v[138:139], v186 offset:1024
    v_mfma_f32_32x32x16_bf16 v[16:31], v[156:159], v[144:147], v[16:31]
    ds_read_b64_tr_b16 v[140:141], v187 offset:0
    ds_read_b64_tr_b16 v[142:143], v187 offset:1024
    s_add_u32 m0, s28, s32
    s_nop 0
    buffer_load_dwordx4 v188, s[8:11], s30 offen lds
    s_add_u32 m0, s28, s32
    v_mfma_f32_32x32x16_bf16 v[32:47], v[152:155], v[148:151], v[32:47]
    s_add_u32 m0, m0, 1024
    s_nop 0
    buffer_load_dwordx4 v189, s[8:11], s30 offen lds
    s_add_u32 m0, s29, s32
    s_nop 0
    buffer_load_dwordx4 v190, s[12:15], s31 offen lds
    s_add_u32 s30, s30, 64
    v_mfma_f32_32x32x16_bf16 v[48:63], v[156:159], v[148:151], v[48:63]
    s_add_u32 s31, s31, 0x40000
    s_add_u32 s32, s32, 24576
    s_cmp_eq_u32 s32, 147456
    s_cselect_b32 s32, 0, s32
    buffer_store_dwordx4 v[72:75], v176, s[16:19], s81 offen offset:0
    ds_read_b128 v[144:147], v185 offset:0
    ds_read_b128 v[148:151], v185 offset:2048
    ds_read_b64_tr_b16 v[152:153], v186 offset:4096
    ds_read_b64_tr_b16 v[154:155], v186 offset:5120
    ds_read_b64_tr_b16 v[156:157], v187 offset:4096
    ds_read_b64_tr_b16 v[158:159], v187 offset:5120
    s_waitcnt lgkmcnt(6)
    v_mfma_f32_32x32x16_bf16 v[0:15], v[136:139], v[128:131], v[0:15]
    v_mfma_f32_32x32x16_bf16 v[16:31], v[140:143], v[128:131], v[16:31]
    v_mfma_f32_32x32x16_bf16 v[32:47], v[136:139], v[132:135], v[32:47]
    v_mfma_f32_32x32x16_bf16 v[48:63], v[140:143], v[132:135], v[48:63]
    s_waitcnt vmcnt(12) lgkmcnt(0)
    s_barrier
    v_add_u32 v184, s33, v180
    v_add_u32 v185, s33, v181
    v_add_u32 v186, s33, v182
    v_add_u32 v187, s33, v183
    s_add_u32 s33, s33, 24576
    s_cmp_eq_u32 s33, 147456
    s_cselect_b32 s33, 0, s33
    v_mfma_f32_32x32x16_bf16 v[0:15], v[152:155], v[144:147], v[0:15]
    ds_read_b128 v[128:131], v184 offset:0
    ds_read_b128 v[132:135], v184 offset:2048
    ds_read_b64_tr_b16 v[136:137], v186 offset:0
    ds_read_b64_tr_b16 v[138:139], v186 offset:1024
    v_mfma_f32_32x32x16_bf16 v[16:31], v[156:159], v[144:147], v[16:31]
    ds_read_b64_tr_b16 v[140:141], v187 offset:0
    ds_read_b64_tr_b16 v[142:143], v187 offset:1024
    s_add_u32 m0, s28, s32
    s_nop 0
    buffer_load_dwordx4 v188, s[8:11], s30 offen lds
    s_add_u32 m0, s28, s32
    v_mfma_f32_32x32x16_bf16 v[32:47], v[152:155], v[148:151], v[32:47]
    s_add_u32 m0, m0, 1024
    s_nop 0
    buffer_load_dwordx4 v189, s[8:11], s30 offen lds
    s_add_u32 m0, s29, s32
    s_nop 0
    buffer_load_dwordx4 v190, s[12:15], s31 offen lds
    s_add_u32 s30, s30, 64
    v_mfma_f32_32x32x16_bf16 v[48:63], v[156:159], v[148:151], v[48:63]
    s_add_u32 s31, s31, 0x40000
    s_add_u32 s32, s32, 24576
    s_cmp_eq_u32 s32, 147456
    s_cselect_b32 s32, 0, s32
    buffer_store_dwordx4 v[76:79], v176, s[16:19], s81 offen offset:1024
    ds_read_b128 v[144:147], v185 offset:0
    ds_read_b128 v[148:151], v185 offset:2048
    ds_read_b64_tr_b16 v[152:153], v186 offset:4096
    ds_read_b64_tr_b16 v[154:155], v186 offset:5120
    ds_read_b64_tr_b16 v[156:157], v187 offset:4096
    ds_read_b64_tr_b16 v[158:159], v187 offset:5120
    s_waitcnt lgkmcnt(6)
    v_mfma_f32_32x32x16_bf16 v[0:15], v[136:139], v[128:131], v[0:15]
    v_mfma_f32_32x32x16_bf16 v[16:31], v[140:143], v[128:131], v[16:31]
    v_mfma_f32_32x32x16_bf16 v[32:47], v[136:139], v[132:135], v[32:47]
    v_mfma_f32_32x32x16_bf16 v[48:63], v[140:143], v[132:135], v[48:63]
    s_waitcnt vmcnt(13) lgkmcnt(0)
    s_barrier
    v_add_u32 v184, s33, v180
    v_add_u32 v185, s33, v181
    v_add_u32 v186, s33, v182
    v_add_u32 v187, s33, v183
    s_add_u32 s33, s33, 24576
    s_cmp_eq_u32 s33, 147456
    s_cselect_b32 s33, 0, s33
    v_mfma_f32_32x32x16_bf16 v[0:15], v[152:155], v[144:147], v[0:15]
    ds_read_b128 v[128:131], v184 offset:0
    ds_read_b128 v[132:135], v184 offset:2048
    ds_read_b64_tr_b16 v[136:137], v186 offset:0
    ds_read_b64_tr_b16 v[138:139], v186 offset:1024
    v_mfma_f32_32x32x16_bf16 v[16:31], v[156:159], v[144:147], v[16:31]
    ds_read_b64_tr_b16 v[140:141], v187 offset:0
    ds_read_b64_tr_b16 v[142:143], v187 offset:1024
    s_add_u32 m0, s28, s32
    s_nop 0
    buffer_load_dwordx4 v188, s[8:11], s30 offen lds
    s_add_u32 m0, s28, s32
    v_mfma_f32_32x32x16_bf16 v[32:47], v[152:155], v[148:151], v[32:47]
    s_add_u32 m0, m0, 1024
    s_nop 0
    buffer_load_dwordx4 v189, s[8:11], s30 offen lds
    s_add_u32 m0, s29, s32
    s_nop 0
    buffer_load_dwordx4 v190, s[12:15], s31 offen lds
    s_add_u32 s30, s30, 64
    v_mfma_f32_32x32x16_bf16 v[48:63], v[156:159], v[148:151], v[48:63]
    s_add_u32 s31, s31, 0x40000
    s_add_u32 s32, s32, 24576
    s_cmp_eq_u32 s32, 147456
    s_cselect_b32 s32, 0, s32
    buffer_store_dwordx4 v[80:83], v176, s[16:19], s82 offen offset:0
    ds_read_b128 v[144:147], v185 offset:0
    ds_read_b128 v[148:151], v185 offset:2048
    ds_read_b64_tr_b16 v[152:153], v186 offset:4096
    ds_read_b64_tr_b16 v[154:155], v186 offset:5120
    ds_read_b64_tr_b16 v[156:157], v187 offset:4096
    ds_read_b64_tr_b16 v[158:159], v187 offset:5120
    s_waitcnt lgkmcnt(6)
    v_mfma_f32_32x32x16_bf16 v[0:15], v[136:139], v[128:131], v[0:15]
    v_mfma_f32_32x32x16_bf16 v[16:31], v[140:143], v[128:131], v[16:31]
    v_mfma_f32_32x32x16_bf16 v[32:47], v[136:139], v[132:135], v[32:47]
    v_mfma_f32_32x32x16_bf16 v[48:63], v[140:143], v[132:135], v[48:63]
    s_waitcnt vmcnt(13) lgkmcnt(0)
    s_barrier
    v_add_u32 v184, s33, v180
    v_add_u32 v185, s33, v181
    v_add_u32 v186, s33, v182
    v_add_u32 v187, s33, v183
    s_add_u32 s33, s33, 24576
    s_cmp_eq_u32 s33, 147456
    s_cselect_b32 s33, 0, s33
    v_mfma_f32_32x32x16_bf16 v[0:15], v[152:155], v[144:147], v[0:15]
    ds_read_b128 v[128:131], v184 offset:0
    ds_read_b128 v[132:135], v184 offset:2048
    ds_read_b64_tr_b16 v[136:137], v186 offset:0
    ds_read_b64_tr_b16 v[138:139], v186 offset:1024
    v_mfma_f32_32x32x16_bf16 v[16:31], v[156:159], v[144:147], v[16:31]
    ds_read_b64_tr_b16 v[140:141], v187 offset:0
    ds_read_b64_tr_b16 v[142:143], v187 offset:1024
    s_add_u32 m0, s28, s32
    s_nop 0
    buffer_load_dwordx4 v188, s[8:11], s30 offen lds
    s_add_u32 m0, s28, s32
    v_mfma_f32_32x32x16_bf16 v[32:47], v[152:155], v[148:151], v[32:47]
    s_add_u32 m0, m0, 1024
    s_nop 0
    buffer_load_dwordx4 v189, s[8:11], s30 offen lds
    s_add_u32 m0, s29, s32
    s_nop 0
    buffer_load_dwordx4 v190, s[12:15], s31 offen lds
    s_add_u32 s30, s30, 64
    v_mfma_f32_32x32x16_bf16 v[48:63], v[156:159], v[148:151], v[48:63]
    s_add_u32 s31, s31, 0x40000
    s_add_u32 s32, s32, 24576
    s_cmp_eq_u32 s32, 147456
    s_cselect_b32 s32, 0, s32
    buffer_store_dwordx4 v[84:87], v176, s[16:19], s82 offen offset:1024
    ds_read_b128 v[144:147], v185 offset:0
    ds_read_b128 v[148:151], v185 offset:2048
    ds_read_b64_tr_b16 v[152:153], v186 offset:4096
    ds_read_b64_tr_b16 v[154:155], v186 offset:5120
    ds_read_b64_tr_b16 v[156:157], v187 offset:4096
    ds_read_b64_tr_b16 v[158:159], v187 offset:5120
    s_waitcnt lgkmcnt(6)
    v_mfma_f32_32x32x16_bf16 v[0:15], v[136:139], v[128:131], v[0:15]
    v_mfma_f32_32x32x16_bf16 v[16:31], v[140:143], v[128:131], v[16:31]
    v_mfma_f32_32x32x16_bf16 v[32:47], v[136:139], v[132:135], v[32:47]
    v_mfma_f32_32x32x16_bf16 v[48:63], v[140:143], v[132:135], v[48:63]
    s_waitcnt vmcnt(13) lgkmcnt(0)
    s_barrier
    v_add_u32 v184, s33, v180
    v_add_u32 v185, s33, v181
    v_add_u32 v186, s33, v182
    v_add_u32 v187, s33, v183
    s_add_u32 s33, s33, 24576
    s_cmp_eq_u32 s33, 147456
    s_cselect_b32 s33, 0, s33
    v_mfma_f32_32x32x16_bf16 v[0:15], v[152:155], v[144:147], v[0:15]
    ds_read_b128 v[128:131], v184 offset:0
    ds_read_b128 v[132:135], v184 offset:2048
    ds_read_b64_tr_b16 v[136:137], v186 offset:0
    ds_read_b64_tr_b16 v[138:139], v186 offset:1024
    v_mfma_f32_32x32x16_bf16 v[16:31], v[156:159], v[144:147], v[16:31]
    ds_read_b64_tr_b16 v[140:141], v187 offset:0
    ds_read_b64_tr_b16 v[142:143], v187 offset:1024
    s_add_u32 m0, s28, s32
    s_nop 0
    buffer_load_dwordx4 v188, s[8:11], s30 offen lds
    s_add_u32 m0, s28, s32
    v_mfma_f32_32x32x16_bf16 v[32:47], v[152:155], v[148:151], v[32:47]
    s_add_u32 m0, m0, 1024
    s_nop 0
    buffer_load_dwordx4 v189, s[8:11], s30 offen lds
    s_add_u32 m0, s29, s32
    s_nop 0
    buffer_load_dwordx4 v190, s[12:15], s31 offen lds
    s_add_u32 s30, s30, 64
    v_mfma_f32_32x32x16_bf16 v[48:63], v[156:159], v[148:151], v[48:63]
    s_add_u32 s31, s31, 0x40000
    s_add_u32 s32, s32, 24576
    s_cmp_eq_u32 s32, 147456
    s_cselect_b32 s32, 0, s32
    buffer_store_dwordx4 v[88:91], v176, s[16:19], s83 offen offset:0
    ds_read_b128 v[144:147], v185 offset:0
    ds_read_b128 v[148:151], v185 offset:2048
    ds_read_b64_tr_b16 v[152:153], v186 offset:4096
    ds_read_b64_tr_b16 v[154:155], v186 offset:5120
    ds_read_b64_tr_b16 v[156:157], v187 offset:4096
    ds_read_b64_tr_b16 v[158:159], v187 offset:5120
    s_waitcnt lgkmcnt(6)
    v_mfma_f32_32x32x16_bf16 v[0:15], v[136:139], v[128:131], v[0:15]
    v_mfma_f32_32x32x16_bf16 v[16:31], v[140:143], v[128:131], v[16:31]
    v_mfma_f32_32x32x16_bf16 v[32:47], v[136:139], v[132:135], v[32:47]
    v_mfma_f32_32x32x16_bf16 v[48:63], v[140:143], v[132:135], v[48:63]
    s_waitcnt vmcnt(13) lgkmcnt(0)
    s_barrier
    v_add_u32 v184, s33, v180
    v_add_u32 v185, s33, v181
    v_add_u32 v186, s33, v182
    v_add_u32 v187, s33, v183
    s_add_u32 s33, s33, 24576
    s_cmp_eq_u32 s33, 147456
    s_cselect_b32 s33, 0, s33
    v_mfma_f32_32x32x16_bf16 v[0:15], v[152:155], v[144:147], v[0:15]
    ds_read_b128 v[128:131], v184 offset:0
    ds_read_b128 v[132:135], v184 offset:2048
    ds_read_b64_tr_b16 v[136:137], v186 offset:0
    ds_read_b64_tr_b16 v[138:139], v186 offset:1024
    v_mfma_f32_32x32x16_bf16 v[16:31], v[156:159], v[144:147], v[16:31]
    ds_read_b64_tr_b16 v[140:141], v187 offset:0
    ds_read_b64_tr_b16 v[142:143], v187 offset:1024
    s_add_u32 m0, s28, s32
    s_nop 0
    buffer_load_dwordx4 v188, s[8:11], s30 offen lds
    s_add_u32 m0, s28, s32
    v_mfma_f32_32x32x16_bf16 v[32:47], v[152:155], v[148:151], v[32:47]
    s_add_u32 m0, m0, 1024
    s_nop 0
    buffer_load_dwordx4 v189, s[8:11], s30 offen lds
    s_add_u32 m0, s29, s32
    s_nop 0
    buffer_load_dwordx4 v190, s[12:15], s31 offen lds
    s_add_u32 s30, s30, 64
    v_mfma_f32_32x32x16_bf16 v[48:63], v[156:159], v[148:151], v[48:63]
    s_add_u32 s31, s31, 0x40000
    s_add_u32 s32, s32, 24576
    s_cmp_eq_u32 s32, 147456
    s_cselect_b32 s32, 0, s32
    buffer_store_dwordx4 v[92:95], v176, s[16:19], s83 offen offset:1024
    ds_read_b128 v[144:147], v185 offset:0
    ds_read_b128 v[148:151], v185 offset:2048
    ds_read_b64_tr_b16 v[152:153], v186 offset:4096
    ds_read_b64_tr_b16 v[154:155], v186 offset:5120
    ds_read_b64_tr_b16 v[156:157], v187 offset:4096
    ds_read_b64_tr_b16 v[158:159], v187 offset:5120
    s_waitcnt lgkmcnt(6)
    v_mfma_f32_32x32x16_bf16 v[0:15], v[136:139], v[128:131], v[0:15]
    v_mfma_f32_32x32x16_bf16 v[16:31], v[140:143], v[128:131], v[16:31]
    v_mfma_f32_32x32x16_bf16 v[32:47], v[136:139], v[132:135], v[32:47]
    v_mfma_f32_32x32x16_bf16 v[48:63], v[140:143], v[132:135], v[48:63]
    s_waitcnt vmcnt(13) lgkmcnt(0)
    s_barrier
    v_add_u32 v184, s33, v180
    v_add_u32 v185, s33, v181
    v_add_u32 v186, s33, v182
    v_add_u32 v187, s33, v183
    s_add_u32 s33, s33, 24576
    s_cmp_eq_u32 s33, 147456
    s_cselect_b32 s33, 0, s33
    v_mfma_f32_32x32x16_bf16 v[0:15], v[152:155], v[144:147], v[0:15]
    ds_read_b128 v[128:131], v184 offset:0
    ds_read_b128 v[132:135], v184 offset:2048
    ds_read_b64_tr_b16 v[136:137], v186 offset:0
    ds_read_b64_tr_b16 v[138:139], v186 offset:1024
    v_mfma_f32_32x32x16_bf16 v[16:31], v[156:159], v[144:147], v[16:31]
    ds_read_b64_tr_b16 v[140:141], v187 offset:0
    ds_read_b64_tr_b16 v[142:143], v187 offset:1024
    s_add_u32 m0, s28, s32
    s_nop 0
    buffer_load_dwordx4 v188, s[8:11], s30 offen lds
    s_add_u32 m0, s28, s32
    v_mfma_f32_32x32x16_bf16 v[32:47], v[152:155], v[148:151], v[32:47]
    s_add_u32 m0, m0, 1024
    s_nop 0
    buffer_load_dwordx4 v189, s[8:11], s30 offen lds
    s_add_u32 m0, s29, s32
    s_nop 0
    buffer_load_dwordx4 v190, s[12:15], s31 offen lds
    s_add_u32 s30, s30, 64
    v_mfma_f32_32x32x16_bf16 v[48:63], v[156:159], v[148:151], v[48:63]
    s_add_u32 s31, s31, 0x40000
    s_add_u32 s32, s32, 24576
    s_cmp_eq_u32 s32, 147456
    s_cselect_b32 s32, 0, s32
    buffer_store_dwordx4 v[96:99], v176, s[16:19], s84 offen offset:0
    ds_read_b128 v[144:147], v185 offset:0
    ds_read_b128 v[148:151], v185 offset:2048
    ds_read_b64_tr_b16 v[152:153], v186 offset:4096
    ds_read_b64_tr_b16 v[154:155], v186 offset:5120
    ds_read_b64_tr_b16 v[156:157], v187 offset:4096
    ds_read_b64_tr_b16 v[158:159], v187 offset:5120
    s_waitcnt lgkmcnt(6)
    v_mfma_f32_32x32x16_bf16 v[0:15], v[136:139], v[128:131], v[0:15]
    v_mfma_f32_32x32x16_bf16 v[16:31], v[140:143], v[128:131], v[16:31]
    v_mfma_f32_32x32x16_bf16 v[32:47], v[136:139], v[132:135], v[32:47]
    v_mfma_f32_32x32x16_bf16 v[48:63], v[140:143], v[132:135], v[48:63]
    s_waitcnt vmcnt(13) lgkmcnt(0)
    s_barrier
    v_add_u32 v184, s33, v180
    v_add_u32 v185, s33, v181
    v_add_u32 v186, s33, v182
    v_add_u32 v187, s33, v183
    s_add_u32 s33, s33, 24576
    s_cmp_eq_u32 s33, 147456
    s_cselect_b32 s33, 0, s33
    v_mfma_f32_32x32x16_bf16 v[0:15], v[152:155], v[144:147], v[0:15]
    ds_read_b128 v[128:131], v184 offset:0
    ds_read_b128 v[132:135], v184 offset:2048
    ds_read_b64_tr_b16 v[136:137], v186 offset:0
    ds_read_b64_tr_b16 v[138:139], v186 offset:1024
    v_mfma_f32_32x32x16_bf16 v[16:31], v[156:159], v[144:147], v[16:31]
    ds_read_b64_tr_b16 v[140:141], v187 offset:0
    ds_read_b64_tr_b16 v[142:143], v187 offset:1024
    s_add_u32 m0, s28, s32
    s_nop 0
    buffer_load_dwordx4 v188, s[8:11], s30 offen lds
    s_add_u32 m0, s28, s32
    v_mfma_f32_32x32x16_bf16 v[32:47], v[152:155], v[148:151], v[32:47]
    s_add_u32 m0, m0, 1024
    s_nop 0
    buffer_load_dwordx4 v189, s[8:11], s30 offen lds
    s_add_u32 m0, s29, s32
    s_nop 0
    buffer_load_dwordx4 v190, s[12:15], s31 offen lds
    s_add_u32 s30, s30, 64
    v_mfma_f32_32x32x16_bf16 v[48:63], v[156:159], v[148:151], v[48:63]
    s_add_u32 s31, s31, 0x40000
    s_add_u32 s32, s32, 24576
    s_cmp_eq_u32 s32, 147456
    s_cselect_b32 s32, 0, s32
    buffer_store_dwordx4 v[100:103], v176, s[16:19], s84 offen offset:1024
    ds_read_b128 v[144:147], v185 offset:0
    ds_read_b128 v[148:151], v185 offset:2048
    ds_read_b64_tr_b16 v[152:153], v186 offset:4096
    ds_read_b64_tr_b16 v[154:155], v186 offset:5120
    ds_read_b64_tr_b16 v[156:157], v187 offset:4096
    ds_read_b64_tr_b16 v[158:159], v187 offset:5120
    s_waitcnt lgkmcnt(6)
    v_mfma_f32_32x32x16_bf16 v[0:15], v[136:139], v[128:131], v[0:15]
    v_mfma_f32_32x32x16_bf16 v[16:31], v[140:143], v[128:131], v[16:31]
    v_mfma_f32_32x32x16_bf16 v[32:47], v[136:139], v[132:135], v[32:47]
    v_mfma_f32_32x32x16_bf16 v[48:63], v[140:143], v[132:135], v[48:63]
    s_waitcnt vmcnt(13) lgkmcnt(0)
    s_barrier
    v_add_u32 v184, s33, v180
    v_add_u32 v185, s33, v181
    v_add_u32 v186, s33, v182
    v_add_u32 v187, s33, v183
    s_add_u32 s33, s33, 24576
    s_cmp_eq_u32 s33, 147456
    s_cselect_b32 s33, 0, s33
    v_mfma_f32_32x32x16_bf16 v[0:15], v[152:155], v[144:147], v[0:15]
    ds_read_b128 v[128:131], v184 offset:0
    ds_read_b128 v[132:135], v184 offset:2048
    ds_read_b64_tr_b16 v[136:137], v186 offset:0
    ds_read_b64_tr_b16 v[138:139], v186 offset:1024
    v_mfma_f32_32x32x16_bf16 v[16:31], v[156:159], v[144:147], v[16:31]
    ds_read_b64_tr_b16 v[140:141], v187 offset:0
    ds_read_b64_tr_b16 v[142:143], v187 offset:1024
    s_add_u32 m0, s28, s32
    s_nop 0
    buffer_load_dwordx4 v188, s[8:11], s30 offen lds
    s_add_u32 m0, s28, s32
    v_mfma_f32_32x32x16_bf16 v[32:47], v[152:155], v[148:151], v[32:47]
    s_add_u32 m0, m0, 1024
    s_nop 0
    buffer_load_dwordx4 v189, s[8:11], s30 offen lds
    s_add_u32 m0, s29, s32
    s_nop 0
    buffer_load_dwordx4 v190, s[12:15], s31 offen lds
    s_add_u32 s30, s30, 64
    v_mfma_f32_32x32x16_bf16 v[48:63], v[156:159], v[148:151], v[48:63]
    s_add_u32 s31, s31, 0x40000
    s_add_u32 s32, s32, 24576
    s_cmp_eq_u32 s32, 147456
    s_cselect_b32 s32, 0, s32
    buffer_store_dwordx4 v[104:107], v176, s[16:19], s85 offen offset:0
    ds_read_b128 v[144:147], v185 offset:0
    ds_read_b128 v[148:151], v185 offset:2048
    ds_read_b64_tr_b16 v[152:153], v186 offset:4096
    ds_read_b64_tr_b16 v[154:155], v186 offset:5120
    ds_read_b64_tr_b16 v[156:157], v187 offset:4096
    ds_read_b64_tr_b16 v[158:159], v187 offset:5120
    s_waitcnt lgkmcnt(6)
    v_mfma_f32_32x32x16_bf16 v[0:15], v[136:139], v[128:131], v[0:15]
    v_mfma_f32_32x32x16_bf16 v[16:31], v[140:143], v[128:131], v[16:31]
    v_mfma_f32_32x32x16_bf16 v[32:47], v[136:139], v[132:135], v[32:47]
    v_mfma_f32_32x32x16_bf16 v[48:63], v[140:143], v[132:135], v[48:63]
    s_waitcnt vmcnt(13) lgkmcnt(0)
    s_barrier
    v_add_u32 v184, s33, v180
    v_add_u32 v185, s33, v181
    v_add_u32 v186, s33, v182
    v_add_u32 v187, s33, v183
    s_add_u32 s33, s33, 24576
    s_cmp_eq_u32 s33, 147456
    s_cselect_b32 s33, 0, s33
    v_mfma_f32_32x32x16_bf16 v[0:15], v[152:155], v[144:147], v[0:15]
    ds_read_b128 v[128:131], v184 offset:0
    ds_read_b128 v[132:135], v184 offset:2048
    ds_read_b64_tr_b16 v[136:137], v186 offset:0
    ds_read_b64_tr_b16 v[138:139], v186 offset:1024
    v_mfma_f32_32x32x16_bf16 v[16:31], v[156:159], v[144:147], v[16:31]
    ds_read_b64_tr_b16 v[140:141], v187 offset:0
    ds_read_b64_tr_b16 v[142:143], v187 offset:1024
    s_add_u32 m0, s28, s32
    s_nop 0
    buffer_load_dwordx4 v188, s[8:11], s30 offen lds
    s_add_u32 m0, s28, s32
    v_mfma_f32_32x32x16_bf16 v[32:47], v[152:155], v[148:151], v[32:47]
    s_add_u32 m0, m0, 1024
    s_nop 0
    buffer_load_dwordx4 v189, s[8:11], s30 offen lds
    s_add_u32 m0, s29, s32
    s_nop 0
    buffer_load_dwordx4 v190, s[12:15], s31 offen lds
    s_add_u32 s30, s30, 64
    v_mfma_f32_32x32x16_bf16 v[48:63], v[156:159], v[148:151], v[48:63]
    s_add_u32 s31, s31, 0x40000
    s_add_u32 s32, s32, 24576
    s_cmp_eq_u32 s32, 147456
    s_cselect_b32 s32, 0, s32
    buffer_store_dwordx4 v[108:111], v176, s[16:19], s85 offen offset:1024
    ds_read_b128 v[144:147], v185 offset:0
    ds_read_b128 v[148:151], v185 offset:2048
    ds_read_b64_tr_b16 v[152:153], v186 offset:4096
    ds_read_b64_tr_b16 v[154:155], v186 offset:5120
    ds_read_b64_tr_b16 v[156:157], v187 offset:4096
    ds_read_b64_tr_b16 v[158:159], v187 offset:5120
    s_waitcnt lgkmcnt(6)
    v_mfma_f32_32x32x16_bf16 v[0:15], v[136:139], v[128:131], v[0:15]
    v_mfma_f32_32x32x16_bf16 v[16:31], v[140:143], v[128:131], v[16:31]
    v_mfma_f32_32x32x16_bf16 v[32:47], v[136:139], v[132:135], v[32:47]
    v_mfma_f32_32x32x16_bf16 v[48:63], v[140:143], v[132:135], v[48:63]
    s_waitcnt vmcnt(13) lgkmcnt(0)
    s_barrier
    v_add_u32 v184, s33, v180
    v_add_u32 v185, s33, v181
    v_add_u32 v186, s33, v182
    v_add_u32 v187, s33, v183
    s_add_u32 s33, s33, 24576
    s_cmp_eq_u32 s33, 147456
    s_cselect_b32 s33, 0, s33
    v_mfma_f32_32x32x16_bf16 v[0:15], v[152:155], v[144:147], v[0:15]
    ds_read_b128 v[128:131], v184 offset:0
    ds_read_b128 v[132:135], v184 offset:2048
    ds_read_b64_tr_b16 v[136:137], v186 offset:0
    ds_read_b64_tr_b16 v[138:139], v186 offset:1024
    v_mfma_f32_32x32x16_bf16 v[16:31], v[156:159], v[144:147], v[16:31]
    ds_read_b64_tr_b16 v[140:141], v187 offset:0
    ds_read_b64_tr_b16 v[142:143], v187 offset:1024
    s_add_u32 m0, s28, s32
    s_nop 0
    buffer_load_dwordx4 v188, s[8:11], s30 offen lds
    s_add_u32 m0, s28, s32
    v_mfma_f32_32x32x16_bf16 v[32:47], v[152:155], v[148:151], v[32:47]
    s_add_u32 m0, m0, 1024
    s_nop 0
    buffer_load_dwordx4 v189, s[8:11], s30 offen lds
    s_add_u32 m0, s29, s32
    s_nop 0
    buffer_load_dwordx4 v190, s[12:15], s31 offen lds
    s_add_u32 s30, s30, 64
    v_mfma_f32_32x32x16_bf16 v[48:63], v[156:159], v[148:151], v[48:63]
    s_add_u32 s31, s31, 0x40000
    s_add_u32 s32, s32, 24576
    s_cmp_eq_u32 s32, 147456
    s_cselect_b32 s32, 0, s32
    buffer_store_dwordx4 v[112:115], v176, s[16:19], s86 offen offset:0
    ds_read_b128 v[144:147], v185 offset:0
    ds_read_b128 v[148:151], v185 offset:2048
    ds_read_b64_tr_b16 v[152:153], v186 offset:4096
    ds_read_b64_tr_b16 v[154:155], v186 offset:5120
    ds_read_b64_tr_b16 v[156:157], v187 offset:4096
    ds_read_b64_tr_b16 v[158:159], v187 offset:5120
    s_waitcnt lgkmcnt(6)
    v_mfma_f32_32x32x16_bf16 v[0:15], v[136:139], v[128:131], v[0:15]
    v_mfma_f32_32x32x16_bf16 v[16:31], v[140:143], v[128:131], v[16:31]
    v_mfma_f32_32x32x16_bf16 v[32:47], v[136:139], v[132:135], v[32:47]
    v_mfma_f32_32x32x16_bf16 v[48:63], v[140:143], v[132:135], v[48:63]
    s_waitcnt vmcnt(13) lgkmcnt(0)
    s_barrier
    v_add_u32 v184, s33, v180
    v_add_u32 v185, s33, v181
    v_add_u32 v186, s33, v182
    v_add_u32 v187, s33, v183
    s_add_u32 s33, s33, 24576
    s_cmp_eq_u32 s33, 147456
    s_cselect_b32 s33, 0, s33
    v_mfma_f32_32x32x16_bf16 v[0:15], v[152:155], v[144:147], v[0:15]
    ds_read_b128 v[128:131], v184 offset:0
    v_mfma_f32_32x32x16_bf16 v[16:31], v[156:159], v[144:147], v[16:31]
    ds_read_b128 v[132:135], v184 offset:2048
    ds_read_b64_tr_b16 v[136:137], v186 offset:0
    v_mfma_f32_32x32x16_bf16 v[32:47], v[152:155], v[148:151], v[32:47]
    ds_read_b64_tr_b16 v[138:139], v186 offset:1024
    ds_read_b64_tr_b16 v[140:141], v187 offset:0
    v_mfma_f32_32x32x16_bf16 v[48:63], v[156:159], v[148:151], v[48:63]
    ds_read_b64_tr_b16 v[142:143], v187 offset:1024
    buffer_store_dwordx4 v[116:119], v176, s[16:19], s86 offen offset:1024
    ds_read_b128 v[144:147], v185 offset:0
    ds_read_b128 v[148:151], v185 offset:2048
    ds_read_b64_tr_b16 v[152:153], v186 offset:4096
    ds_read_b64_tr_b16 v[154:155], v186 offset:5120
    ds_read_b64_tr_b16 v[156:157], v187 offset:4096
    ds_read_b64_tr_b16 v[158:159], v187 offset:5120
    s_waitcnt lgkmcnt(6)
    v_mfma_f32_32x32x16_bf16 v[0:15], v[136:139], v[128:131], v[0:15]
    v_mfma_f32_32x32x16_bf16 v[16:31], v[140:143], v[128:131], v[16:31]
    v_mfma_f32_32x32x16_bf16 v[32:47], v[136:139], v[132:135], v[32:47]
    v_mfma_f32_32x32x16_bf16 v[48:63], v[140:143], v[132:135], v[48:63]
    s_waitcnt vmcnt(10) lgkmcnt(0)
    s_barrier
    v_add_u32 v184, s33, v180
    v_add_u32 v185, s33, v181
    v_add_u32 v186, s33, v182
    v_add_u32 v187, s33, v183
    s_add_u32 s33, s33, 24576
    s_cmp_eq_u32 s33, 147456
    s_cselect_b32 s33, 0, s33
    v_mfma_f32_32x32x16_bf16 v[0:15], v[152:155], v[144:147], v[0:15]
    ds_read_b128 v[128:131], v184 offset:0
    v_mfma_f32_32x32x16_bf16 v[16:31], v[156:159], v[144:147], v[16:31]
    ds_read_b128 v[132:135], v184 offset:2048
    ds_read_b64_tr_b16 v[136:137], v186 offset:0
    v_mfma_f32_32x32x16_bf16 v[32:47], v[152:155], v[148:151], v[32:47]
    ds_read_b64_tr_b16 v[138:139], v186 offset:1024
    ds_read_b64_tr_b16 v[140:141], v187 offset:0
    v_mfma_f32_32x32x16_bf16 v[48:63], v[156:159], v[148:151], v[48:63]
    ds_read_b64_tr_b16 v[142:143], v187 offset:1024
    buffer_store_dwordx4 v[120:123], v176, s[16:19], s87 offen offset:0
    ds_read_b128 v[144:147], v185 offset:0
    ds_read_b128 v[148:151], v185 offset:2048
    ds_read_b64_tr_b16 v[152:153], v186 offset:4096
    ds_read_b64_tr_b16 v[154:155], v186 offset:5120
    ds_read_b64_tr_b16 v[156:157], v187 offset:4096
    ds_read_b64_tr_b16 v[158:159], v187 offset:5120
    s_waitcnt lgkmcnt(6)
    v_mfma_f32_32x32x16_bf16 v[0:15], v[136:139], v[128:131], v[0:15]
    v_mfma_f32_32x32x16_bf16 v[16:31], v[140:143], v[128:131], v[16:31]
    v_mfma_f32_32x32x16_bf16 v[32:47], v[136:139], v[132:135], v[32:47]
    v_mfma_f32_32x32x16_bf16 v[48:63], v[140:143], v[132:135], v[48:63]
    s_waitcnt vmcnt(7) lgkmcnt(0)
    s_barrier
    v_add_u32 v184, s33, v180
    v_add_u32 v185, s33, v181
    v_add_u32 v186, s33, v182
    v_add_u32 v187, s33, v183
    s_add_u32 s33, s33, 24576
    s_cmp_eq_u32 s33, 147456
    s_cselect_b32 s33, 0, s33
    v_mfma_f32_32x32x16_bf16 v[0:15], v[152:155], v[144:147], v[0:15]
    ds_read_b128 v[128:131], v184 offset:0
    v_mfma_f32_32x32x16_bf16 v[16:31], v[156:159], v[144:147], v[16:31]
    ds_read_b128 v[132:135], v184 offset:2048
    ds_read_b64_tr_b16 v[136:137], v186 offset:0
    v_mfma_f32_32x32x16_bf16 v[32:47], v[152:155], v[148:151], v[32:47]
    ds_read_b64_tr_b16 v[138:139], v186 offset:1024
    ds_read_b64_tr_b16 v[140:141], v187 offset:0
    v_mfma_f32_32x32x16_bf16 v[48:63], v[156:159], v[148:151], v[48:63]
    ds_read_b64_tr_b16 v[142:143], v187 offset:1024
    buffer_store_dwordx4 v[124:127], v176, s[16:19], s87 offen offset:1024
    ds_read_b128 v[144:147], v185 offset:0
    ds_read_b128 v[148:151], v185 offset:2048
    ds_read_b64_tr_b16 v[152:153], v186 offset:4096
    ds_read_b64_tr_b16 v[154:155], v186 offset:5120
    ds_read_b64_tr_b16 v[156:157], v187 offset:4096
    ds_read_b64_tr_b16 v[158:159], v187 offset:5120
    s_waitcnt lgkmcnt(6)
    v_mfma_f32_32x32x16_bf16 v[0:15], v[136:139], v[128:131], v[0:15]
    v_mfma_f32_32x32x16_bf16 v[16:31], v[140:143], v[128:131], v[16:31]
    v_mfma_f32_32x32x16_bf16 v[32:47], v[136:139], v[132:135], v[32:47]
    v_mfma_f32_32x32x16_bf16 v[48:63], v[140:143], v[132:135], v[48:63]
    s_waitcnt vmcnt(4) lgkmcnt(0)
    s_barrier
    v_add_u32 v184, s33, v180
    v_add_u32 v185, s33, v181
    v_add_u32 v186, s33, v182
    v_add_u32 v187, s33, v183
    s_add_u32 s33, s33, 24576
    s_cmp_eq_u32 s33, 147456
    s_cselect_b32 s33, 0, s33
    v_mfma_f32_32x32x16_bf16 v[0:15], v[152:155], v[144:147], v[0:15]
    ds_read_b128 v[128:131], v184 offset:0
    v_mfma_f32_32x32x16_bf16 v[16:31], v[156:159], v[144:147], v[16:31]
    ds_read_b128 v[132:135], v184 offset:2048
    ds_read_b64_tr_b16 v[136:137], v186 offset:0
    v_mfma_f32_32x32x16_bf16 v[32:47], v[152:155], v[148:151], v[32:47]
    ds_read_b64_tr_b16 v[138:139], v186 offset:1024
    v_mfma_f32_32x32x16_bf16 v[48:63], v[156:159], v[148:151], v[48:63]
    ds_read_b64_tr_b16 v[140:141], v187 offset:0
    ds_read_b64_tr_b16 v[142:143], v187 offset:1024
    ds_read_b128 v[144:147], v185 offset:0
    ds_read_b128 v[148:151], v185 offset:2048
    ds_read_b64_tr_b16 v[152:153], v186 offset:4096
    ds_read_b64_tr_b16 v[154:155], v186 offset:5120
    ds_read_b64_tr_b16 v[156:157], v187 offset:4096
    ds_read_b64_tr_b16 v[158:159], v187 offset:5120
    s_waitcnt lgkmcnt(6)
    v_mfma_f32_32x32x16_bf16 v[0:15], v[136:139], v[128:131], v[0:15]
    v_mfma_f32_32x32x16_bf16 v[16:31], v[140:143], v[128:131], v[16:31]
    v_mfma_f32_32x32x16_bf16 v[32:47], v[136:139], v[132:135], v[32:47]
    v_mfma_f32_32x32x16_bf16 v[48:63], v[140:143], v[132:135], v[48:63]
    s_waitcnt lgkmcnt(0)
    v_mfma_f32_32x32x16_bf16 v[0:15], v[152:155], v[144:147], v[0:15]
    v_mfma_f32_32x32x16_bf16 v[16:31], v[156:159], v[144:147], v[16:31]
    v_mfma_f32_32x32x16_bf16 v[32:47], v[152:155], v[148:151], v[32:47]
    v_mfma_f32_32x32x16_bf16 v[48:63], v[156:159], v[148:151], v[48:63]
    v_mbcnt_lo_u32_b32 v192, -1, 0
    v_mbcnt_hi_u32_b32 v192, -1, v192
    v_and_b32 v193, 31, v192
    v_bfe_u32 v194, v192, 5, 1
    v_lshlrev_b32 v192, 4, v192
    s_mul_i32 s25, s69, 2
    s_add_u32 s25, s25, 0
    s_lshr_b32 s26, s20, 5
    s_add_u32 s25, s25, s26
    s_lshl_b32 s26, s70, 1
    s_add_u32 s26, s26, 0
    s_lshr_b32 s27, s68, 5
    s_add_u32 s26, s26, s27
    s_lshr_b32 s27, s26, 2
    s_lshl_b32 s27, s27, 6
    s_add_u32 s27, s27, s25
    s_lshl_b32 s27, s27, 13
    s_and_b32 s26, s26, 3
    s_lshl_b32 s26, s26, 11
    s_add_u32 s27, s27, s26
    v_mul_f32 v0, 0x3e0293ee, v0
    v_mul_f32 v1, 0x3e0293ee, v1
    v_mul_f32 v2, 0x3e0293ee, v2
    v_mul_f32 v3, 0x3e0293ee, v3
    v_mul_f32 v4, 0x3e0293ee, v4
    v_mul_f32 v5, 0x3e0293ee, v5
    v_mul_f32 v6, 0x3e0293ee, v6
    v_mul_f32 v7, 0x3e0293ee, v7
    v_cvt_pk_bf16_f32 v128, v0, v1
    v_cvt_pk_bf16_f32 v129, v2, v3
    v_cvt_pk_bf16_f32 v130, v4, v5
    v_cvt_pk_bf16_f32 v131, v6, v7
    buffer_store_dwordx4 v[128:131], v192, s[64:67], s27 offen offset:0
    v_mul_f32 v8, 0x3e0293ee, v8
    v_mul_f32 v9, 0x3e0293ee, v9
    v_mul_f32 v10, 0x3e0293ee, v10
    v_mul_f32 v11, 0x3e0293ee, v11
    v_mul_f32 v12, 0x3e0293ee, v12
    v_mul_f32 v13, 0x3e0293ee, v13
    v_mul_f32 v14, 0x3e0293ee, v14
    v_mul_f32 v15, 0x3e0293ee, v15
    v_cvt_pk_bf16_f32 v132, v8, v9
    v_cvt_pk_bf16_f32 v133, v10, v11
    v_cvt_pk_bf16_f32 v134, v12, v13
    v_cvt_pk_bf16_f32 v135, v14, v15
    buffer_store_dwordx4 v[132:135], v192, s[64:67], s27 offen offset:1024
    s_mul_i32 s25, s69, 2
    s_add_u32 s25, s25, 0
    s_lshr_b32 s26, s20, 5
    s_add_u32 s25, s25, s26
    s_lshl_b32 s26, s70, 1
    s_add_u32 s26, s26, 1
    s_lshr_b32 s27, s68, 5
    s_add_u32 s26, s26, s27
    s_lshr_b32 s27, s26, 2
    s_lshl_b32 s27, s27, 6
    s_add_u32 s27, s27, s25
    s_lshl_b32 s27, s27, 13
    s_and_b32 s26, s26, 3
    s_lshl_b32 s26, s26, 11
    s_add_u32 s27, s27, s26
    v_mul_f32 v16, 0x3e0293ee, v16
    v_mul_f32 v17, 0x3e0293ee, v17
    v_mul_f32 v18, 0x3e0293ee, v18
    v_mul_f32 v19, 0x3e0293ee, v19
    v_mul_f32 v20, 0x3e0293ee, v20
    v_mul_f32 v21, 0x3e0293ee, v21
    v_mul_f32 v22, 0x3e0293ee, v22
    v_mul_f32 v23, 0x3e0293ee, v23
    v_cvt_pk_bf16_f32 v136, v16, v17
    v_cvt_pk_bf16_f32 v137, v18, v19
    v_cvt_pk_bf16_f32 v138, v20, v21
    v_cvt_pk_bf16_f32 v139, v22, v23
    buffer_store_dwordx4 v[136:139], v192, s[64:67], s27 offen offset:0
    v_mul_f32 v24, 0x3e0293ee, v24
    v_mul_f32 v25, 0x3e0293ee, v25
    v_mul_f32 v26, 0x3e0293ee, v26
    v_mul_f32 v27, 0x3e0293ee, v27
    v_mul_f32 v28, 0x3e0293ee, v28
    v_mul_f32 v29, 0x3e0293ee, v29
    v_mul_f32 v30, 0x3e0293ee, v30
    v_mul_f32 v31, 0x3e0293ee, v31
    v_cvt_pk_bf16_f32 v140, v24, v25
    v_cvt_pk_bf16_f32 v141, v26, v27
    v_cvt_pk_bf16_f32 v142, v28, v29
    v_cvt_pk_bf16_f32 v143, v30, v31
    buffer_store_dwordx4 v[140:143], v192, s[64:67], s27 offen offset:1024
    s_mul_i32 s25, s69, 2
    s_add_u32 s25, s25, 1
    s_lshr_b32 s26, s20, 5
    s_add_u32 s25, s25, s26
    s_lshl_b32 s26, s70, 1
    s_add_u32 s26, s26, 0
    s_lshr_b32 s27, s68, 5
    s_add_u32 s26, s26, s27
    s_lshr_b32 s27, s26, 2
    s_lshl_b32 s27, s27, 6
    s_add_u32 s27, s27, s25
    s_lshl_b32 s27, s27, 13
    s_and_b32 s26, s26, 3
    s_lshl_b32 s26, s26, 11
    s_add_u32 s27, s27, s26
    v_mul_f32 v32, 0x3e0293ee, v32
    v_mul_f32 v33, 0x3e0293ee, v33
    v_mul_f32 v34, 0x3e0293ee, v34
    v_mul_f32 v35, 0x3e0293ee, v35
    v_mul_f32 v36, 0x3e0293ee, v36
    v_mul_f32 v37, 0x3e0293ee, v37
    v_mul_f32 v38, 0x3e0293ee, v38
    v_mul_f32 v39, 0x3e0293ee, v39
    v_cvt_pk_bf16_f32 v144, v32, v33
    v_cvt_pk_bf16_f32 v145, v34, v35
    v_cvt_pk_bf16_f32 v146, v36, v37
    v_cvt_pk_bf16_f32 v147, v38, v39
    buffer_store_dwordx4 v[144:147], v192, s[64:67], s27 offen offset:0
    v_mul_f32 v40, 0x3e0293ee, v40
    v_mul_f32 v41, 0x3e0293ee, v41
    v_mul_f32 v42, 0x3e0293ee, v42
    v_mul_f32 v43, 0x3e0293ee, v43
    v_mul_f32 v44, 0x3e0293ee, v44
    v_mul_f32 v45, 0x3e0293ee, v45
    v_mul_f32 v46, 0x3e0293ee, v46
    v_mul_f32 v47, 0x3e0293ee, v47
    v_cvt_pk_bf16_f32 v148, v40, v41
    v_cvt_pk_bf16_f32 v149, v42, v43
    v_cvt_pk_bf16_f32 v150, v44, v45
    v_cvt_pk_bf16_f32 v151, v46, v47
    buffer_store_dwordx4 v[148:151], v192, s[64:67], s27 offen offset:1024
    s_mul_i32 s25, s69, 2
    s_add_u32 s25, s25, 1
    s_lshr_b32 s26, s20, 5
    s_add_u32 s25, s25, s26
    s_lshl_b32 s26, s70, 1
    s_add_u32 s26, s26, 1
    s_lshr_b32 s27, s68, 5
    s_add_u32 s26, s26, s27
    s_lshr_b32 s27, s26, 2
    s_lshl_b32 s27, s27, 6
    s_add_u32 s27, s27, s25
    s_lshl_b32 s27, s27, 13
    s_and_b32 s26, s26, 3
    s_lshl_b32 s26, s26, 11
    s_add_u32 s27, s27, s26
    v_mul_f32 v48, 0x3e0293ee, v48
    v_mul_f32 v49, 0x3e0293ee, v49
    v_mul_f32 v50, 0x3e0293ee, v50
    v_mul_f32 v51, 0x3e0293ee, v51
    v_mul_f32 v52, 0x3e0293ee, v52
    v_mul_f32 v53, 0x3e0293ee, v53
    v_mul_f32 v54, 0x3e0293ee, v54
    v_mul_f32 v55, 0x3e0293ee, v55
    v_cvt_pk_bf16_f32 v152, v48, v49
    v_cvt_pk_bf16_f32 v153, v50, v51
    v_cvt_pk_bf16_f32 v154, v52, v53
    v_cvt_pk_bf16_f32 v155, v54, v55
    buffer_store_dwordx4 v[152:155], v192, s[64:67], s27 offen offset:0
    v_mul_f32 v56, 0x3e0293ee, v56
    v_mul_f32 v57, 0x3e0293ee, v57
    v_mul_f32 v58, 0x3e0293ee, v58
    v_mul_f32 v59, 0x3e0293ee, v59
    v_mul_f32 v60, 0x3e0293ee, v60
    v_mul_f32 v61, 0x3e0293ee, v61
    v_mul_f32 v62, 0x3e0293ee, v62
    v_mul_f32 v63, 0x3e0293ee, v63
    v_cvt_pk_bf16_f32 v156, v56, v57
    v_cvt_pk_bf16_f32 v157, v58, v59
    v_cvt_pk_bf16_f32 v158, v60, v61
    v_cvt_pk_bf16_f32 v159, v62, v63
    buffer_store_dwordx4 v[156:159], v192, s[64:67], s27 offen offset:1024
Lproj_exit:
    s_endpgm
.globl l2_kernel
.p2align 8
.type l2_kernel,@function
l2_kernel:
    s_load_dwordx2 s[46:47], s[0:1], 88
    v_lshrrev_b32 v1, 6, v0
    s_nop 0
    v_readfirstlane_b32 s24, v1
    s_cmp_ge_u32 s2, 256
    s_cbranch_scc1 Lattn_exit
    s_waitcnt lgkmcnt(0)
    s_lshr_b32 s25, s24, 2
    s_and_b32 s26, s24, 3
    s_and_b32 s3, s2, 7
    s_lshr_b32 s4, s2, 3
    s_and_b32 s5, s4, 3
    s_lshl_b32 s27, s3, 2
    s_add_u32 s27, s27, s5
    s_lshr_b32 s28, s2, 5
    s_lshl_b32 s3, s27, 19
    s_add_u32 s8, s46, 16777216
    s_addc_u32 s9, s47, 0
    s_add_u32 s8, s8, s3
    s_addc_u32 s9, s9, 0
    s_mov_b32 s10, 0x80000
    s_mov_b32 s11, 0x00020000
    s_add_u32 s12, s46, 33554432
    s_addc_u32 s13, s47, 0
    s_add_u32 s12, s12, s3
    s_addc_u32 s13, s13, 0
    s_mov_b32 s14, 0x80000
    s_mov_b32 s15, 0x00020000
    s_add_u32 s16, s46, 0
    s_addc_u32 s17, s47, 0
    s_add_u32 s16, s16, s3
    s_addc_u32 s17, s17, 0
    s_mov_b32 s18, 0x80000
    s_mov_b32 s19, 0x00020000
    s_add_u32 s20, s46, 50331648
    s_addc_u32 s21, s47, 0
    s_mov_b32 s22, 16777216
    s_mov_b32 s23, 0x00020000
    s_mov_b32 s44, 0x3e0293ee
    s_mov_b32 s45, 0x41000000
    s_mov_b32 s54, 0
    v_and_b32 v192, 63, v0
    v_lshlrev_b32 v188, 4, v192
    s_lshl_b32 s3, s25, 14
    v_add_u32 v182, s3, v188
    v_add_u32 v183, 0x8000, v182
    v_add_u32 v184, 0x10000, v182
    v_add_u32 v185, 0x18000, v182
    s_lshl_b32 s3, s24, 12
    v_add_u32 v187, s3, v188
    v_and_b32 v193, 31, v0
    v_bfe_u32 v194, v0, 5, 1
    v_lshlrev_b32 v194, 2, v194
    v_sub_u32 v186, v193, v194
    s_lshl_b32 s3, s25, 1
    s_sub_u32 s3, s3, s26
    s_lshl_b32 s3, s3, 5
    v_subrev_u32 v186, s3, v186
    v_mov_b32 v189, 0xf149f2ca
    s_sub_u32 s29, 15, s28
    s_sub_u32 s35, 16, s28
    s_mov_b32 s30, 0
    s_mov_b32 s34, 0
    s_lshl_b32 s32, s24, 12
    s_mov_b32 s36, 0
    s_mov_b32 s37, 0
    s_sub_u32 s3, s36, s35
    s_cmp_ge_u32 s36, s35
    s_cselect_b32 s3, s3, s36
    s_lshl_b32 s33, s3, 15
    s_cmp_ge_u32 s36, 17
    s_cselect_b32 s33, 0x7f000000, s33
    s_and_b32 s4, s36, 1
    s_lshl_b32 s4, s4, 15
    s_add_u32 s4, s4, s32
    s_add_u32 m0, s4, 0
    s_add_u32 s36, s36, 1
    buffer_load_dwordx4 v187, s[8:11], s33 offen offset:0 lds
    buffer_load_dwordx4 v187, s[8:11], s33 offen offset:1024 lds
    buffer_load_dwordx4 v187, s[8:11], s33 offen offset:2048 lds
    buffer_load_dwordx4 v187, s[8:11], s33 offen offset:3072 lds
    s_sub_u32 s3, s37, s35
    s_cmp_ge_u32 s37, s35
    s_cselect_b32 s3, s3, s37
    s_lshl_b32 s31, s3, 15
    s_cmp_ge_u32 s37, 17
    s_cselect_b32 s31, 0x7f000000, s31
    s_and_b32 s4, s37, 1
    s_lshl_b32 s4, s4, 15
    s_add_u32 s4, s4, s32
    s_add_u32 m0, s4, 65536
    s_add_u32 s37, s37, 1
    buffer_load_dwordx4 v187, s[12:15], s31 offen offset:0 lds
    buffer_load_dwordx4 v187, s[12:15], s31 offen offset:1024 lds
    buffer_load_dwordx4 v187, s[12:15], s31 offen offset:2048 lds
    buffer_load_dwordx4 v187, s[12:15], s31 offen offset:3072 lds
    s_sub_u32 s3, s36, s35
    s_cmp_ge_u32 s36, s35
    s_cselect_b32 s3, s3, s36
    s_lshl_b32 s33, s3, 15
    s_cmp_ge_u32 s36, 17
    s_cselect_b32 s33, 0x7f000000, s33
    s_and_b32 s4, s36, 1
    s_lshl_b32 s4, s4, 15
    s_add_u32 s4, s4, s32
    s_add_u32 m0, s4, 0
    s_add_u32 s36, s36, 1
    buffer_load_dwordx4 v187, s[8:11], s33 offen offset:0 lds
    buffer_load_dwordx4 v187, s[8:11], s33 offen offset:1024 lds
    buffer_load_dwordx4 v187, s[8:11], s33 offen offset:2048 lds
    buffer_load_dwordx4 v187, s[8:11], s33 offen offset:3072 lds
    s_lshl_b32 s3, s29, 2
    s_add_u32 s3, s3, s26
    s_lshl_b32 s3, s3, 13
    v_add_u32 v195, 4096, v188
    buffer_load_dwordx4 v[0:3], v188, s[16:19], s3 offen offset:0
    buffer_load_dwordx4 v[4:7], v188, s[16:19], s3 offen offset:1024
    buffer_load_dwordx4 v[8:11], v188, s[16:19], s3 offen offset:2048
    buffer_load_dwordx4 v[12:15], v188, s[16:19], s3 offen offset:3072
    buffer_load_dwordx4 v[16:19], v195, s[16:19], s3 offen offset:0
    buffer_load_dwordx4 v[20:23], v195, s[16:19], s3 offen offset:1024
    buffer_load_dwordx4 v[24:27], v195, s[16:19], s3 offen offset:2048
    buffer_load_dwordx4 v[28:31], v195, s[16:19], s3 offen offset:3072
    v_mov_b32 v32, 0
    v_mov_b32 v33, 0
    v_mov_b32 v34, 0
    v_mov_b32 v35, 0
    v_mov_b32 v36, 0
    v_mov_b32 v37, 0
    v_mov_b32 v38, 0
    v_mov_b32 v39, 0
    v_mov_b32 v40, 0
    v_mov_b32 v41, 0
    v_mov_b32 v42, 0
    v_mov_b32 v43, 0
    v_mov_b32 v44, 0
    v_mov_b32 v45, 0
    v_mov_b32 v46, 0
    v_mov_b32 v47, 0
    v_mov_b32 v48, 0
    v_mov_b32 v49, 0
    v_mov_b32 v50, 0
    v_mov_b32 v51, 0
    v_mov_b32 v52, 0
    v_mov_b32 v53, 0
    v_mov_b32 v54, 0
    v_mov_b32 v55, 0
    v_mov_b32 v56, 0
    v_mov_b32 v57, 0
    v_mov_b32 v58, 0
    v_mov_b32 v59, 0
    v_mov_b32 v60, 0
    v_mov_b32 v61, 0
    v_mov_b32 v62, 0
    v_mov_b32 v63, 0
    v_mov_b32 v64, 0
    v_mov_b32 v65, 0
    v_mov_b32 v66, 0
    v_mov_b32 v67, 0
    v_mov_b32 v68, 0
    v_mov_b32 v69, 0
    v_mov_b32 v70, 0
    v_mov_b32 v71, 0
    v_mov_b32 v72, 0
    v_mov_b32 v73, 0
    v_mov_b32 v74, 0
    v_mov_b32 v75, 0
    v_mov_b32 v76, 0
    v_mov_b32 v77, 0
    v_mov_b32 v78, 0
    v_mov_b32 v79, 0
    v_mov_b32 v80, 0
    v_mov_b32 v81, 0
    v_mov_b32 v82, 0
    v_mov_b32 v83, 0
    v_mov_b32 v84, 0
    v_mov_b32 v85, 0
    v_mov_b32 v86, 0
    v_mov_b32 v87, 0
    v_mov_b32 v88, 0
    v_mov_b32 v89, 0
    v_mov_b32 v90, 0
    v_mov_b32 v91, 0
    v_mov_b32 v92, 0
    v_mov_b32 v93, 0
    v_mov_b32 v94, 0
    v_mov_b32 v95, 0
    v_mov_b32 v208, 0
    v_mov_b32 v209, 0
    v_mov_b32 v210, 0
    v_mov_b32 v211, 0
    v_mov_b32 v212, 0
    v_mov_b32 v213, 0
    v_mov_b32 v214, 0
    v_mov_b32 v215, 0
    v_mov_b32 v216, 0
    v_mov_b32 v217, 0
    v_mov_b32 v218, 0
    v_mov_b32 v219, 0
    v_mov_b32 v220, 0
    v_mov_b32 v221, 0
    v_mov_b32 v222, 0
    v_mov_b32 v223, 0
    v_mov_b32 v176, 0
    v_mov_b32 v178, 0
    v_mov_b32 v179, 0
    s_mov_b32 s54, 0
Lattn_tile:
    s_waitcnt vmcnt(0)
    s_barrier
    ds_read_b128 v[144:147], v182 offset:0
    s_waitcnt lgkmcnt(0)
    v_mfma_f32_32x32x16_bf16 v[96:111], v[144:147], v[0:3], v[208:223]
    ds_read_b128 v[148:151], v182 offset:1024
    ds_read_b128 v[152:155], v182 offset:2048
    ds_read_b128 v[156:159], v182 offset:3072
    ds_read_b128 v[160:163], v182 offset:4096
    ds_read_b128 v[164:167], v182 offset:5120
    s_waitcnt lgkmcnt(4)
    v_mfma_f32_32x32x16_bf16 v[96:111], v[148:151], v[4:7], v[96:111]
    ds_read_b128 v[168:171], v182 offset:6144
    s_waitcnt lgkmcnt(4)
    v_mfma_f32_32x32x16_bf16 v[96:111], v[152:155], v[8:11], v[96:111]
    ds_read_b128 v[172:175], v182 offset:7168
    s_waitcnt lgkmcnt(4)
    v_mfma_f32_32x32x16_bf16 v[96:111], v[156:159], v[12:15], v[96:111]
    ds_read_b128 v[144:147], v182 offset:8192
    s_waitcnt lgkmcnt(4)
    v_mfma_f32_32x32x16_bf16 v[96:111], v[160:163], v[16:19], v[96:111]
    ds_read_b128 v[148:151], v182 offset:9216
    s_waitcnt lgkmcnt(4)
    v_mfma_f32_32x32x16_bf16 v[96:111], v[164:167], v[20:23], v[96:111]
    ds_read_b128 v[152:155], v182 offset:10240
    s_waitcnt lgkmcnt(4)
    v_mfma_f32_32x32x16_bf16 v[96:111], v[168:171], v[24:27], v[96:111]
    ds_read_b128 v[156:159], v182 offset:11264
    s_waitcnt lgkmcnt(4)
    v_mfma_f32_32x32x16_bf16 v[96:111], v[172:175], v[28:31], v[96:111]
    ds_read_b128 v[160:163], v182 offset:12288
    s_cmp_eq_u32 s29, 0
    s_cbranch_scc1 Lattn_only
    s_waitcnt lgkmcnt(4)
    v_mfma_f32_32x32x16_bf16 v[112:127], v[144:147], v[0:3], v[208:223]
    ds_read_b128 v[164:167], v182 offset:13312
    s_nop 5
    v_max3_f32 v192, v96, v97, v98
    v_max3_f32 v193, v99, v100, v101
    s_waitcnt lgkmcnt(4)
    v_mfma_f32_32x32x16_bf16 v[112:127], v[148:151], v[4:7], v[112:127]
    ds_read_b128 v[168:171], v182 offset:14336
    v_max3_f32 v192, v192, v102, v103
    v_max3_f32 v193, v193, v104, v105
    v_max3_f32 v192, v192, v106, v107
    s_waitcnt lgkmcnt(4)
    v_mfma_f32_32x32x16_bf16 v[112:127], v[152:155], v[8:11], v[112:127]
    ds_read_b128 v[172:175], v182 offset:15360
    v_max3_f32 v193, v193, v108, v109
    v_max3_f32 v192, v192, v110, v111
    s_waitcnt lgkmcnt(4)
    v_mfma_f32_32x32x16_bf16 v[112:127], v[156:159], v[12:15], v[112:127]
    v_max_f32 v192, v192, v193
    v_mov_b32 v193, v192
    s_nop 1
    v_permlane32_swap_b32 v192, v193
    s_waitcnt lgkmcnt(3)
    v_mfma_f32_32x32x16_bf16 v[112:127], v[160:163], v[16:19], v[112:127]
    v_max_f32 v192, v192, v193
    s_branch Lattn_slow1
Lattn_back1:
    s_waitcnt lgkmcnt(2)
    v_mfma_f32_32x32x16_bf16 v[112:127], v[164:167], v[20:23], v[112:127]
    v_exp_f32 v96, v96
    v_exp_f32 v97, v97
    s_waitcnt lgkmcnt(1)
    v_mfma_f32_32x32x16_bf16 v[112:127], v[168:171], v[24:27], v[112:127]
    v_exp_f32 v98, v98
    v_exp_f32 v99, v99
    v_exp_f32 v100, v100
    s_waitcnt lgkmcnt(0)
    v_mfma_f32_32x32x16_bf16 v[112:127], v[172:175], v[28:31], v[112:127]
    v_exp_f32 v101, v101
    v_exp_f32 v102, v102
    v_exp_f32 v103, v103
    v_exp_f32 v104, v104
    v_exp_f32 v105, v105
    v_exp_f32 v106, v106
    v_exp_f32 v107, v107
    v_exp_f32 v108, v108
    v_exp_f32 v109, v109
    v_exp_f32 v110, v110
    v_exp_f32 v111, v111
    v_add_f32 v179, v179, v96
    v_add_f32 v178, v178, v97
    v_cvt_pk_bf16_f32 v128, v96, v97
    v_add_f32 v179, v179, v98
    v_add_f32 v178, v178, v99
    v_cvt_pk_bf16_f32 v129, v98, v99
    v_add_f32 v179, v179, v100
    v_add_f32 v178, v178, v101
    v_cvt_pk_bf16_f32 v130, v100, v101
    v_add_f32 v179, v179, v102
    v_add_f32 v178, v178, v103
    v_cvt_pk_bf16_f32 v131, v102, v103
    v_add_f32 v179, v179, v104
    v_add_f32 v178, v178, v105
    v_cvt_pk_bf16_f32 v132, v104, v105
    v_add_f32 v179, v179, v106
    v_add_f32 v178, v178, v107
    v_cvt_pk_bf16_f32 v133, v106, v107
    v_add_f32 v179, v179, v108
    v_add_f32 v178, v178, v109
    v_cvt_pk_bf16_f32 v134, v108, v109
    v_add_f32 v179, v179, v110
    v_add_f32 v178, v178, v111
    v_cvt_pk_bf16_f32 v135, v110, v111
    s_waitcnt vmcnt(0)
    s_barrier
    ds_read_b128 v[144:147], v183 offset:0
    ds_read_b128 v[148:151], v183 offset:1024
    ds_read_b128 v[152:155], v183 offset:2048
    ds_read_b128 v[156:159], v183 offset:3072
    ds_read_b128 v[160:163], v183 offset:4096
    s_sub_u32 s3, s36, s35
    s_cmp_ge_u32 s36, s35
    s_cselect_b32 s3, s3, s36
    s_lshl_b32 s33, s3, 15
    s_cmp_ge_u32 s36, 17
    s_cselect_b32 s33, 0x7f000000, s33
    s_and_b32 s4, s36, 1
    s_lshl_b32 s4, s4, 15
    s_add_u32 s4, s4, s32
    s_add_u32 m0, s4, 0
    s_add_u32 s36, s36, 1
    s_waitcnt lgkmcnt(4)
    v_mfma_f32_32x32x16_bf16 v[96:111], v[144:147], v[0:3], v[208:223]
    ds_read_b128 v[164:167], v183 offset:5120
    s_cmp_lg_u32 s54, 0
    s_cbranch_scc1 Lattn_fix2
Lattn_fixb2:
    s_waitcnt lgkmcnt(4)
    v_mfma_f32_32x32x16_bf16 v[96:111], v[148:151], v[4:7], v[96:111]
    ds_read_b128 v[168:171], v183 offset:6144
    v_max3_f32 v192, v112, v113, v114
    v_max3_f32 v193, v115, v116, v117
    v_max3_f32 v192, v192, v118, v119
    v_max3_f32 v193, v193, v120, v121
    s_waitcnt lgkmcnt(4)
    v_mfma_f32_32x32x16_bf16 v[96:111], v[152:155], v[8:11], v[96:111]
    ds_read_b128 v[172:175], v183 offset:7168
    buffer_load_dwordx4 v187, s[8:11], s33 offen offset:0 lds
    v_max3_f32 v192, v192, v122, v123
    v_max3_f32 v193, v193, v124, v125
    v_max3_f32 v192, v192, v126, v127
    s_waitcnt lgkmcnt(4)
    v_mfma_f32_32x32x16_bf16 v[96:111], v[156:159], v[12:15], v[96:111]
    ds_read_b128 v[144:147], v184 offset:0
    v_max_f32 v192, v192, v193
    v_mov_b32 v193, v192
    s_nop 1
    v_permlane32_swap_b32 v192, v193
    buffer_load_dwordx4 v187, s[8:11], s33 offen offset:1024 lds
    s_waitcnt lgkmcnt(4)
    v_mfma_f32_32x32x16_bf16 v[96:111], v[160:163], v[16:19], v[96:111]
    ds_read_b128 v[148:151], v184 offset:2048
    v_max_f32 v192, v192, v193
    v_cmp_lt_f32 vcc, s45, v192
    s_mov_b32 s51, 0
    s_nop 1
    s_cmp_lg_u64 vcc, 0
    s_waitcnt lgkmcnt(4)
    v_mfma_f32_32x32x16_bf16 v[96:111], v[164:167], v[20:23], v[96:111]
    ds_read_b128 v[152:155], v184 offset:4096
    s_cbranch_scc1 Lattn_slow2
Lattn_back2:
    buffer_load_dwordx4 v187, s[8:11], s33 offen offset:2048 lds
    v_exp_f32 v112, v112
    s_waitcnt lgkmcnt(4)
    v_mfma_f32_32x32x16_bf16 v[96:111], v[168:171], v[24:27], v[96:111]
    ds_read_b128 v[156:159], v184 offset:6144
    v_exp_f32 v113, v113
    v_exp_f32 v114, v114
    v_exp_f32 v115, v115
    v_exp_f32 v116, v116
    s_waitcnt lgkmcnt(4)
    v_mfma_f32_32x32x16_bf16 v[96:111], v[172:175], v[28:31], v[96:111]
    ds_read_b128 v[160:163], v184 offset:1024
    v_exp_f32 v117, v117
    buffer_load_dwordx4 v187, s[8:11], s33 offen offset:3072 lds
    v_exp_f32 v118, v118
    v_exp_f32 v119, v119
    s_cmp_eq_u32 s50, 0
    s_cbranch_scc1 Lattn_rs3
    v_mul_f32 v32, v32, v180
    v_mul_f32 v33, v33, v180
    v_mul_f32 v34, v34, v180
    v_mul_f32 v35, v35, v180
    v_mul_f32 v36, v36, v180
    v_mul_f32 v37, v37, v180
    v_mul_f32 v38, v38, v180
    v_mul_f32 v39, v39, v180
    v_mul_f32 v40, v40, v180
    v_mul_f32 v41, v41, v180
    v_mul_f32 v42, v42, v180
    v_mul_f32 v43, v43, v180
    v_mul_f32 v44, v44, v180
    v_mul_f32 v45, v45, v180
    v_mul_f32 v46, v46, v180
    v_mul_f32 v47, v47, v180
    v_mul_f32 v48, v48, v180
    v_mul_f32 v49, v49, v180
    v_mul_f32 v50, v50, v180
    v_mul_f32 v51, v51, v180
    v_mul_f32 v52, v52, v180
    v_mul_f32 v53, v53, v180
    v_mul_f32 v54, v54, v180
    v_mul_f32 v55, v55, v180
    v_mul_f32 v56, v56, v180
    v_mul_f32 v57, v57, v180
    v_mul_f32 v58, v58, v180
    v_mul_f32 v59, v59, v180
    v_mul_f32 v60, v60, v180
    v_mul_f32 v61, v61, v180
    v_mul_f32 v62, v62, v180
    v_mul_f32 v63, v63, v180
    v_mul_f32 v64, v64, v180
    v_mul_f32 v65, v65, v180
    v_mul_f32 v66, v66, v180
    v_mul_f32 v67, v67, v180
    v_mul_f32 v68, v68, v180
    v_mul_f32 v69, v69, v180
    v_mul_f32 v70, v70, v180
    v_mul_f32 v71, v71, v180
    v_mul_f32 v72, v72, v180
    v_mul_f32 v73, v73, v180
    v_mul_f32 v74, v74, v180
    v_mul_f32 v75, v75, v180
    v_mul_f32 v76, v76, v180
    v_mul_f32 v77, v77, v180
    v_mul_f32 v78, v78, v180
    v_mul_f32 v79, v79, v180
    v_mul_f32 v80, v80, v180
    v_mul_f32 v81, v81, v180
    v_mul_f32 v82, v82, v180
    v_mul_f32 v83, v83, v180
    v_mul_f32 v84, v84, v180
    v_mul_f32 v85, v85, v180
    v_mul_f32 v86, v86, v180
    v_mul_f32 v87, v87, v180
    v_mul_f32 v88, v88, v180
    v_mul_f32 v89, v89, v180
    v_mul_f32 v90, v90, v180
    v_mul_f32 v91, v91, v180
    v_mul_f32 v92, v92, v180
    v_mul_f32 v93, v93, v180
    v_mul_f32 v94, v94, v180
    v_mul_f32 v95, v95, v180
Lattn_rs3:
    s_sub_u32 s3, s37, s35
    s_cmp_ge_u32 s37, s35
    s_cselect_b32 s3, s3, s37
    s_lshl_b32 s31, s3, 15
    s_cmp_ge_u32 s37, 17
    s_cselect_b32 s31, 0x7f000000, s31
    s_and_b32 s4, s37, 1
    s_lshl_b32 s4, s4, 15
    s_add_u32 s4, s4, s32
    s_add_u32 m0, s4, 65536
    s_add_u32 s37, s37, 1
    s_waitcnt lgkmcnt(4)
    v_mfma_f32_32x32x16_bf16 v[32:47], v[144:147], v[128:131], v[32:47]
    ds_read_b128 v[164:167], v184 offset:3072
    v_exp_f32 v120, v120
    v_exp_f32 v121, v121
    v_exp_f32 v122, v122
    v_exp_f32 v123, v123
    s_waitcnt lgkmcnt(4)
    v_mfma_f32_32x32x16_bf16 v[48:63], v[148:151], v[128:131], v[48:63]
    ds_read_b128 v[168:171], v184 offset:5120
    v_exp_f32 v124, v124
    v_exp_f32 v125, v125
    v_exp_f32 v126, v126
    v_exp_f32 v127, v127
    buffer_load_dwordx4 v187, s[12:15], s31 offen offset:0 lds
    s_waitcnt lgkmcnt(4)
    v_mfma_f32_32x32x16_bf16 v[64:79], v[152:155], v[128:131], v[64:79]
    ds_read_b128 v[172:175], v184 offset:7168
    v_add_f32 v179, v179, v112
    v_add_f32 v178, v178, v113
    v_cvt_pk_bf16_f32 v136, v112, v113
    v_add_f32 v179, v179, v114
    s_waitcnt lgkmcnt(4)
    v_mfma_f32_32x32x16_bf16 v[80:95], v[156:159], v[128:131], v[80:95]
    ds_read_b128 v[144:147], v183 offset:8192
    v_add_f32 v178, v178, v115
    v_cvt_pk_bf16_f32 v137, v114, v115
    v_add_f32 v179, v179, v116
    buffer_load_dwordx4 v187, s[12:15], s31 offen offset:1024 lds
    v_add_f32 v178, v178, v117
    s_waitcnt lgkmcnt(4)
    v_mfma_f32_32x32x16_bf16 v[32:47], v[160:163], v[132:135], v[32:47]
    ds_read_b128 v[148:151], v183 offset:9216
    v_cvt_pk_bf16_f32 v138, v116, v117
    v_add_f32 v179, v179, v118
    v_add_f32 v178, v178, v119
    v_cvt_pk_bf16_f32 v139, v118, v119
    s_waitcnt lgkmcnt(4)
    v_mfma_f32_32x32x16_bf16 v[48:63], v[164:167], v[132:135], v[48:63]
    ds_read_b128 v[152:155], v183 offset:10240
    v_add_f32 v179, v179, v120
    v_add_f32 v178, v178, v121
    buffer_load_dwordx4 v187, s[12:15], s31 offen offset:2048 lds
    v_cvt_pk_bf16_f32 v140, v120, v121
    v_add_f32 v179, v179, v122
    s_waitcnt lgkmcnt(4)
    v_mfma_f32_32x32x16_bf16 v[64:79], v[168:171], v[132:135], v[64:79]
    ds_read_b128 v[156:159], v183 offset:11264
    v_add_f32 v178, v178, v123
    v_cvt_pk_bf16_f32 v141, v122, v123
    v_add_f32 v179, v179, v124
    v_add_f32 v178, v178, v125
    s_waitcnt lgkmcnt(4)
    v_mfma_f32_32x32x16_bf16 v[80:95], v[172:175], v[132:135], v[80:95]
    ds_read_b128 v[160:163], v183 offset:12288
    v_cvt_pk_bf16_f32 v142, v124, v125
    buffer_load_dwordx4 v187, s[12:15], s31 offen offset:3072 lds
    v_add_f32 v179, v179, v126
    v_add_f32 v178, v178, v127
    v_cvt_pk_bf16_f32 v143, v126, v127
    v_xor_b32 v182, 0x8000, v182
    v_xor_b32 v183, 0x8000, v183
    v_xor_b32 v184, 0x8000, v184
    v_xor_b32 v185, 0x8000, v185
    s_mov_b32 s30, 1
Lattn_loop:
    s_cmp_ge_u32 s30, s29
    s_cbranch_scc1 Lattn_last
    s_waitcnt lgkmcnt(4)
    v_mfma_f32_32x32x16_bf16 v[112:127], v[144:147], v[0:3], v[208:223]
    ds_read_b128 v[164:167], v182 offset:13312
    s_cmp_lg_u32 s54, 0
    s_cbranch_scc1 Lattn_fix4
Lattn_fixb4:
    s_waitcnt lgkmcnt(4)
    v_mfma_f32_32x32x16_bf16 v[112:127], v[148:151], v[4:7], v[112:127]
    ds_read_b128 v[168:171], v182 offset:14336
    v_max3_f32 v192, v96, v97, v98
    v_max3_f32 v193, v99, v100, v101
    v_max3_f32 v192, v192, v102, v103
    s_waitcnt lgkmcnt(4)
    v_mfma_f32_32x32x16_bf16 v[112:127], v[152:155], v[8:11], v[112:127]
    ds_read_b128 v[172:175], v182 offset:15360
    v_max3_f32 v193, v193, v104, v105
    v_max3_f32 v192, v192, v106, v107
    v_max3_f32 v193, v193, v108, v109
    v_max3_f32 v192, v192, v110, v111
    s_waitcnt lgkmcnt(4)
    v_mfma_f32_32x32x16_bf16 v[112:127], v[156:159], v[12:15], v[112:127]
    ds_read_b128 v[144:147], v185 offset:8192
    v_max_f32 v192, v192, v193
    v_mov_b32 v193, v192
    s_nop 1
    v_permlane32_swap_b32 v192, v193
    s_waitcnt lgkmcnt(4)
    v_mfma_f32_32x32x16_bf16 v[112:127], v[160:163], v[16:19], v[112:127]
    ds_read_b128 v[148:151], v185 offset:10240
    v_max_f32 v192, v192, v193
    v_cmp_lt_f32 vcc, s45, v192
    s_mov_b32 s50, 0
    s_waitcnt lgkmcnt(4)
    v_mfma_f32_32x32x16_bf16 v[112:127], v[164:167], v[20:23], v[112:127]
    ds_read_b128 v[152:155], v185 offset:12288
    s_cmp_lg_u64 vcc, 0
    s_cbranch_scc1 Lattn_slow4
Lattn_back4:
    v_exp_f32 v96, v96
    s_waitcnt lgkmcnt(4)
    v_mfma_f32_32x32x16_bf16 v[112:127], v[168:171], v[24:27], v[112:127]
    ds_read_b128 v[156:159], v185 offset:14336
    v_exp_f32 v97, v97
    v_exp_f32 v98, v98
    v_exp_f32 v99, v99
    s_waitcnt lgkmcnt(4)
    v_mfma_f32_32x32x16_bf16 v[112:127], v[172:175], v[28:31], v[112:127]
    ds_read_b128 v[160:163], v185 offset:9216
    v_exp_f32 v100, v100
    v_exp_f32 v101, v101
    v_exp_f32 v102, v102
    v_exp_f32 v103, v103
    s_cmp_eq_u32 s51, 0
    s_cbranch_scc1 Lattn_rs6
    v_mul_f32 v32, v32, v181
    v_mul_f32 v33, v33, v181
    v_mul_f32 v34, v34, v181
    v_mul_f32 v35, v35, v181
    v_mul_f32 v36, v36, v181
    v_mul_f32 v37, v37, v181
    v_mul_f32 v38, v38, v181
    v_mul_f32 v39, v39, v181
    v_mul_f32 v40, v40, v181
    v_mul_f32 v41, v41, v181
    v_mul_f32 v42, v42, v181
    v_mul_f32 v43, v43, v181
    v_mul_f32 v44, v44, v181
    v_mul_f32 v45, v45, v181
    v_mul_f32 v46, v46, v181
    v_mul_f32 v47, v47, v181
    v_mul_f32 v48, v48, v181
    v_mul_f32 v49, v49, v181
    v_mul_f32 v50, v50, v181
    v_mul_f32 v51, v51, v181
    v_mul_f32 v52, v52, v181
    v_mul_f32 v53, v53, v181
    v_mul_f32 v54, v54, v181
    v_mul_f32 v55, v55, v181
    v_mul_f32 v56, v56, v181
    v_mul_f32 v57, v57, v181
    v_mul_f32 v58, v58, v181
    v_mul_f32 v59, v59, v181
    v_mul_f32 v60, v60, v181
    v_mul_f32 v61, v61, v181
    v_mul_f32 v62, v62, v181
    v_mul_f32 v63, v63, v181
    v_mul_f32 v64, v64, v181
    v_mul_f32 v65, v65, v181
    v_mul_f32 v66, v66, v181
    v_mul_f32 v67, v67, v181
    v_mul_f32 v68, v68, v181
    v_mul_f32 v69, v69, v181
    v_mul_f32 v70, v70, v181
    v_mul_f32 v71, v71, v181
    v_mul_f32 v72, v72, v181
    v_mul_f32 v73, v73, v181
    v_mul_f32 v74, v74, v181
    v_mul_f32 v75, v75, v181
    v_mul_f32 v76, v76, v181
    v_mul_f32 v77, v77, v181
    v_mul_f32 v78, v78, v181
    v_mul_f32 v79, v79, v181
    v_mul_f32 v80, v80, v181
    v_mul_f32 v81, v81, v181
    v_mul_f32 v82, v82, v181
    v_mul_f32 v83, v83, v181
    v_mul_f32 v84, v84, v181
    v_mul_f32 v85, v85, v181
    v_mul_f32 v86, v86, v181
    v_mul_f32 v87, v87, v181
    v_mul_f32 v88, v88, v181
    v_mul_f32 v89, v89, v181
    v_mul_f32 v90, v90, v181
    v_mul_f32 v91, v91, v181
    v_mul_f32 v92, v92, v181
    v_mul_f32 v93, v93, v181
    v_mul_f32 v94, v94, v181
    v_mul_f32 v95, v95, v181
Lattn_rs6:
    s_waitcnt lgkmcnt(4)
    v_mfma_f32_32x32x16_bf16 v[32:47], v[144:147], v[136:139], v[32:47]
    ds_read_b128 v[164:167], v185 offset:11264
    v_exp_f32 v104, v104
    v_exp_f32 v105, v105
    v_exp_f32 v106, v106
    v_exp_f32 v107, v107
    s_waitcnt lgkmcnt(4)
    v_mfma_f32_32x32x16_bf16 v[48:63], v[148:151], v[136:139], v[48:63]
    ds_read_b128 v[168:171], v185 offset:13312
    v_exp_f32 v108, v108
    v_exp_f32 v109, v109
    v_exp_f32 v110, v110
    v_exp_f32 v111, v111
    s_waitcnt lgkmcnt(4)
    v_mfma_f32_32x32x16_bf16 v[64:79], v[152:155], v[136:139], v[64:79]
    ds_read_b128 v[172:175], v185 offset:15360
    v_add_f32 v179, v179, v96
    v_add_f32 v178, v178, v97
    v_cvt_pk_bf16_f32 v128, v96, v97
    v_add_f32 v179, v179, v98
    s_waitcnt lgkmcnt(4)
    v_mfma_f32_32x32x16_bf16 v[80:95], v[156:159], v[136:139], v[80:95]
    v_add_f32 v178, v178, v99
    v_cvt_pk_bf16_f32 v129, v98, v99
    v_add_f32 v179, v179, v100
    v_add_f32 v178, v178, v101
    s_waitcnt lgkmcnt(3)
    v_mfma_f32_32x32x16_bf16 v[32:47], v[160:163], v[140:143], v[32:47]
    v_cvt_pk_bf16_f32 v130, v100, v101
    v_add_f32 v179, v179, v102
    v_add_f32 v178, v178, v103
    v_cvt_pk_bf16_f32 v131, v102, v103
    s_waitcnt lgkmcnt(2)
    v_mfma_f32_32x32x16_bf16 v[48:63], v[164:167], v[140:143], v[48:63]
    v_add_f32 v179, v179, v104
    v_add_f32 v178, v178, v105
    v_cvt_pk_bf16_f32 v132, v104, v105
    v_add_f32 v179, v179, v106
    s_waitcnt lgkmcnt(1)
    v_mfma_f32_32x32x16_bf16 v[64:79], v[168:171], v[140:143], v[64:79]
    v_add_f32 v178, v178, v107
    v_cvt_pk_bf16_f32 v133, v106, v107
    v_add_f32 v179, v179, v108
    v_add_f32 v178, v178, v109
    s_waitcnt lgkmcnt(0)
    v_mfma_f32_32x32x16_bf16 v[80:95], v[172:175], v[140:143], v[80:95]
    v_cvt_pk_bf16_f32 v134, v108, v109
    v_add_f32 v179, v179, v110
    v_add_f32 v178, v178, v111
    v_cvt_pk_bf16_f32 v135, v110, v111
    s_waitcnt vmcnt(0)
    s_barrier
    ds_read_b128 v[144:147], v183 offset:0
    ds_read_b128 v[148:151], v183 offset:1024
    ds_read_b128 v[152:155], v183 offset:2048
    ds_read_b128 v[156:159], v183 offset:3072
    ds_read_b128 v[160:163], v183 offset:4096
    s_sub_u32 s3, s36, s35
    s_cmp_ge_u32 s36, s35
    s_cselect_b32 s3, s3, s36
    s_lshl_b32 s33, s3, 15
    s_cmp_ge_u32 s36, 17
    s_cselect_b32 s33, 0x7f000000, s33
    s_and_b32 s4, s36, 1
    s_lshl_b32 s4, s4, 15
    s_add_u32 s4, s4, s32
    s_add_u32 m0, s4, 0
    s_add_u32 s36, s36, 1
    s_waitcnt lgkmcnt(4)
    v_mfma_f32_32x32x16_bf16 v[96:111], v[144:147], v[0:3], v[208:223]
    ds_read_b128 v[164:167], v183 offset:5120
    s_cmp_lg_u32 s54, 0
    s_cbranch_scc1 Lattn_fix5
Lattn_fixb5:
    s_waitcnt lgkmcnt(4)
    v_mfma_f32_32x32x16_bf16 v[96:111], v[148:151], v[4:7], v[96:111]
    ds_read_b128 v[168:171], v183 offset:6144
    v_max3_f32 v192, v112, v113, v114
    v_max3_f32 v193, v115, v116, v117
    v_max3_f32 v192, v192, v118, v119
    v_max3_f32 v193, v193, v120, v121
    s_waitcnt lgkmcnt(4)
    v_mfma_f32_32x32x16_bf16 v[96:111], v[152:155], v[8:11], v[96:111]
    ds_read_b128 v[172:175], v183 offset:7168
    buffer_load_dwordx4 v187, s[8:11], s33 offen offset:0 lds
    v_max3_f32 v192, v192, v122, v123
    v_max3_f32 v193, v193, v124, v125
    v_max3_f32 v192, v192, v126, v127
    s_waitcnt lgkmcnt(4)
    v_mfma_f32_32x32x16_bf16 v[96:111], v[156:159], v[12:15], v[96:111]
    ds_read_b128 v[144:147], v184 offset:0
    v_max_f32 v192, v192, v193
    v_mov_b32 v193, v192
    s_nop 1
    v_permlane32_swap_b32 v192, v193
    buffer_load_dwordx4 v187, s[8:11], s33 offen offset:1024 lds
    s_waitcnt lgkmcnt(4)
    v_mfma_f32_32x32x16_bf16 v[96:111], v[160:163], v[16:19], v[96:111]
    ds_read_b128 v[148:151], v184 offset:2048
    v_max_f32 v192, v192, v193
    v_cmp_lt_f32 vcc, s45, v192
    s_mov_b32 s51, 0
    s_nop 1
    s_cmp_lg_u64 vcc, 0
    s_waitcnt lgkmcnt(4)
    v_mfma_f32_32x32x16_bf16 v[96:111], v[164:167], v[20:23], v[96:111]
    ds_read_b128 v[152:155], v184 offset:4096
    s_cbranch_scc1 Lattn_slow5
Lattn_back5:
    buffer_load_dwordx4 v187, s[8:11], s33 offen offset:2048 lds
    v_exp_f32 v112, v112
    s_waitcnt lgkmcnt(4)
    v_mfma_f32_32x32x16_bf16 v[96:111], v[168:171], v[24:27], v[96:111]
    ds_read_b128 v[156:159], v184 offset:6144
    v_exp_f32 v113, v113
    v_exp_f32 v114, v114
    v_exp_f32 v115, v115
    v_exp_f32 v116, v116
    s_waitcnt lgkmcnt(4)
    v_mfma_f32_32x32x16_bf16 v[96:111], v[172:175], v[28:31], v[96:111]
    ds_read_b128 v[160:163], v184 offset:1024
    v_exp_f32 v117, v117
    buffer_load_dwordx4 v187, s[8:11], s33 offen offset:3072 lds
    v_exp_f32 v118, v118
    v_exp_f32 v119, v119
    s_cmp_eq_u32 s50, 0
    s_cbranch_scc1 Lattn_rs7
    v_mul_f32 v32, v32, v180
    v_mul_f32 v33, v33, v180
    v_mul_f32 v34, v34, v180
    v_mul_f32 v35, v35, v180
    v_mul_f32 v36, v36, v180
    v_mul_f32 v37, v37, v180
    v_mul_f32 v38, v38, v180
    v_mul_f32 v39, v39, v180
    v_mul_f32 v40, v40, v180
    v_mul_f32 v41, v41, v180
    v_mul_f32 v42, v42, v180
    v_mul_f32 v43, v43, v180
    v_mul_f32 v44, v44, v180
    v_mul_f32 v45, v45, v180
    v_mul_f32 v46, v46, v180
    v_mul_f32 v47, v47, v180
    v_mul_f32 v48, v48, v180
    v_mul_f32 v49, v49, v180
    v_mul_f32 v50, v50, v180
    v_mul_f32 v51, v51, v180
    v_mul_f32 v52, v52, v180
    v_mul_f32 v53, v53, v180
    v_mul_f32 v54, v54, v180
    v_mul_f32 v55, v55, v180
    v_mul_f32 v56, v56, v180
    v_mul_f32 v57, v57, v180
    v_mul_f32 v58, v58, v180
    v_mul_f32 v59, v59, v180
    v_mul_f32 v60, v60, v180
    v_mul_f32 v61, v61, v180
    v_mul_f32 v62, v62, v180
    v_mul_f32 v63, v63, v180
    v_mul_f32 v64, v64, v180
    v_mul_f32 v65, v65, v180
    v_mul_f32 v66, v66, v180
    v_mul_f32 v67, v67, v180
    v_mul_f32 v68, v68, v180
    v_mul_f32 v69, v69, v180
    v_mul_f32 v70, v70, v180
    v_mul_f32 v71, v71, v180
    v_mul_f32 v72, v72, v180
    v_mul_f32 v73, v73, v180
    v_mul_f32 v74, v74, v180
    v_mul_f32 v75, v75, v180
    v_mul_f32 v76, v76, v180
    v_mul_f32 v77, v77, v180
    v_mul_f32 v78, v78, v180
    v_mul_f32 v79, v79, v180
    v_mul_f32 v80, v80, v180
    v_mul_f32 v81, v81, v180
    v_mul_f32 v82, v82, v180
    v_mul_f32 v83, v83, v180
    v_mul_f32 v84, v84, v180
    v_mul_f32 v85, v85, v180
    v_mul_f32 v86, v86, v180
    v_mul_f32 v87, v87, v180
    v_mul_f32 v88, v88, v180
    v_mul_f32 v89, v89, v180
    v_mul_f32 v90, v90, v180
    v_mul_f32 v91, v91, v180
    v_mul_f32 v92, v92, v180
    v_mul_f32 v93, v93, v180
    v_mul_f32 v94, v94, v180
    v_mul_f32 v95, v95, v180
Lattn_rs7:
    s_sub_u32 s3, s37, s35
    s_cmp_ge_u32 s37, s35
    s_cselect_b32 s3, s3, s37
    s_lshl_b32 s31, s3, 15
    s_cmp_ge_u32 s37, 17
    s_cselect_b32 s31, 0x7f000000, s31
    s_and_b32 s4, s37, 1
    s_lshl_b32 s4, s4, 15
    s_add_u32 s4, s4, s32
    s_add_u32 m0, s4, 65536
    s_add_u32 s37, s37, 1
    s_waitcnt lgkmcnt(4)
    v_mfma_f32_32x32x16_bf16 v[32:47], v[144:147], v[128:131], v[32:47]
    ds_read_b128 v[164:167], v184 offset:3072
    v_exp_f32 v120, v120
    v_exp_f32 v121, v121
    v_exp_f32 v122, v122
    v_exp_f32 v123, v123
    s_waitcnt lgkmcnt(4)
    v_mfma_f32_32x32x16_bf16 v[48:63], v[148:151], v[128:131], v[48:63]
    ds_read_b128 v[168:171], v184 offset:5120
    v_exp_f32 v124, v124
    v_exp_f32 v125, v125
    v_exp_f32 v126, v126
    v_exp_f32 v127, v127
    buffer_load_dwordx4 v187, s[12:15], s31 offen offset:0 lds
    s_waitcnt lgkmcnt(4)
    v_mfma_f32_32x32x16_bf16 v[64:79], v[152:155], v[128:131], v[64:79]
    ds_read_b128 v[172:175], v184 offset:7168
    v_add_f32 v179, v179, v112
    v_add_f32 v178, v178, v113
    v_cvt_pk_bf16_f32 v136, v112, v113
    v_add_f32 v179, v179, v114
    s_waitcnt lgkmcnt(4)
    v_mfma_f32_32x32x16_bf16 v[80:95], v[156:159], v[128:131], v[80:95]
    ds_read_b128 v[144:147], v183 offset:8192
    v_add_f32 v178, v178, v115
    v_cvt_pk_bf16_f32 v137, v114, v115
    v_add_f32 v179, v179, v116
    buffer_load_dwordx4 v187, s[12:15], s31 offen offset:1024 lds
    v_add_f32 v178, v178, v117
    s_waitcnt lgkmcnt(4)
    v_mfma_f32_32x32x16_bf16 v[32:47], v[160:163], v[132:135], v[32:47]
    ds_read_b128 v[148:151], v183 offset:9216
    v_cvt_pk_bf16_f32 v138, v116, v117
    v_add_f32 v179, v179, v118
    v_add_f32 v178, v178, v119
    v_cvt_pk_bf16_f32 v139, v118, v119
    s_waitcnt lgkmcnt(4)
    v_mfma_f32_32x32x16_bf16 v[48:63], v[164:167], v[132:135], v[48:63]
    ds_read_b128 v[152:155], v183 offset:10240
    v_add_f32 v179, v179, v120
    v_add_f32 v178, v178, v121
    buffer_load_dwordx4 v187, s[12:15], s31 offen offset:2048 lds
    v_cvt_pk_bf16_f32 v140, v120, v121
    v_add_f32 v179, v179, v122
    s_waitcnt lgkmcnt(4)
    v_mfma_f32_32x32x16_bf16 v[64:79], v[168:171], v[132:135], v[64:79]
    ds_read_b128 v[156:159], v183 offset:11264
    v_add_f32 v178, v178, v123
    v_cvt_pk_bf16_f32 v141, v122, v123
    v_add_f32 v179, v179, v124
    v_add_f32 v178, v178, v125
    s_waitcnt lgkmcnt(4)
    v_mfma_f32_32x32x16_bf16 v[80:95], v[172:175], v[132:135], v[80:95]
    ds_read_b128 v[160:163], v183 offset:12288
    v_cvt_pk_bf16_f32 v142, v124, v125
    buffer_load_dwordx4 v187, s[12:15], s31 offen offset:3072 lds
    v_add_f32 v179, v179, v126
    v_add_f32 v178, v178, v127
    v_cvt_pk_bf16_f32 v143, v126, v127
    v_xor_b32 v182, 0x8000, v182
    v_xor_b32 v183, 0x8000, v183
    v_xor_b32 v184, 0x8000, v184
    v_xor_b32 v185, 0x8000, v185
    s_add_u32 s30, s30, 1
    s_branch Lattn_loop
Lattn_last:
    s_waitcnt lgkmcnt(4)
    v_mfma_f32_32x32x16_bf16 v[112:127], v[144:147], v[0:3], v[208:223]
    ds_read_b128 v[164:167], v182 offset:13312
    s_cmp_lg_u32 s54, 0
    s_cbranch_scc1 Lattn_fix8
Lattn_fixb8:
    v_cmp_gt_i32 vcc, 0, v186
    s_nop 1
    v_cndmask_b32 v96, v96, v189, vcc
    v_cmp_gt_i32 vcc, 1, v186
    s_nop 1
    v_cndmask_b32 v97, v97, v189, vcc
    s_waitcnt lgkmcnt(4)
    v_mfma_f32_32x32x16_bf16 v[112:127], v[148:151], v[4:7], v[112:127]
    ds_read_b128 v[168:171], v182 offset:14336
    v_cmp_gt_i32 vcc, 2, v186
    s_nop 1
    v_cndmask_b32 v98, v98, v189, vcc
    v_cmp_gt_i32 vcc, 3, v186
    s_nop 1
    v_cndmask_b32 v99, v99, v189, vcc
    v_cmp_gt_i32 vcc, 8, v186
    s_nop 1
    v_cndmask_b32 v100, v100, v189, vcc
    v_cmp_gt_i32 vcc, 9, v186
    s_waitcnt lgkmcnt(4)
    v_mfma_f32_32x32x16_bf16 v[112:127], v[152:155], v[8:11], v[112:127]
    ds_read_b128 v[172:175], v182 offset:15360
    v_cndmask_b32 v101, v101, v189, vcc
    v_cmp_gt_i32 vcc, 10, v186
    s_nop 1
    v_cndmask_b32 v102, v102, v189, vcc
    v_cmp_gt_i32 vcc, 11, v186
    s_nop 1
    v_cndmask_b32 v103, v103, v189, vcc
    v_cmp_gt_i32 vcc, 16, v186
    s_nop 1
    v_cndmask_b32 v104, v104, v189, vcc
    v_cmp_gt_i32 vcc, 17, v186
    s_waitcnt lgkmcnt(4)
    v_mfma_f32_32x32x16_bf16 v[112:127], v[156:159], v[12:15], v[112:127]
    ds_read_b128 v[144:147], v185 offset:8192
    v_cndmask_b32 v105, v105, v189, vcc
    v_cmp_gt_i32 vcc, 18, v186
    s_nop 1
    v_cndmask_b32 v106, v106, v189, vcc
    v_cmp_gt_i32 vcc, 19, v186
    s_nop 1
    v_cndmask_b32 v107, v107, v189, vcc
    v_cmp_gt_i32 vcc, 24, v186
    s_nop 1
    v_cndmask_b32 v108, v108, v189, vcc
    s_waitcnt lgkmcnt(4)
    v_mfma_f32_32x32x16_bf16 v[112:127], v[160:163], v[16:19], v[112:127]
    ds_read_b128 v[148:151], v185 offset:10240
    v_cmp_gt_i32 vcc, 25, v186
    s_nop 1
    v_cndmask_b32 v109, v109, v189, vcc
    v_cmp_gt_i32 vcc, 26, v186
    s_nop 1
    v_cndmask_b32 v110, v110, v189, vcc
    v_cmp_gt_i32 vcc, 27, v186
    s_nop 1
    v_cndmask_b32 v111, v111, v189, vcc
    v_max3_f32 v192, v96, v97, v98
    s_waitcnt lgkmcnt(4)
    v_mfma_f32_32x32x16_bf16 v[112:127], v[164:167], v[20:23], v[112:127]
    ds_read_b128 v[152:155], v185 offset:12288
    v_max3_f32 v193, v99, v100, v101
    v_max3_f32 v192, v192, v102, v103
    v_max3_f32 v193, v193, v104, v105
    v_max3_f32 v192, v192, v106, v107
    v_max3_f32 v193, v193, v108, v109
    v_max3_f32 v192, v192, v110, v111
    v_max_f32 v192, v192, v193
    v_mov_b32 v193, v192
    s_waitcnt lgkmcnt(4)
    v_mfma_f32_32x32x16_bf16 v[112:127], v[168:171], v[24:27], v[112:127]
    ds_read_b128 v[156:159], v185 offset:14336
    v_permlane32_swap_b32 v192, v193
    v_max_f32 v192, v192, v193
    v_cmp_lt_f32 vcc, s45, v192
    s_mov_b32 s50, 0
    s_nop 1
    s_cmp_lg_u64 vcc, 0
    s_cbranch_scc1 Lattn_slow8
Lattn_back8:
    s_waitcnt lgkmcnt(4)
    v_mfma_f32_32x32x16_bf16 v[112:127], v[172:175], v[28:31], v[112:127]
    ds_read_b128 v[160:163], v185 offset:9216
    v_exp_f32 v96, v96
    v_exp_f32 v97, v97
    v_exp_f32 v98, v98
    v_exp_f32 v99, v99
    v_exp_f32 v100, v100
    v_exp_f32 v101, v101
    v_exp_f32 v102, v102
    v_exp_f32 v103, v103
    s_cmp_eq_u32 s51, 0
    s_cbranch_scc1 Lattn_rs10
    v_mul_f32 v32, v32, v181
    v_mul_f32 v33, v33, v181
    v_mul_f32 v34, v34, v181
    v_mul_f32 v35, v35, v181
    v_mul_f32 v36, v36, v181
    v_mul_f32 v37, v37, v181
    v_mul_f32 v38, v38, v181
    v_mul_f32 v39, v39, v181
    v_mul_f32 v40, v40, v181
    v_mul_f32 v41, v41, v181
    v_mul_f32 v42, v42, v181
    v_mul_f32 v43, v43, v181
    v_mul_f32 v44, v44, v181
    v_mul_f32 v45, v45, v181
    v_mul_f32 v46, v46, v181
    v_mul_f32 v47, v47, v181
    v_mul_f32 v48, v48, v181
    v_mul_f32 v49, v49, v181
    v_mul_f32 v50, v50, v181
    v_mul_f32 v51, v51, v181
    v_mul_f32 v52, v52, v181
    v_mul_f32 v53, v53, v181
    v_mul_f32 v54, v54, v181
    v_mul_f32 v55, v55, v181
    v_mul_f32 v56, v56, v181
    v_mul_f32 v57, v57, v181
    v_mul_f32 v58, v58, v181
    v_mul_f32 v59, v59, v181
    v_mul_f32 v60, v60, v181
    v_mul_f32 v61, v61, v181
    v_mul_f32 v62, v62, v181
    v_mul_f32 v63, v63, v181
    v_mul_f32 v64, v64, v181
    v_mul_f32 v65, v65, v181
    v_mul_f32 v66, v66, v181
    v_mul_f32 v67, v67, v181
    v_mul_f32 v68, v68, v181
    v_mul_f32 v69, v69, v181
    v_mul_f32 v70, v70, v181
    v_mul_f32 v71, v71, v181
    v_mul_f32 v72, v72, v181
    v_mul_f32 v73, v73, v181
    v_mul_f32 v74, v74, v181
    v_mul_f32 v75, v75, v181
    v_mul_f32 v76, v76, v181
    v_mul_f32 v77, v77, v181
    v_mul_f32 v78, v78, v181
    v_mul_f32 v79, v79, v181
    v_mul_f32 v80, v80, v181
    v_mul_f32 v81, v81, v181
    v_mul_f32 v82, v82, v181
    v_mul_f32 v83, v83, v181
    v_mul_f32 v84, v84, v181
    v_mul_f32 v85, v85, v181
    v_mul_f32 v86, v86, v181
    v_mul_f32 v87, v87, v181
    v_mul_f32 v88, v88, v181
    v_mul_f32 v89, v89, v181
    v_mul_f32 v90, v90, v181
    v_mul_f32 v91, v91, v181
    v_mul_f32 v92, v92, v181
    v_mul_f32 v93, v93, v181
    v_mul_f32 v94, v94, v181
    v_mul_f32 v95, v95, v181
Lattn_rs10:
    s_waitcnt lgkmcnt(4)
    v_mfma_f32_32x32x16_bf16 v[32:47], v[144:147], v[136:139], v[32:47]
    ds_read_b128 v[164:167], v185 offset:11264
    v_exp_f32 v104, v104
    v_exp_f32 v105, v105
    v_exp_f32 v106, v106
    v_exp_f32 v107, v107
    s_waitcnt lgkmcnt(4)
    v_mfma_f32_32x32x16_bf16 v[48:63], v[148:151], v[136:139], v[48:63]
    ds_read_b128 v[168:171], v185 offset:13312
    v_exp_f32 v108, v108
    v_exp_f32 v109, v109
    v_exp_f32 v110, v110
    v_exp_f32 v111, v111
    s_waitcnt lgkmcnt(4)
    v_mfma_f32_32x32x16_bf16 v[64:79], v[152:155], v[136:139], v[64:79]
    ds_read_b128 v[172:175], v185 offset:15360
    v_add_f32 v179, v179, v96
    v_add_f32 v178, v178, v97
    v_cvt_pk_bf16_f32 v128, v96, v97
    v_add_f32 v179, v179, v98
    s_waitcnt lgkmcnt(4)
    v_mfma_f32_32x32x16_bf16 v[80:95], v[156:159], v[136:139], v[80:95]
    v_add_f32 v178, v178, v99
    v_cvt_pk_bf16_f32 v129, v98, v99
    v_add_f32 v179, v179, v100
    v_add_f32 v178, v178, v101
    s_waitcnt lgkmcnt(3)
    v_mfma_f32_32x32x16_bf16 v[32:47], v[160:163], v[140:143], v[32:47]
    v_cvt_pk_bf16_f32 v130, v100, v101
    v_add_f32 v179, v179, v102
    v_add_f32 v178, v178, v103
    v_cvt_pk_bf16_f32 v131, v102, v103
    s_waitcnt lgkmcnt(2)
    v_mfma_f32_32x32x16_bf16 v[48:63], v[164:167], v[140:143], v[48:63]
    v_add_f32 v179, v179, v104
    v_add_f32 v178, v178, v105
    v_cvt_pk_bf16_f32 v132, v104, v105
    v_add_f32 v179, v179, v106
    s_waitcnt lgkmcnt(1)
    v_mfma_f32_32x32x16_bf16 v[64:79], v[168:171], v[140:143], v[64:79]
    v_add_f32 v178, v178, v107
    v_cvt_pk_bf16_f32 v133, v106, v107
    v_add_f32 v179, v179, v108
    v_add_f32 v178, v178, v109
    s_waitcnt lgkmcnt(0)
    v_mfma_f32_32x32x16_bf16 v[80:95], v[172:175], v[140:143], v[80:95]
    v_cvt_pk_bf16_f32 v134, v108, v109
    v_add_f32 v179, v179, v110
    v_add_f32 v178, v178, v111
    v_cvt_pk_bf16_f32 v135, v110, v111
    s_waitcnt vmcnt(0)
    s_barrier
    ds_read_b128 v[144:147], v184 offset:0
    ds_read_b128 v[148:151], v184 offset:2048
    ds_read_b128 v[152:155], v184 offset:4096
    ds_read_b128 v[156:159], v184 offset:6144
    ds_read_b128 v[160:163], v184 offset:1024
    s_cmp_lg_u32 s54, 0
    s_cbranch_scc1 Lattn_fix9
Lattn_fixb9:
    v_cmp_gt_i32 vcc, 32, v186
    s_nop 1
    v_cndmask_b32 v112, v112, v189, vcc
    v_cmp_gt_i32 vcc, 33, v186
    s_nop 1
    v_cndmask_b32 v113, v113, v189, vcc
    v_cmp_gt_i32 vcc, 34, v186
    s_nop 1
    v_cndmask_b32 v114, v114, v189, vcc
    v_cmp_gt_i32 vcc, 35, v186
    s_nop 1
    v_cndmask_b32 v115, v115, v189, vcc
    v_cmp_gt_i32 vcc, 40, v186
    s_nop 1
    v_cndmask_b32 v116, v116, v189, vcc
    v_cmp_gt_i32 vcc, 41, v186
    s_nop 1
    v_cndmask_b32 v117, v117, v189, vcc
    v_cmp_gt_i32 vcc, 42, v186
    s_nop 1
    v_cndmask_b32 v118, v118, v189, vcc
    v_cmp_gt_i32 vcc, 43, v186
    s_nop 1
    v_cndmask_b32 v119, v119, v189, vcc
    v_cmp_gt_i32 vcc, 48, v186
    s_nop 1
    v_cndmask_b32 v120, v120, v189, vcc
    v_cmp_gt_i32 vcc, 49, v186
    s_nop 1
    v_cndmask_b32 v121, v121, v189, vcc
    v_cmp_gt_i32 vcc, 50, v186
    s_nop 1
    v_cndmask_b32 v122, v122, v189, vcc
    v_cmp_gt_i32 vcc, 51, v186
    s_nop 1
    v_cndmask_b32 v123, v123, v189, vcc
    v_cmp_gt_i32 vcc, 56, v186
    s_nop 1
    v_cndmask_b32 v124, v124, v189, vcc
    v_cmp_gt_i32 vcc, 57, v186
    s_nop 1
    v_cndmask_b32 v125, v125, v189, vcc
    v_cmp_gt_i32 vcc, 58, v186
    s_nop 1
    v_cndmask_b32 v126, v126, v189, vcc
    v_cmp_gt_i32 vcc, 59, v186
    s_nop 1
    v_cndmask_b32 v127, v127, v189, vcc
    v_max3_f32 v192, v112, v113, v114
    v_max3_f32 v193, v115, v116, v117
    v_max3_f32 v192, v192, v118, v119
    v_max3_f32 v193, v193, v120, v121
    v_max3_f32 v192, v192, v122, v123
    v_max3_f32 v193, v193, v124, v125
    v_max3_f32 v192, v192, v126, v127
    v_max_f32 v192, v192, v193
    v_mov_b32 v193, v192
    s_nop 1
    v_permlane32_swap_b32 v192, v193
    v_max_f32 v192, v192, v193
    v_cmp_lt_f32 vcc, s45, v192
    s_mov_b32 s51, 0
    s_nop 1
    s_cmp_lg_u64 vcc, 0
    s_cbranch_scc1 Lattn_slow9
Lattn_back9:
    v_exp_f32 v112, v112
    v_exp_f32 v113, v113
    v_exp_f32 v114, v114
    v_exp_f32 v115, v115
    v_exp_f32 v116, v116
    v_exp_f32 v117, v117
    v_exp_f32 v118, v118
    v_exp_f32 v119, v119
    s_cmp_eq_u32 s50, 0
    s_cbranch_scc1 Lattn_rs11
    v_mul_f32 v32, v32, v180
    v_mul_f32 v33, v33, v180
    v_mul_f32 v34, v34, v180
    v_mul_f32 v35, v35, v180
    v_mul_f32 v36, v36, v180
    v_mul_f32 v37, v37, v180
    v_mul_f32 v38, v38, v180
    v_mul_f32 v39, v39, v180
    v_mul_f32 v40, v40, v180
    v_mul_f32 v41, v41, v180
    v_mul_f32 v42, v42, v180
    v_mul_f32 v43, v43, v180
    v_mul_f32 v44, v44, v180
    v_mul_f32 v45, v45, v180
    v_mul_f32 v46, v46, v180
    v_mul_f32 v47, v47, v180
    v_mul_f32 v48, v48, v180
    v_mul_f32 v49, v49, v180
    v_mul_f32 v50, v50, v180
    v_mul_f32 v51, v51, v180
    v_mul_f32 v52, v52, v180
    v_mul_f32 v53, v53, v180
    v_mul_f32 v54, v54, v180
    v_mul_f32 v55, v55, v180
    v_mul_f32 v56, v56, v180
    v_mul_f32 v57, v57, v180
    v_mul_f32 v58, v58, v180
    v_mul_f32 v59, v59, v180
    v_mul_f32 v60, v60, v180
    v_mul_f32 v61, v61, v180
    v_mul_f32 v62, v62, v180
    v_mul_f32 v63, v63, v180
    v_mul_f32 v64, v64, v180
    v_mul_f32 v65, v65, v180
    v_mul_f32 v66, v66, v180
    v_mul_f32 v67, v67, v180
    v_mul_f32 v68, v68, v180
    v_mul_f32 v69, v69, v180
    v_mul_f32 v70, v70, v180
    v_mul_f32 v71, v71, v180
    v_mul_f32 v72, v72, v180
    v_mul_f32 v73, v73, v180
    v_mul_f32 v74, v74, v180
    v_mul_f32 v75, v75, v180
    v_mul_f32 v76, v76, v180
    v_mul_f32 v77, v77, v180
    v_mul_f32 v78, v78, v180
    v_mul_f32 v79, v79, v180
    v_mul_f32 v80, v80, v180
    v_mul_f32 v81, v81, v180
    v_mul_f32 v82, v82, v180
    v_mul_f32 v83, v83, v180
    v_mul_f32 v84, v84, v180
    v_mul_f32 v85, v85, v180
    v_mul_f32 v86, v86, v180
    v_mul_f32 v87, v87, v180
    v_mul_f32 v88, v88, v180
    v_mul_f32 v89, v89, v180
    v_mul_f32 v90, v90, v180
    v_mul_f32 v91, v91, v180
    v_mul_f32 v92, v92, v180
    v_mul_f32 v93, v93, v180
    v_mul_f32 v94, v94, v180
    v_mul_f32 v95, v95, v180
Lattn_rs11:
    s_sub_u32 s3, s37, s35
    s_cmp_ge_u32 s37, s35
    s_cselect_b32 s3, s3, s37
    s_lshl_b32 s31, s3, 15
    s_cmp_ge_u32 s37, 17
    s_cselect_b32 s31, 0x7f000000, s31
    s_and_b32 s4, s37, 1
    s_lshl_b32 s4, s4, 15
    s_add_u32 s4, s4, s32
    s_add_u32 m0, s4, 65536
    s_add_u32 s37, s37, 1
    s_waitcnt lgkmcnt(4)
    v_mfma_f32_32x32x16_bf16 v[32:47], v[144:147], v[128:131], v[32:47]
    ds_read_b128 v[164:167], v184 offset:3072
    v_exp_f32 v120, v120
    v_exp_f32 v121, v121
    v_exp_f32 v122, v122
    v_exp_f32 v123, v123
    s_waitcnt lgkmcnt(4)
    v_mfma_f32_32x32x16_bf16 v[48:63], v[148:151], v[128:131], v[48:63]
    ds_read_b128 v[168:171], v184 offset:5120
    v_exp_f32 v124, v124
    v_exp_f32 v125, v125
    v_exp_f32 v126, v126
    v_exp_f32 v127, v127
    buffer_load_dwordx4 v187, s[12:15], s31 offen offset:0 lds
    s_waitcnt lgkmcnt(4)
    v_mfma_f32_32x32x16_bf16 v[64:79], v[152:155], v[128:131], v[64:79]
    ds_read_b128 v[172:175], v184 offset:7168
    v_add_f32 v179, v179, v112
    v_add_f32 v178, v178, v113
    v_cvt_pk_bf16_f32 v136, v112, v113
    v_add_f32 v179, v179, v114
    s_waitcnt lgkmcnt(4)
    v_mfma_f32_32x32x16_bf16 v[80:95], v[156:159], v[128:131], v[80:95]
    ds_read_b128 v[144:147], v184 offset:8192
    v_add_f32 v178, v178, v115
    v_cvt_pk_bf16_f32 v137, v114, v115
    v_add_f32 v179, v179, v116
    buffer_load_dwordx4 v187, s[12:15], s31 offen offset:1024 lds
    v_add_f32 v178, v178, v117
    s_waitcnt lgkmcnt(4)
    v_mfma_f32_32x32x16_bf16 v[32:47], v[160:163], v[132:135], v[32:47]
    ds_read_b128 v[148:151], v184 offset:10240
    v_cvt_pk_bf16_f32 v138, v116, v117
    v_add_f32 v179, v179, v118
    v_add_f32 v178, v178, v119
    v_cvt_pk_bf16_f32 v139, v118, v119
    s_waitcnt lgkmcnt(4)
    v_mfma_f32_32x32x16_bf16 v[48:63], v[164:167], v[132:135], v[48:63]
    ds_read_b128 v[152:155], v184 offset:12288
    v_add_f32 v179, v179, v120
    v_add_f32 v178, v178, v121
    buffer_load_dwordx4 v187, s[12:15], s31 offen offset:2048 lds
    v_cvt_pk_bf16_f32 v140, v120, v121
    v_add_f32 v179, v179, v122
    s_waitcnt lgkmcnt(4)
    v_mfma_f32_32x32x16_bf16 v[64:79], v[168:171], v[132:135], v[64:79]
    ds_read_b128 v[156:159], v184 offset:14336
    v_add_f32 v178, v178, v123
    v_cvt_pk_bf16_f32 v141, v122, v123
    v_add_f32 v179, v179, v124
    v_add_f32 v178, v178, v125
    s_waitcnt lgkmcnt(4)
    v_mfma_f32_32x32x16_bf16 v[80:95], v[172:175], v[132:135], v[80:95]
    ds_read_b128 v[160:163], v184 offset:9216
    v_cvt_pk_bf16_f32 v142, v124, v125
    buffer_load_dwordx4 v187, s[12:15], s31 offen offset:3072 lds
    v_add_f32 v179, v179, v126
    v_add_f32 v178, v178, v127
    v_cvt_pk_bf16_f32 v143, v126, v127
    s_cmp_eq_u32 s51, 0
    s_cbranch_scc1 Lattn_rs12
    v_mul_f32 v32, v32, v181
    v_mul_f32 v33, v33, v181
    v_mul_f32 v34, v34, v181
    v_mul_f32 v35, v35, v181
    v_mul_f32 v36, v36, v181
    v_mul_f32 v37, v37, v181
    v_mul_f32 v38, v38, v181
    v_mul_f32 v39, v39, v181
    v_mul_f32 v40, v40, v181
    v_mul_f32 v41, v41, v181
    v_mul_f32 v42, v42, v181
    v_mul_f32 v43, v43, v181
    v_mul_f32 v44, v44, v181
    v_mul_f32 v45, v45, v181
    v_mul_f32 v46, v46, v181
    v_mul_f32 v47, v47, v181
    v_mul_f32 v48, v48, v181
    v_mul_f32 v49, v49, v181
    v_mul_f32 v50, v50, v181
    v_mul_f32 v51, v51, v181
    v_mul_f32 v52, v52, v181
    v_mul_f32 v53, v53, v181
    v_mul_f32 v54, v54, v181
    v_mul_f32 v55, v55, v181
    v_mul_f32 v56, v56, v181
    v_mul_f32 v57, v57, v181
    v_mul_f32 v58, v58, v181
    v_mul_f32 v59, v59, v181
    v_mul_f32 v60, v60, v181
    v_mul_f32 v61, v61, v181
    v_mul_f32 v62, v62, v181
    v_mul_f32 v63, v63, v181
    v_mul_f32 v64, v64, v181
    v_mul_f32 v65, v65, v181
    v_mul_f32 v66, v66, v181
    v_mul_f32 v67, v67, v181
    v_mul_f32 v68, v68, v181
    v_mul_f32 v69, v69, v181
    v_mul_f32 v70, v70, v181
    v_mul_f32 v71, v71, v181
    v_mul_f32 v72, v72, v181
    v_mul_f32 v73, v73, v181
    v_mul_f32 v74, v74, v181
    v_mul_f32 v75, v75, v181
    v_mul_f32 v76, v76, v181
    v_mul_f32 v77, v77, v181
    v_mul_f32 v78, v78, v181
    v_mul_f32 v79, v79, v181
    v_mul_f32 v80, v80, v181
    v_mul_f32 v81, v81, v181
    v_mul_f32 v82, v82, v181
    v_mul_f32 v83, v83, v181
    v_mul_f32 v84, v84, v181
    v_mul_f32 v85, v85, v181
    v_mul_f32 v86, v86, v181
    v_mul_f32 v87, v87, v181
    v_mul_f32 v88, v88, v181
    v_mul_f32 v89, v89, v181
    v_mul_f32 v90, v90, v181
    v_mul_f32 v91, v91, v181
    v_mul_f32 v92, v92, v181
    v_mul_f32 v93, v93, v181
    v_mul_f32 v94, v94, v181
    v_mul_f32 v95, v95, v181
Lattn_rs12:
    s_waitcnt lgkmcnt(4)
    v_mfma_f32_32x32x16_bf16 v[32:47], v[144:147], v[136:139], v[32:47]
    ds_read_b128 v[164:167], v184 offset:11264
    s_waitcnt lgkmcnt(4)
    v_mfma_f32_32x32x16_bf16 v[48:63], v[148:151], v[136:139], v[48:63]
    ds_read_b128 v[168:171], v184 offset:13312
    s_waitcnt lgkmcnt(4)
    v_mfma_f32_32x32x16_bf16 v[64:79], v[152:155], v[136:139], v[64:79]
    ds_read_b128 v[172:175], v184 offset:15360
    s_waitcnt lgkmcnt(4)
    v_mfma_f32_32x32x16_bf16 v[80:95], v[156:159], v[136:139], v[80:95]
    s_waitcnt lgkmcnt(3)
    v_mfma_f32_32x32x16_bf16 v[32:47], v[160:163], v[140:143], v[32:47]
    s_waitcnt lgkmcnt(2)
    v_mfma_f32_32x32x16_bf16 v[48:63], v[164:167], v[140:143], v[48:63]
    s_waitcnt lgkmcnt(1)
    v_mfma_f32_32x32x16_bf16 v[64:79], v[168:171], v[140:143], v[64:79]
    s_waitcnt lgkmcnt(0)
    v_mfma_f32_32x32x16_bf16 v[80:95], v[172:175], v[140:143], v[80:95]
    s_branch Lattn_fin
Lattn_only:
    s_waitcnt lgkmcnt(4)
    v_mfma_f32_32x32x16_bf16 v[112:127], v[144:147], v[0:3], v[208:223]
    ds_read_b128 v[164:167], v182 offset:13312
    v_cmp_gt_i32 vcc, 0, v186
    s_nop 4
    v_cndmask_b32 v96, v96, v189, vcc
    v_cmp_gt_i32 vcc, 1, v186
    s_nop 1
    v_cndmask_b32 v97, v97, v189, vcc
    v_cmp_gt_i32 vcc, 2, v186
    s_nop 1
    v_cndmask_b32 v98, v98, v189, vcc
    s_waitcnt lgkmcnt(4)
    v_mfma_f32_32x32x16_bf16 v[112:127], v[148:151], v[4:7], v[112:127]
    ds_read_b128 v[168:171], v182 offset:14336
    v_cmp_gt_i32 vcc, 3, v186
    s_nop 1
    v_cndmask_b32 v99, v99, v189, vcc
    v_cmp_gt_i32 vcc, 8, v186
    s_nop 1
    v_cndmask_b32 v100, v100, v189, vcc
    v_cmp_gt_i32 vcc, 9, v186
    s_nop 1
    v_cndmask_b32 v101, v101, v189, vcc
    v_cmp_gt_i32 vcc, 10, v186
    s_waitcnt lgkmcnt(4)
    v_mfma_f32_32x32x16_bf16 v[112:127], v[152:155], v[8:11], v[112:127]
    ds_read_b128 v[172:175], v182 offset:15360
    v_cndmask_b32 v102, v102, v189, vcc
    v_cmp_gt_i32 vcc, 11, v186
    s_nop 1
    v_cndmask_b32 v103, v103, v189, vcc
    v_cmp_gt_i32 vcc, 16, v186
    s_nop 1
    v_cndmask_b32 v104, v104, v189, vcc
    v_cmp_gt_i32 vcc, 17, v186
    s_waitcnt lgkmcnt(4)
    v_mfma_f32_32x32x16_bf16 v[112:127], v[156:159], v[12:15], v[112:127]
    v_cndmask_b32 v105, v105, v189, vcc
    v_cmp_gt_i32 vcc, 18, v186
    s_nop 1
    v_cndmask_b32 v106, v106, v189, vcc
    v_cmp_gt_i32 vcc, 19, v186
    s_nop 1
    v_cndmask_b32 v107, v107, v189, vcc
    v_cmp_gt_i32 vcc, 24, v186
    s_nop 1
    v_cndmask_b32 v108, v108, v189, vcc
    s_waitcnt lgkmcnt(3)
    v_mfma_f32_32x32x16_bf16 v[112:127], v[160:163], v[16:19], v[112:127]
    v_cmp_gt_i32 vcc, 25, v186
    s_nop 1
    v_cndmask_b32 v109, v109, v189, vcc
    v_cmp_gt_i32 vcc, 26, v186
    s_nop 1
    v_cndmask_b32 v110, v110, v189, vcc
    v_cmp_gt_i32 vcc, 27, v186
    s_nop 1
    v_cndmask_b32 v111, v111, v189, vcc
    v_max3_f32 v192, v96, v97, v98
    s_waitcnt lgkmcnt(2)
    v_mfma_f32_32x32x16_bf16 v[112:127], v[164:167], v[20:23], v[112:127]
    v_max3_f32 v193, v99, v100, v101
    v_max3_f32 v192, v192, v102, v103
    v_max3_f32 v193, v193, v104, v105
    v_max3_f32 v192, v192, v106, v107
    v_max3_f32 v193, v193, v108, v109
    v_max3_f32 v192, v192, v110, v111
    s_waitcnt lgkmcnt(1)
    v_mfma_f32_32x32x16_bf16 v[112:127], v[168:171], v[24:27], v[112:127]
    v_max_f32 v192, v192, v193
    v_mov_b32 v193, v192
    s_nop 1
    v_permlane32_swap_b32 v192, v193
    v_max_f32 v192, v192, v193
    s_branch Lattn_slow13
Lattn_back13:
    v_exp_f32 v96, v96
    s_waitcnt lgkmcnt(0)
    v_mfma_f32_32x32x16_bf16 v[112:127], v[172:175], v[28:31], v[112:127]
    v_exp_f32 v97, v97
    v_exp_f32 v98, v98
    v_exp_f32 v99, v99
    v_exp_f32 v100, v100
    v_exp_f32 v101, v101
    v_exp_f32 v102, v102
    v_exp_f32 v103, v103
    v_exp_f32 v104, v104
    v_exp_f32 v105, v105
    v_exp_f32 v106, v106
    v_exp_f32 v107, v107
    v_exp_f32 v108, v108
    v_exp_f32 v109, v109
    v_exp_f32 v110, v110
    v_exp_f32 v111, v111
    v_add_f32 v179, v179, v96
    v_add_f32 v178, v178, v97
    v_cvt_pk_bf16_f32 v128, v96, v97
    v_add_f32 v179, v179, v98
    v_add_f32 v178, v178, v99
    v_cvt_pk_bf16_f32 v129, v98, v99
    v_add_f32 v179, v179, v100
    v_add_f32 v178, v178, v101
    v_cvt_pk_bf16_f32 v130, v100, v101
    v_add_f32 v179, v179, v102
    v_add_f32 v178, v178, v103
    v_cvt_pk_bf16_f32 v131, v102, v103
    v_add_f32 v179, v179, v104
    v_add_f32 v178, v178, v105
    v_cvt_pk_bf16_f32 v132, v104, v105
    v_add_f32 v179, v179, v106
    v_add_f32 v178, v178, v107
    v_cvt_pk_bf16_f32 v133, v106, v107
    v_add_f32 v179, v179, v108
    v_add_f32 v178, v178, v109
    v_cvt_pk_bf16_f32 v134, v108, v109
    v_add_f32 v179, v179, v110
    v_add_f32 v178, v178, v111
    v_cvt_pk_bf16_f32 v135, v110, v111
    s_waitcnt vmcnt(0)
    s_barrier
    ds_read_b128 v[144:147], v184 offset:0
    ds_read_b128 v[148:151], v184 offset:2048
    ds_read_b128 v[152:155], v184 offset:4096
    ds_read_b128 v[156:159], v184 offset:6144
    ds_read_b128 v[160:163], v184 offset:1024
    s_cmp_lg_u32 s54, 0
    s_cbranch_scc1 Lattn_fix14
Lattn_fixb14:
    v_cmp_gt_i32 vcc, 32, v186
    s_nop 1
    v_cndmask_b32 v112, v112, v189, vcc
    v_cmp_gt_i32 vcc, 33, v186
    s_nop 1
    v_cndmask_b32 v113, v113, v189, vcc
    v_cmp_gt_i32 vcc, 34, v186
    s_nop 1
    v_cndmask_b32 v114, v114, v189, vcc
    v_cmp_gt_i32 vcc, 35, v186
    s_nop 1
    v_cndmask_b32 v115, v115, v189, vcc
    v_cmp_gt_i32 vcc, 40, v186
    s_nop 1
    v_cndmask_b32 v116, v116, v189, vcc
    v_cmp_gt_i32 vcc, 41, v186
    s_nop 1
    v_cndmask_b32 v117, v117, v189, vcc
    v_cmp_gt_i32 vcc, 42, v186
    s_nop 1
    v_cndmask_b32 v118, v118, v189, vcc
    v_cmp_gt_i32 vcc, 43, v186
    s_nop 1
    v_cndmask_b32 v119, v119, v189, vcc
    v_cmp_gt_i32 vcc, 48, v186
    s_nop 1
    v_cndmask_b32 v120, v120, v189, vcc
    v_cmp_gt_i32 vcc, 49, v186
    s_nop 1
    v_cndmask_b32 v121, v121, v189, vcc
    v_cmp_gt_i32 vcc, 50, v186
    s_nop 1
    v_cndmask_b32 v122, v122, v189, vcc
    v_cmp_gt_i32 vcc, 51, v186
    s_nop 1
    v_cndmask_b32 v123, v123, v189, vcc
    v_cmp_gt_i32 vcc, 56, v186
    s_nop 1
    v_cndmask_b32 v124, v124, v189, vcc
    v_cmp_gt_i32 vcc, 57, v186
    s_nop 1
    v_cndmask_b32 v125, v125, v189, vcc
    v_cmp_gt_i32 vcc, 58, v186
    s_nop 1
    v_cndmask_b32 v126, v126, v189, vcc
    v_cmp_gt_i32 vcc, 59, v186
    s_nop 1
    v_cndmask_b32 v127, v127, v189, vcc
    v_max3_f32 v192, v112, v113, v114
    v_max3_f32 v193, v115, v116, v117
    v_max3_f32 v192, v192, v118, v119
    v_max3_f32 v193, v193, v120, v121
    v_max3_f32 v192, v192, v122, v123
    v_max3_f32 v193, v193, v124, v125
    v_max3_f32 v192, v192, v126, v127
    v_max_f32 v192, v192, v193
    v_mov_b32 v193, v192
    s_nop 1
    v_permlane32_swap_b32 v192, v193
    v_max_f32 v192, v192, v193
    v_cmp_lt_f32 vcc, s45, v192
    s_mov_b32 s51, 0
    s_nop 1
    s_cmp_lg_u64 vcc, 0
    s_cbranch_scc1 Lattn_slow14
Lattn_back14:
    v_exp_f32 v112, v112
    v_exp_f32 v113, v113
    v_exp_f32 v114, v114
    v_exp_f32 v115, v115
    v_exp_f32 v116, v116
    v_exp_f32 v117, v117
    v_exp_f32 v118, v118
    v_exp_f32 v119, v119
    s_cmp_eq_u32 s50, 0
    s_cbranch_scc1 Lattn_rs15
    v_mul_f32 v32, v32, v180
    v_mul_f32 v33, v33, v180
    v_mul_f32 v34, v34, v180
    v_mul_f32 v35, v35, v180
    v_mul_f32 v36, v36, v180
    v_mul_f32 v37, v37, v180
    v_mul_f32 v38, v38, v180
    v_mul_f32 v39, v39, v180
    v_mul_f32 v40, v40, v180
    v_mul_f32 v41, v41, v180
    v_mul_f32 v42, v42, v180
    v_mul_f32 v43, v43, v180
    v_mul_f32 v44, v44, v180
    v_mul_f32 v45, v45, v180
    v_mul_f32 v46, v46, v180
    v_mul_f32 v47, v47, v180
    v_mul_f32 v48, v48, v180
    v_mul_f32 v49, v49, v180
    v_mul_f32 v50, v50, v180
    v_mul_f32 v51, v51, v180
    v_mul_f32 v52, v52, v180
    v_mul_f32 v53, v53, v180
    v_mul_f32 v54, v54, v180
    v_mul_f32 v55, v55, v180
    v_mul_f32 v56, v56, v180
    v_mul_f32 v57, v57, v180
    v_mul_f32 v58, v58, v180
    v_mul_f32 v59, v59, v180
    v_mul_f32 v60, v60, v180
    v_mul_f32 v61, v61, v180
    v_mul_f32 v62, v62, v180
    v_mul_f32 v63, v63, v180
    v_mul_f32 v64, v64, v180
    v_mul_f32 v65, v65, v180
    v_mul_f32 v66, v66, v180
    v_mul_f32 v67, v67, v180
    v_mul_f32 v68, v68, v180
    v_mul_f32 v69, v69, v180
    v_mul_f32 v70, v70, v180
    v_mul_f32 v71, v71, v180
    v_mul_f32 v72, v72, v180
    v_mul_f32 v73, v73, v180
    v_mul_f32 v74, v74, v180
    v_mul_f32 v75, v75, v180
    v_mul_f32 v76, v76, v180
    v_mul_f32 v77, v77, v180
    v_mul_f32 v78, v78, v180
    v_mul_f32 v79, v79, v180
    v_mul_f32 v80, v80, v180
    v_mul_f32 v81, v81, v180
    v_mul_f32 v82, v82, v180
    v_mul_f32 v83, v83, v180
    v_mul_f32 v84, v84, v180
    v_mul_f32 v85, v85, v180
    v_mul_f32 v86, v86, v180
    v_mul_f32 v87, v87, v180
    v_mul_f32 v88, v88, v180
    v_mul_f32 v89, v89, v180
    v_mul_f32 v90, v90, v180
    v_mul_f32 v91, v91, v180
    v_mul_f32 v92, v92, v180
    v_mul_f32 v93, v93, v180
    v_mul_f32 v94, v94, v180
    v_mul_f32 v95, v95, v180
Lattn_rs15:
    s_sub_u32 s3, s37, s35
    s_cmp_ge_u32 s37, s35
    s_cselect_b32 s3, s3, s37
    s_lshl_b32 s31, s3, 15
    s_cmp_ge_u32 s37, 17
    s_cselect_b32 s31, 0x7f000000, s31
    s_and_b32 s4, s37, 1
    s_lshl_b32 s4, s4, 15
    s_add_u32 s4, s4, s32
    s_add_u32 m0, s4, 65536
    s_add_u32 s37, s37, 1
    s_waitcnt lgkmcnt(4)
    v_mfma_f32_32x32x16_bf16 v[32:47], v[144:147], v[128:131], v[32:47]
    ds_read_b128 v[164:167], v184 offset:3072
    v_exp_f32 v120, v120
    v_exp_f32 v121, v121
    v_exp_f32 v122, v122
    v_exp_f32 v123, v123
    s_waitcnt lgkmcnt(4)
    v_mfma_f32_32x32x16_bf16 v[48:63], v[148:151], v[128:131], v[48:63]
    ds_read_b128 v[168:171], v184 offset:5120
    v_exp_f32 v124, v124
    v_exp_f32 v125, v125
    v_exp_f32 v126, v126
    v_exp_f32 v127, v127
    buffer_load_dwordx4 v187, s[12:15], s31 offen offset:0 lds
    s_waitcnt lgkmcnt(4)
    v_mfma_f32_32x32x16_bf16 v[64:79], v[152:155], v[128:131], v[64:79]
    ds_read_b128 v[172:175], v184 offset:7168
    v_add_f32 v179, v179, v112
    v_add_f32 v178, v178, v113
    v_cvt_pk_bf16_f32 v136, v112, v113
    v_add_f32 v179, v179, v114
    s_waitcnt lgkmcnt(4)
    v_mfma_f32_32x32x16_bf16 v[80:95], v[156:159], v[128:131], v[80:95]
    ds_read_b128 v[144:147], v184 offset:8192
    v_add_f32 v178, v178, v115
    v_cvt_pk_bf16_f32 v137, v114, v115
    v_add_f32 v179, v179, v116
    buffer_load_dwordx4 v187, s[12:15], s31 offen offset:1024 lds
    v_add_f32 v178, v178, v117
    s_waitcnt lgkmcnt(4)
    v_mfma_f32_32x32x16_bf16 v[32:47], v[160:163], v[132:135], v[32:47]
    ds_read_b128 v[148:151], v184 offset:10240
    v_cvt_pk_bf16_f32 v138, v116, v117
    v_add_f32 v179, v179, v118
    v_add_f32 v178, v178, v119
    v_cvt_pk_bf16_f32 v139, v118, v119
    s_waitcnt lgkmcnt(4)
    v_mfma_f32_32x32x16_bf16 v[48:63], v[164:167], v[132:135], v[48:63]
    ds_read_b128 v[152:155], v184 offset:12288
    v_add_f32 v179, v179, v120
    v_add_f32 v178, v178, v121
    buffer_load_dwordx4 v187, s[12:15], s31 offen offset:2048 lds
    v_cvt_pk_bf16_f32 v140, v120, v121
    v_add_f32 v179, v179, v122
    s_waitcnt lgkmcnt(4)
    v_mfma_f32_32x32x16_bf16 v[64:79], v[168:171], v[132:135], v[64:79]
    ds_read_b128 v[156:159], v184 offset:14336
    v_add_f32 v178, v178, v123
    v_cvt_pk_bf16_f32 v141, v122, v123
    v_add_f32 v179, v179, v124
    v_add_f32 v178, v178, v125
    s_waitcnt lgkmcnt(4)
    v_mfma_f32_32x32x16_bf16 v[80:95], v[172:175], v[132:135], v[80:95]
    ds_read_b128 v[160:163], v184 offset:9216
    v_cvt_pk_bf16_f32 v142, v124, v125
    buffer_load_dwordx4 v187, s[12:15], s31 offen offset:3072 lds
    v_add_f32 v179, v179, v126
    v_add_f32 v178, v178, v127
    v_cvt_pk_bf16_f32 v143, v126, v127
    s_cmp_eq_u32 s51, 0
    s_cbranch_scc1 Lattn_rs16
    v_mul_f32 v32, v32, v181
    v_mul_f32 v33, v33, v181
    v_mul_f32 v34, v34, v181
    v_mul_f32 v35, v35, v181
    v_mul_f32 v36, v36, v181
    v_mul_f32 v37, v37, v181
    v_mul_f32 v38, v38, v181
    v_mul_f32 v39, v39, v181
    v_mul_f32 v40, v40, v181
    v_mul_f32 v41, v41, v181
    v_mul_f32 v42, v42, v181
    v_mul_f32 v43, v43, v181
    v_mul_f32 v44, v44, v181
    v_mul_f32 v45, v45, v181
    v_mul_f32 v46, v46, v181
    v_mul_f32 v47, v47, v181
    v_mul_f32 v48, v48, v181
    v_mul_f32 v49, v49, v181
    v_mul_f32 v50, v50, v181
    v_mul_f32 v51, v51, v181
    v_mul_f32 v52, v52, v181
    v_mul_f32 v53, v53, v181
    v_mul_f32 v54, v54, v181
    v_mul_f32 v55, v55, v181
    v_mul_f32 v56, v56, v181
    v_mul_f32 v57, v57, v181
    v_mul_f32 v58, v58, v181
    v_mul_f32 v59, v59, v181
    v_mul_f32 v60, v60, v181
    v_mul_f32 v61, v61, v181
    v_mul_f32 v62, v62, v181
    v_mul_f32 v63, v63, v181
    v_mul_f32 v64, v64, v181
    v_mul_f32 v65, v65, v181
    v_mul_f32 v66, v66, v181
    v_mul_f32 v67, v67, v181
    v_mul_f32 v68, v68, v181
    v_mul_f32 v69, v69, v181
    v_mul_f32 v70, v70, v181
    v_mul_f32 v71, v71, v181
    v_mul_f32 v72, v72, v181
    v_mul_f32 v73, v73, v181
    v_mul_f32 v74, v74, v181
    v_mul_f32 v75, v75, v181
    v_mul_f32 v76, v76, v181
    v_mul_f32 v77, v77, v181
    v_mul_f32 v78, v78, v181
    v_mul_f32 v79, v79, v181
    v_mul_f32 v80, v80, v181
    v_mul_f32 v81, v81, v181
    v_mul_f32 v82, v82, v181
    v_mul_f32 v83, v83, v181
    v_mul_f32 v84, v84, v181
    v_mul_f32 v85, v85, v181
    v_mul_f32 v86, v86, v181
    v_mul_f32 v87, v87, v181
    v_mul_f32 v88, v88, v181
    v_mul_f32 v89, v89, v181
    v_mul_f32 v90, v90, v181
    v_mul_f32 v91, v91, v181
    v_mul_f32 v92, v92, v181
    v_mul_f32 v93, v93, v181
    v_mul_f32 v94, v94, v181
    v_mul_f32 v95, v95, v181
Lattn_rs16:
    s_waitcnt lgkmcnt(4)
    v_mfma_f32_32x32x16_bf16 v[32:47], v[144:147], v[136:139], v[32:47]
    ds_read_b128 v[164:167], v184 offset:11264
    s_waitcnt lgkmcnt(4)
    v_mfma_f32_32x32x16_bf16 v[48:63], v[148:151], v[136:139], v[48:63]
    ds_read_b128 v[168:171], v184 offset:13312
    s_waitcnt lgkmcnt(4)
    v_mfma_f32_32x32x16_bf16 v[64:79], v[152:155], v[136:139], v[64:79]
    ds_read_b128 v[172:175], v184 offset:15360
    s_waitcnt lgkmcnt(4)
    v_mfma_f32_32x32x16_bf16 v[80:95], v[156:159], v[136:139], v[80:95]
    s_waitcnt lgkmcnt(3)
    v_mfma_f32_32x32x16_bf16 v[32:47], v[160:163], v[140:143], v[32:47]
    s_waitcnt lgkmcnt(2)
    v_mfma_f32_32x32x16_bf16 v[48:63], v[164:167], v[140:143], v[48:63]
    s_waitcnt lgkmcnt(1)
    v_mfma_f32_32x32x16_bf16 v[64:79], v[168:171], v[140:143], v[64:79]
    s_waitcnt lgkmcnt(0)
    v_mfma_f32_32x32x16_bf16 v[80:95], v[172:175], v[140:143], v[80:95]
Lattn_fin:
    v_add_f32 v178, v178, v179
    v_mov_b32 v192, v178
    v_mov_b32 v193, v178
    s_nop 1
    v_permlane32_swap_b32 v192, v193
    v_add_f32 v178, v192, v193
    s_barrier
    v_lshrrev_b32 v194, 1, v188
    s_lshl_b32 s3, s24, 9
    s_add_u32 s3, s3, 131072
    v_add_u32 v194, s3, v194
    v_mov_b32 v198, v176
    v_mov_b32 v199, v178
    ds_write_b64 v194, v[198:199]
    s_lshl_b32 s3, s25, 14
    v_subrev_u32 v195, s3, v182
    s_lshl_b32 s3, s26, 13
    v_add_u32 v195, s3, v195
    v_add_u32 v196, 0x10000, v195
    s_cmp_eq_u32 s25, 0
    s_cbranch_scc0 Lattn_w1
    ds_write_b128 v195, v[64:67] offset:0
    ds_write_b128 v195, v[68:71] offset:1024
    ds_write_b128 v195, v[72:75] offset:2048
    ds_write_b128 v195, v[76:79] offset:3072
    ds_write_b128 v195, v[80:83] offset:4096
    ds_write_b128 v195, v[84:87] offset:5120
    ds_write_b128 v195, v[88:91] offset:6144
    ds_write_b128 v195, v[92:95] offset:7168
    s_branch Lattn_w2
Lattn_w1:
    ds_write_b128 v196, v[32:35] offset:0
    ds_write_b128 v196, v[36:39] offset:1024
    ds_write_b128 v196, v[40:43] offset:2048
    ds_write_b128 v196, v[44:47] offset:3072
    ds_write_b128 v196, v[48:51] offset:4096
    ds_write_b128 v196, v[52:55] offset:5120
    ds_write_b128 v196, v[56:59] offset:6144
    ds_write_b128 v196, v[60:63] offset:7168
Lattn_w2:
    s_waitcnt lgkmcnt(0)
    s_barrier
    v_xor_b32 v194, 2048, v194
    ds_read_b64 v[198:199], v194
    s_cmp_eq_u32 s25, 0
    s_cbranch_scc0 Lattn_r1
    ds_read_b128 v[96:99], v196 offset:0
    ds_read_b128 v[100:103], v196 offset:1024
    ds_read_b128 v[104:107], v196 offset:2048
    ds_read_b128 v[108:111], v196 offset:3072
    ds_read_b128 v[112:115], v196 offset:4096
    ds_read_b128 v[116:119], v196 offset:5120
    ds_read_b128 v[120:123], v196 offset:6144
    ds_read_b128 v[124:127], v196 offset:7168
    s_branch Lattn_r2
Lattn_r1:
    ds_read_b128 v[96:99], v195 offset:0
    ds_read_b128 v[100:103], v195 offset:1024
    ds_read_b128 v[104:107], v195 offset:2048
    ds_read_b128 v[108:111], v195 offset:3072
    ds_read_b128 v[112:115], v195 offset:4096
    ds_read_b128 v[116:119], v195 offset:5120
    ds_read_b128 v[120:123], v195 offset:6144
    ds_read_b128 v[124:127], v195 offset:7168
Lattn_r2:
    s_waitcnt lgkmcnt(0)
    v_max_f32 v192, v176, v198
    v_sub_f32 v193, v176, v192
    v_sub_f32 v197, v198, v192
    v_exp_f32 v193, v193
    v_exp_f32 v197, v197
    v_mul_f32 v200, v178, v193
    v_fma_f32 v200, v199, v197, v200
    v_rcp_f32 v200, v200
    s_nop 0
    v_mul_f32 v193, v193, v200
    v_mul_f32 v197, v197, v200
    s_lshl_b32 s3, s29, 2
    s_add_u32 s3, s3, s26
    s_lshl_b32 s3, s3, 5
    s_add_u32 s3, s3, s27
    s_lshl_b32 s3, s3, 13
    s_lshl_b32 s4, s25, 12
    s_add_u32 s3, s3, s4
    s_cmp_eq_u32 s25, 0
    s_cbranch_scc0 Lattn_f1
    v_mul_f32 v96, v96, v197
    v_fma_f32 v96, v32, v193, v96
    v_mul_f32 v97, v97, v197
    v_fma_f32 v97, v33, v193, v97
    v_mul_f32 v98, v98, v197
    v_fma_f32 v98, v34, v193, v98
    v_mul_f32 v99, v99, v197
    v_fma_f32 v99, v35, v193, v99
    v_mul_f32 v100, v100, v197
    v_fma_f32 v100, v36, v193, v100
    v_mul_f32 v101, v101, v197
    v_fma_f32 v101, v37, v193, v101
    v_mul_f32 v102, v102, v197
    v_fma_f32 v102, v38, v193, v102
    v_mul_f32 v103, v103, v197
    v_fma_f32 v103, v39, v193, v103
    v_cvt_pk_bf16_f32 v128, v96, v97
    v_cvt_pk_bf16_f32 v129, v98, v99
    v_cvt_pk_bf16_f32 v130, v100, v101
    v_cvt_pk_bf16_f32 v131, v102, v103
    buffer_store_dwordx4 v[128:131], v188, s[20:23], s3 offen offset:0
    v_mul_f32 v104, v104, v197
    v_fma_f32 v104, v40, v193, v104
    v_mul_f32 v105, v105, v197
    v_fma_f32 v105, v41, v193, v105
    v_mul_f32 v106, v106, v197
    v_fma_f32 v106, v42, v193, v106
    v_mul_f32 v107, v107, v197
    v_fma_f32 v107, v43, v193, v107
    v_mul_f32 v108, v108, v197
    v_fma_f32 v108, v44, v193, v108
    v_mul_f32 v109, v109, v197
    v_fma_f32 v109, v45, v193, v109
    v_mul_f32 v110, v110, v197
    v_fma_f32 v110, v46, v193, v110
    v_mul_f32 v111, v111, v197
    v_fma_f32 v111, v47, v193, v111
    v_cvt_pk_bf16_f32 v132, v104, v105
    v_cvt_pk_bf16_f32 v133, v106, v107
    v_cvt_pk_bf16_f32 v134, v108, v109
    v_cvt_pk_bf16_f32 v135, v110, v111
    buffer_store_dwordx4 v[132:135], v188, s[20:23], s3 offen offset:1024
    v_mul_f32 v112, v112, v197
    v_fma_f32 v112, v48, v193, v112
    v_mul_f32 v113, v113, v197
    v_fma_f32 v113, v49, v193, v113
    v_mul_f32 v114, v114, v197
    v_fma_f32 v114, v50, v193, v114
    v_mul_f32 v115, v115, v197
    v_fma_f32 v115, v51, v193, v115
    v_mul_f32 v116, v116, v197
    v_fma_f32 v116, v52, v193, v116
    v_mul_f32 v117, v117, v197
    v_fma_f32 v117, v53, v193, v117
    v_mul_f32 v118, v118, v197
    v_fma_f32 v118, v54, v193, v118
    v_mul_f32 v119, v119, v197
    v_fma_f32 v119, v55, v193, v119
    v_cvt_pk_bf16_f32 v136, v112, v113
    v_cvt_pk_bf16_f32 v137, v114, v115
    v_cvt_pk_bf16_f32 v138, v116, v117
    v_cvt_pk_bf16_f32 v139, v118, v119
    buffer_store_dwordx4 v[136:139], v188, s[20:23], s3 offen offset:2048
    v_mul_f32 v120, v120, v197
    v_fma_f32 v120, v56, v193, v120
    v_mul_f32 v121, v121, v197
    v_fma_f32 v121, v57, v193, v121
    v_mul_f32 v122, v122, v197
    v_fma_f32 v122, v58, v193, v122
    v_mul_f32 v123, v123, v197
    v_fma_f32 v123, v59, v193, v123
    v_mul_f32 v124, v124, v197
    v_fma_f32 v124, v60, v193, v124
    v_mul_f32 v125, v125, v197
    v_fma_f32 v125, v61, v193, v125
    v_mul_f32 v126, v126, v197
    v_fma_f32 v126, v62, v193, v126
    v_mul_f32 v127, v127, v197
    v_fma_f32 v127, v63, v193, v127
    v_cvt_pk_bf16_f32 v140, v120, v121
    v_cvt_pk_bf16_f32 v141, v122, v123
    v_cvt_pk_bf16_f32 v142, v124, v125
    v_cvt_pk_bf16_f32 v143, v126, v127
    buffer_store_dwordx4 v[140:143], v188, s[20:23], s3 offen offset:3072
    s_branch Lattn_f2
Lattn_f1:
    v_mul_f32 v96, v96, v197
    v_fma_f32 v96, v64, v193, v96
    v_mul_f32 v97, v97, v197
    v_fma_f32 v97, v65, v193, v97
    v_mul_f32 v98, v98, v197
    v_fma_f32 v98, v66, v193, v98
    v_mul_f32 v99, v99, v197
    v_fma_f32 v99, v67, v193, v99
    v_mul_f32 v100, v100, v197
    v_fma_f32 v100, v68, v193, v100
    v_mul_f32 v101, v101, v197
    v_fma_f32 v101, v69, v193, v101
    v_mul_f32 v102, v102, v197
    v_fma_f32 v102, v70, v193, v102
    v_mul_f32 v103, v103, v197
    v_fma_f32 v103, v71, v193, v103
    v_cvt_pk_bf16_f32 v128, v96, v97
    v_cvt_pk_bf16_f32 v129, v98, v99
    v_cvt_pk_bf16_f32 v130, v100, v101
    v_cvt_pk_bf16_f32 v131, v102, v103
    buffer_store_dwordx4 v[128:131], v188, s[20:23], s3 offen offset:0
    v_mul_f32 v104, v104, v197
    v_fma_f32 v104, v72, v193, v104
    v_mul_f32 v105, v105, v197
    v_fma_f32 v105, v73, v193, v105
    v_mul_f32 v106, v106, v197
    v_fma_f32 v106, v74, v193, v106
    v_mul_f32 v107, v107, v197
    v_fma_f32 v107, v75, v193, v107
    v_mul_f32 v108, v108, v197
    v_fma_f32 v108, v76, v193, v108
    v_mul_f32 v109, v109, v197
    v_fma_f32 v109, v77, v193, v109
    v_mul_f32 v110, v110, v197
    v_fma_f32 v110, v78, v193, v110
    v_mul_f32 v111, v111, v197
    v_fma_f32 v111, v79, v193, v111
    v_cvt_pk_bf16_f32 v132, v104, v105
    v_cvt_pk_bf16_f32 v133, v106, v107
    v_cvt_pk_bf16_f32 v134, v108, v109
    v_cvt_pk_bf16_f32 v135, v110, v111
    buffer_store_dwordx4 v[132:135], v188, s[20:23], s3 offen offset:1024
    v_mul_f32 v112, v112, v197
    v_fma_f32 v112, v80, v193, v112
    v_mul_f32 v113, v113, v197
    v_fma_f32 v113, v81, v193, v113
    v_mul_f32 v114, v114, v197
    v_fma_f32 v114, v82, v193, v114
    v_mul_f32 v115, v115, v197
    v_fma_f32 v115, v83, v193, v115
    v_mul_f32 v116, v116, v197
    v_fma_f32 v116, v84, v193, v116
    v_mul_f32 v117, v117, v197
    v_fma_f32 v117, v85, v193, v117
    v_mul_f32 v118, v118, v197
    v_fma_f32 v118, v86, v193, v118
    v_mul_f32 v119, v119, v197
    v_fma_f32 v119, v87, v193, v119
    v_cvt_pk_bf16_f32 v136, v112, v113
    v_cvt_pk_bf16_f32 v137, v114, v115
    v_cvt_pk_bf16_f32 v138, v116, v117
    v_cvt_pk_bf16_f32 v139, v118, v119
    buffer_store_dwordx4 v[136:139], v188, s[20:23], s3 offen offset:2048
    v_mul_f32 v120, v120, v197
    v_fma_f32 v120, v88, v193, v120
    v_mul_f32 v121, v121, v197
    v_fma_f32 v121, v89, v193, v121
    v_mul_f32 v122, v122, v197
    v_fma_f32 v122, v90, v193, v122
    v_mul_f32 v123, v123, v197
    v_fma_f32 v123, v91, v193, v123
    v_mul_f32 v124, v124, v197
    v_fma_f32 v124, v92, v193, v124
    v_mul_f32 v125, v125, v197
    v_fma_f32 v125, v93, v193, v125
    v_mul_f32 v126, v126, v197
    v_fma_f32 v126, v94, v193, v126
    v_mul_f32 v127, v127, v197
    v_fma_f32 v127, v95, v193, v127
    v_cvt_pk_bf16_f32 v140, v120, v121
    v_cvt_pk_bf16_f32 v141, v122, v123
    v_cvt_pk_bf16_f32 v142, v124, v125
    v_cvt_pk_bf16_f32 v143, v126, v127
    buffer_store_dwordx4 v[140:143], v188, s[20:23], s3 offen offset:3072
Lattn_f2:
    s_cmp_eq_u32 s34, 1
    s_cbranch_scc1 Lattn_exit
    s_mov_b32 s34, 1
    s_mov_b32 s29, s28
    v_xor_b32 v182, 0x8000, v182
    v_xor_b32 v183, 0x8000, v183
    v_xor_b32 v184, 0x8000, v184
    v_xor_b32 v185, 0x8000, v185
    s_barrier
    s_sub_u32 s3, s36, s35
    s_cmp_ge_u32 s36, s35
    s_cselect_b32 s3, s3, s36
    s_lshl_b32 s33, s3, 15
    s_cmp_ge_u32 s36, 17
    s_cselect_b32 s33, 0x7f000000, s33
    s_and_b32 s4, s36, 1
    s_lshl_b32 s4, s4, 15
    s_add_u32 s4, s4, s32
    s_add_u32 m0, s4, 0
    s_add_u32 s36, s36, 1
    buffer_load_dwordx4 v187, s[8:11], s33 offen offset:0 lds
    buffer_load_dwordx4 v187, s[8:11], s33 offen offset:1024 lds
    buffer_load_dwordx4 v187, s[8:11], s33 offen offset:2048 lds
    buffer_load_dwordx4 v187, s[8:11], s33 offen offset:3072 lds
    s_lshl_b32 s3, s29, 2
    s_add_u32 s3, s3, s26
    s_lshl_b32 s3, s3, 13
    v_add_u32 v195, 4096, v188
    buffer_load_dwordx4 v[0:3], v188, s[16:19], s3 offen offset:0
    buffer_load_dwordx4 v[4:7], v188, s[16:19], s3 offen offset:1024
    buffer_load_dwordx4 v[8:11], v188, s[16:19], s3 offen offset:2048
    buffer_load_dwordx4 v[12:15], v188, s[16:19], s3 offen offset:3072
    buffer_load_dwordx4 v[16:19], v195, s[16:19], s3 offen offset:0
    buffer_load_dwordx4 v[20:23], v195, s[16:19], s3 offen offset:1024
    buffer_load_dwordx4 v[24:27], v195, s[16:19], s3 offen offset:2048
    buffer_load_dwordx4 v[28:31], v195, s[16:19], s3 offen offset:3072
    v_mov_b32 v32, 0
    v_mov_b32 v33, 0
    v_mov_b32 v34, 0
    v_mov_b32 v35, 0
    v_mov_b32 v36, 0
    v_mov_b32 v37, 0
    v_mov_b32 v38, 0
    v_mov_b32 v39, 0
    v_mov_b32 v40, 0
    v_mov_b32 v41, 0
    v_mov_b32 v42, 0
    v_mov_b32 v43, 0
    v_mov_b32 v44, 0
    v_mov_b32 v45, 0
    v_mov_b32 v46, 0
    v_mov_b32 v47, 0
    v_mov_b32 v48, 0
    v_mov_b32 v49, 0
    v_mov_b32 v50, 0
    v_mov_b32 v51, 0
    v_mov_b32 v52, 0
    v_mov_b32 v53, 0
    v_mov_b32 v54, 0
    v_mov_b32 v55, 0
    v_mov_b32 v56, 0
    v_mov_b32 v57, 0
    v_mov_b32 v58, 0
    v_mov_b32 v59, 0
    v_mov_b32 v60, 0
    v_mov_b32 v61, 0
    v_mov_b32 v62, 0
    v_mov_b32 v63, 0
    v_mov_b32 v64, 0
    v_mov_b32 v65, 0
    v_mov_b32 v66, 0
    v_mov_b32 v67, 0
    v_mov_b32 v68, 0
    v_mov_b32 v69, 0
    v_mov_b32 v70, 0
    v_mov_b32 v71, 0
    v_mov_b32 v72, 0
    v_mov_b32 v73, 0
    v_mov_b32 v74, 0
    v_mov_b32 v75, 0
    v_mov_b32 v76, 0
    v_mov_b32 v77, 0
    v_mov_b32 v78, 0
    v_mov_b32 v79, 0
    v_mov_b32 v80, 0
    v_mov_b32 v81, 0
    v_mov_b32 v82, 0
    v_mov_b32 v83, 0
    v_mov_b32 v84, 0
    v_mov_b32 v85, 0
    v_mov_b32 v86, 0
    v_mov_b32 v87, 0
    v_mov_b32 v88, 0
    v_mov_b32 v89, 0
    v_mov_b32 v90, 0
    v_mov_b32 v91, 0
    v_mov_b32 v92, 0
    v_mov_b32 v93, 0
    v_mov_b32 v94, 0
    v_mov_b32 v95, 0
    v_mov_b32 v208, 0
    v_mov_b32 v209, 0
    v_mov_b32 v210, 0
    v_mov_b32 v211, 0
    v_mov_b32 v212, 0
    v_mov_b32 v213, 0
    v_mov_b32 v214, 0
    v_mov_b32 v215, 0
    v_mov_b32 v216, 0
    v_mov_b32 v217, 0
    v_mov_b32 v218, 0
    v_mov_b32 v219, 0
    v_mov_b32 v220, 0
    v_mov_b32 v221, 0
    v_mov_b32 v222, 0
    v_mov_b32 v223, 0
    v_mov_b32 v176, 0
    v_mov_b32 v178, 0
    v_mov_b32 v179, 0
    s_mov_b32 s54, 0
    s_branch Lattn_tile
    s_endpgm
Lattn_slow1:
    v_mov_b32 v190, v192
    v_sub_f32 v96, v96, v192
    v_sub_f32 v97, v97, v192
    v_sub_f32 v98, v98, v192
    v_sub_f32 v99, v99, v192
    v_sub_f32 v100, v100, v192
    v_sub_f32 v101, v101, v192
    v_sub_f32 v102, v102, v192
    v_sub_f32 v103, v103, v192
    v_sub_f32 v104, v104, v192
    v_sub_f32 v105, v105, v192
    v_sub_f32 v106, v106, v192
    v_sub_f32 v107, v107, v192
    v_sub_f32 v108, v108, v192
    v_sub_f32 v109, v109, v192
    v_sub_f32 v110, v110, v192
    v_sub_f32 v111, v111, v192
    v_add_f32 v176, v176, v192
    v_sub_f32 v193, 0, v192
    v_mov_b32 v180, 1.0
    v_sub_f32 v193, 0, v176
    v_mov_b32 v208, v193
    v_mov_b32 v209, v193
    v_mov_b32 v210, v193
    v_mov_b32 v211, v193
    v_mov_b32 v212, v193
    v_mov_b32 v213, v193
    v_mov_b32 v214, v193
    v_mov_b32 v215, v193
    v_mov_b32 v216, v193
    v_mov_b32 v217, v193
    v_mov_b32 v218, v193
    v_mov_b32 v219, v193
    v_mov_b32 v220, v193
    v_mov_b32 v221, v193
    v_mov_b32 v222, v193
    v_mov_b32 v223, v193
    v_mul_f32 v178, v178, v180
    v_mul_f32 v179, v179, v180
    s_mov_b32 s50, 0
    s_mov_b32 s54, 1
    s_branch Lattn_back1
Lattn_fix2:
    v_sub_f32 v112, v112, v190
    v_sub_f32 v113, v113, v190
    v_sub_f32 v114, v114, v190
    v_sub_f32 v115, v115, v190
    v_sub_f32 v116, v116, v190
    v_sub_f32 v117, v117, v190
    v_sub_f32 v118, v118, v190
    v_sub_f32 v119, v119, v190
    v_sub_f32 v120, v120, v190
    v_sub_f32 v121, v121, v190
    v_sub_f32 v122, v122, v190
    v_sub_f32 v123, v123, v190
    v_sub_f32 v124, v124, v190
    v_sub_f32 v125, v125, v190
    v_sub_f32 v126, v126, v190
    v_sub_f32 v127, v127, v190
    s_mov_b32 s54, 0
    s_branch Lattn_fixb2
Lattn_slow2:
    v_max_f32 v192, 0, v192
    v_mov_b32 v190, v192
    v_sub_f32 v112, v112, v192
    v_sub_f32 v113, v113, v192
    v_sub_f32 v114, v114, v192
    v_sub_f32 v115, v115, v192
    v_sub_f32 v116, v116, v192
    v_sub_f32 v117, v117, v192
    v_sub_f32 v118, v118, v192
    v_sub_f32 v119, v119, v192
    v_sub_f32 v120, v120, v192
    v_sub_f32 v121, v121, v192
    v_sub_f32 v122, v122, v192
    v_sub_f32 v123, v123, v192
    v_sub_f32 v124, v124, v192
    v_sub_f32 v125, v125, v192
    v_sub_f32 v126, v126, v192
    v_sub_f32 v127, v127, v192
    v_add_f32 v176, v176, v192
    v_sub_f32 v193, 0, v192
    v_exp_f32 v181, v193
    v_sub_f32 v193, 0, v176
    v_mov_b32 v208, v193
    v_mov_b32 v209, v193
    v_mov_b32 v210, v193
    v_mov_b32 v211, v193
    v_mov_b32 v212, v193
    v_mov_b32 v213, v193
    v_mov_b32 v214, v193
    v_mov_b32 v215, v193
    v_mov_b32 v216, v193
    v_mov_b32 v217, v193
    v_mov_b32 v218, v193
    v_mov_b32 v219, v193
    v_mov_b32 v220, v193
    v_mov_b32 v221, v193
    v_mov_b32 v222, v193
    v_mov_b32 v223, v193
    v_mul_f32 v178, v178, v181
    v_mul_f32 v179, v179, v181
    s_mov_b32 s51, 1
    s_mov_b32 s54, 1
    s_branch Lattn_back2
Lattn_fix4:
    v_sub_f32 v96, v96, v190
    v_sub_f32 v97, v97, v190
    v_sub_f32 v98, v98, v190
    v_sub_f32 v99, v99, v190
    v_sub_f32 v100, v100, v190
    v_sub_f32 v101, v101, v190
    v_sub_f32 v102, v102, v190
    v_sub_f32 v103, v103, v190
    v_sub_f32 v104, v104, v190
    v_sub_f32 v105, v105, v190
    v_sub_f32 v106, v106, v190
    v_sub_f32 v107, v107, v190
    v_sub_f32 v108, v108, v190
    v_sub_f32 v109, v109, v190
    v_sub_f32 v110, v110, v190
    v_sub_f32 v111, v111, v190
    s_mov_b32 s54, 0
    s_branch Lattn_fixb4
Lattn_slow4:
    v_max_f32 v192, 0, v192
    v_mov_b32 v190, v192
    v_sub_f32 v96, v96, v192
    v_sub_f32 v97, v97, v192
    v_sub_f32 v98, v98, v192
    v_sub_f32 v99, v99, v192
    v_sub_f32 v100, v100, v192
    v_sub_f32 v101, v101, v192
    v_sub_f32 v102, v102, v192
    v_sub_f32 v103, v103, v192
    v_sub_f32 v104, v104, v192
    v_sub_f32 v105, v105, v192
    v_sub_f32 v106, v106, v192
    v_sub_f32 v107, v107, v192
    v_sub_f32 v108, v108, v192
    v_sub_f32 v109, v109, v192
    v_sub_f32 v110, v110, v192
    v_sub_f32 v111, v111, v192
    v_add_f32 v176, v176, v192
    v_sub_f32 v193, 0, v192
    v_exp_f32 v180, v193
    v_sub_f32 v193, 0, v176
    v_mov_b32 v208, v193
    v_mov_b32 v209, v193
    v_mov_b32 v210, v193
    v_mov_b32 v211, v193
    v_mov_b32 v212, v193
    v_mov_b32 v213, v193
    v_mov_b32 v214, v193
    v_mov_b32 v215, v193
    v_mov_b32 v216, v193
    v_mov_b32 v217, v193
    v_mov_b32 v218, v193
    v_mov_b32 v219, v193
    v_mov_b32 v220, v193
    v_mov_b32 v221, v193
    v_mov_b32 v222, v193
    v_mov_b32 v223, v193
    v_mul_f32 v178, v178, v180
    v_mul_f32 v179, v179, v180
    s_mov_b32 s50, 1
    s_mov_b32 s54, 1
    s_branch Lattn_back4
Lattn_fix5:
    v_sub_f32 v112, v112, v190
    v_sub_f32 v113, v113, v190
    v_sub_f32 v114, v114, v190
    v_sub_f32 v115, v115, v190
    v_sub_f32 v116, v116, v190
    v_sub_f32 v117, v117, v190
    v_sub_f32 v118, v118, v190
    v_sub_f32 v119, v119, v190
    v_sub_f32 v120, v120, v190
    v_sub_f32 v121, v121, v190
    v_sub_f32 v122, v122, v190
    v_sub_f32 v123, v123, v190
    v_sub_f32 v124, v124, v190
    v_sub_f32 v125, v125, v190
    v_sub_f32 v126, v126, v190
    v_sub_f32 v127, v127, v190
    s_mov_b32 s54, 0
    s_branch Lattn_fixb5
Lattn_slow5:
    v_max_f32 v192, 0, v192
    v_mov_b32 v190, v192
    v_sub_f32 v112, v112, v192
    v_sub_f32 v113, v113, v192
    v_sub_f32 v114, v114, v192
    v_sub_f32 v115, v115, v192
    v_sub_f32 v116, v116, v192
    v_sub_f32 v117, v117, v192
    v_sub_f32 v118, v118, v192
    v_sub_f32 v119, v119, v192
    v_sub_f32 v120, v120, v192
    v_sub_f32 v121, v121, v192
    v_sub_f32 v122, v122, v192
    v_sub_f32 v123, v123, v192
    v_sub_f32 v124, v124, v192
    v_sub_f32 v125, v125, v192
    v_sub_f32 v126, v126, v192
    v_sub_f32 v127, v127, v192
    v_add_f32 v176, v176, v192
    v_sub_f32 v193, 0, v192
    v_exp_f32 v181, v193
    v_sub_f32 v193, 0, v176
    v_mov_b32 v208, v193
    v_mov_b32 v209, v193
    v_mov_b32 v210, v193
    v_mov_b32 v211, v193
    v_mov_b32 v212, v193
    v_mov_b32 v213, v193
    v_mov_b32 v214, v193
    v_mov_b32 v215, v193
    v_mov_b32 v216, v193
    v_mov_b32 v217, v193
    v_mov_b32 v218, v193
    v_mov_b32 v219, v193
    v_mov_b32 v220, v193
    v_mov_b32 v221, v193
    v_mov_b32 v222, v193
    v_mov_b32 v223, v193
    v_mul_f32 v178, v178, v181
    v_mul_f32 v179, v179, v181
    s_mov_b32 s51, 1
    s_mov_b32 s54, 1
    s_branch Lattn_back5
Lattn_fix8:
    v_sub_f32 v96, v96, v190
    v_sub_f32 v97, v97, v190
    v_sub_f32 v98, v98, v190
    v_sub_f32 v99, v99, v190
    v_sub_f32 v100, v100, v190
    v_sub_f32 v101, v101, v190
    v_sub_f32 v102, v102, v190
    v_sub_f32 v103, v103, v190
    v_sub_f32 v104, v104, v190
    v_sub_f32 v105, v105, v190
    v_sub_f32 v106, v106, v190
    v_sub_f32 v107, v107, v190
    v_sub_f32 v108, v108, v190
    v_sub_f32 v109, v109, v190
    v_sub_f32 v110, v110, v190
    v_sub_f32 v111, v111, v190
    s_mov_b32 s54, 0
    s_branch Lattn_fixb8
Lattn_slow8:
    v_max_f32 v192, 0, v192
    v_mov_b32 v190, v192
    v_sub_f32 v96, v96, v192
    v_sub_f32 v97, v97, v192
    v_sub_f32 v98, v98, v192
    v_sub_f32 v99, v99, v192
    v_sub_f32 v100, v100, v192
    v_sub_f32 v101, v101, v192
    v_sub_f32 v102, v102, v192
    v_sub_f32 v103, v103, v192
    v_sub_f32 v104, v104, v192
    v_sub_f32 v105, v105, v192
    v_sub_f32 v106, v106, v192
    v_sub_f32 v107, v107, v192
    v_sub_f32 v108, v108, v192
    v_sub_f32 v109, v109, v192
    v_sub_f32 v110, v110, v192
    v_sub_f32 v111, v111, v192
    v_add_f32 v176, v176, v192
    v_sub_f32 v193, 0, v192
    v_exp_f32 v180, v193
    v_sub_f32 v193, 0, v176
    v_mov_b32 v208, v193
    v_mov_b32 v209, v193
    v_mov_b32 v210, v193
    v_mov_b32 v211, v193
    v_mov_b32 v212, v193
    v_mov_b32 v213, v193
    v_mov_b32 v214, v193
    v_mov_b32 v215, v193
    v_mov_b32 v216, v193
    v_mov_b32 v217, v193
    v_mov_b32 v218, v193
    v_mov_b32 v219, v193
    v_mov_b32 v220, v193
    v_mov_b32 v221, v193
    v_mov_b32 v222, v193
    v_mov_b32 v223, v193
    v_mul_f32 v178, v178, v180
    v_mul_f32 v179, v179, v180
    s_mov_b32 s50, 1
    s_mov_b32 s54, 1
    s_branch Lattn_back8
Lattn_fix9:
    v_sub_f32 v112, v112, v190
    v_sub_f32 v113, v113, v190
    v_sub_f32 v114, v114, v190
    v_sub_f32 v115, v115, v190
    v_sub_f32 v116, v116, v190
    v_sub_f32 v117, v117, v190
    v_sub_f32 v118, v118, v190
    v_sub_f32 v119, v119, v190
    v_sub_f32 v120, v120, v190
    v_sub_f32 v121, v121, v190
    v_sub_f32 v122, v122, v190
    v_sub_f32 v123, v123, v190
    v_sub_f32 v124, v124, v190
    v_sub_f32 v125, v125, v190
    v_sub_f32 v126, v126, v190
    v_sub_f32 v127, v127, v190
    s_mov_b32 s54, 0
    s_branch Lattn_fixb9
Lattn_slow9:
    v_max_f32 v192, 0, v192
    v_mov_b32 v190, v192
    v_sub_f32 v112, v112, v192
    v_sub_f32 v113, v113, v192
    v_sub_f32 v114, v114, v192
    v_sub_f32 v115, v115, v192
    v_sub_f32 v116, v116, v192
    v_sub_f32 v117, v117, v192
    v_sub_f32 v118, v118, v192
    v_sub_f32 v119, v119, v192
    v_sub_f32 v120, v120, v192
    v_sub_f32 v121, v121, v192
    v_sub_f32 v122, v122, v192
    v_sub_f32 v123, v123, v192
    v_sub_f32 v124, v124, v192
    v_sub_f32 v125, v125, v192
    v_sub_f32 v126, v126, v192
    v_sub_f32 v127, v127, v192
    v_add_f32 v176, v176, v192
    v_sub_f32 v193, 0, v192
    v_exp_f32 v181, v193
    v_sub_f32 v193, 0, v176
    v_mov_b32 v208, v193
    v_mov_b32 v209, v193
    v_mov_b32 v210, v193
    v_mov_b32 v211, v193
    v_mov_b32 v212, v193
    v_mov_b32 v213, v193
    v_mov_b32 v214, v193
    v_mov_b32 v215, v193
    v_mov_b32 v216, v193
    v_mov_b32 v217, v193
    v_mov_b32 v218, v193
    v_mov_b32 v219, v193
    v_mov_b32 v220, v193
    v_mov_b32 v221, v193
    v_mov_b32 v222, v193
    v_mov_b32 v223, v193
    v_mul_f32 v178, v178, v181
    v_mul_f32 v179, v179, v181
    s_mov_b32 s51, 1
    s_mov_b32 s54, 1
    s_branch Lattn_back9
Lattn_slow13:
    v_mov_b32 v190, v192
    v_sub_f32 v96, v96, v192
    v_sub_f32 v97, v97, v192
    v_sub_f32 v98, v98, v192
    v_sub_f32 v99, v99, v192
    v_sub_f32 v100, v100, v192
    v_sub_f32 v101, v101, v192
    v_sub_f32 v102, v102, v192
    v_sub_f32 v103, v103, v192
    v_sub_f32 v104, v104, v192
    v_sub_f32 v105, v105, v192
    v_sub_f32 v106, v106, v192
    v_sub_f32 v107, v107, v192
    v_sub_f32 v108, v108, v192
    v_sub_f32 v109, v109, v192
    v_sub_f32 v110, v110, v192
    v_sub_f32 v111, v111, v192
    v_add_f32 v176, v176, v192
    v_sub_f32 v193, 0, v192
    v_mov_b32 v180, 1.0
    v_sub_f32 v193, 0, v176
    v_mov_b32 v208, v193
    v_mov_b32 v209, v193
    v_mov_b32 v210, v193
    v_mov_b32 v211, v193
    v_mov_b32 v212, v193
    v_mov_b32 v213, v193
    v_mov_b32 v214, v193
    v_mov_b32 v215, v193
    v_mov_b32 v216, v193
    v_mov_b32 v217, v193
    v_mov_b32 v218, v193
    v_mov_b32 v219, v193
    v_mov_b32 v220, v193
    v_mov_b32 v221, v193
    v_mov_b32 v222, v193
    v_mov_b32 v223, v193
    v_mul_f32 v178, v178, v180
    v_mul_f32 v179, v179, v180
    s_mov_b32 s50, 0
    s_mov_b32 s54, 1
    s_branch Lattn_back13
Lattn_fix14:
    v_sub_f32 v112, v112, v190
    v_sub_f32 v113, v113, v190
    v_sub_f32 v114, v114, v190
    v_sub_f32 v115, v115, v190
    v_sub_f32 v116, v116, v190
    v_sub_f32 v117, v117, v190
    v_sub_f32 v118, v118, v190
    v_sub_f32 v119, v119, v190
    v_sub_f32 v120, v120, v190
    v_sub_f32 v121, v121, v190
    v_sub_f32 v122, v122, v190
    v_sub_f32 v123, v123, v190
    v_sub_f32 v124, v124, v190
    v_sub_f32 v125, v125, v190
    v_sub_f32 v126, v126, v190
    v_sub_f32 v127, v127, v190
    s_mov_b32 s54, 0
    s_branch Lattn_fixb14
Lattn_slow14:
    v_max_f32 v192, 0, v192
    v_mov_b32 v190, v192
    v_sub_f32 v112, v112, v192
    v_sub_f32 v113, v113, v192
    v_sub_f32 v114, v114, v192
    v_sub_f32 v115, v115, v192
    v_sub_f32 v116, v116, v192
    v_sub_f32 v117, v117, v192
    v_sub_f32 v118, v118, v192
    v_sub_f32 v119, v119, v192
    v_sub_f32 v120, v120, v192
    v_sub_f32 v121, v121, v192
    v_sub_f32 v122, v122, v192
    v_sub_f32 v123, v123, v192
    v_sub_f32 v124, v124, v192
    v_sub_f32 v125, v125, v192
    v_sub_f32 v126, v126, v192
    v_sub_f32 v127, v127, v192
    v_add_f32 v176, v176, v192
    v_sub_f32 v193, 0, v192
    v_exp_f32 v181, v193
    v_sub_f32 v193, 0, v176
    v_mov_b32 v208, v193
    v_mov_b32 v209, v193
    v_mov_b32 v210, v193
    v_mov_b32 v211, v193
    v_mov_b32 v212, v193
    v_mov_b32 v213, v193
    v_mov_b32 v214, v193
    v_mov_b32 v215, v193
    v_mov_b32 v216, v193
    v_mov_b32 v217, v193
    v_mov_b32 v218, v193
    v_mov_b32 v219, v193
    v_mov_b32 v220, v193
    v_mov_b32 v221, v193
    v_mov_b32 v222, v193
    v_mov_b32 v223, v193
    v_mul_f32 v178, v178, v181
    v_mul_f32 v179, v179, v181
    s_mov_b32 s51, 1
    s_mov_b32 s54, 1
    s_branch Lattn_back14
Lattn_exit:
    s_endpgm
.globl l3_kernel
.p2align 8
.type l3_kernel,@function
l3_kernel:
    s_cmp_ge_u32 s2, 48
    s_cbranch_scc1 Lm3
    s_load_dwordx4 s[40:43], s[0:1], 56
    s_load_dwordx2 s[46:47], s[0:1], 88
    s_load_dwordx2 s[56:57], s[0:1], 80
    s_load_dwordx2 s[58:59], s[0:1], 72
    v_lshrrev_b32 v1, 6, v0
    s_nop 0
    v_readfirstlane_b32 s24, v1
    s_waitcnt lgkmcnt(0)
    s_mov_b32 s60, s56
    s_mov_b32 s61, s57
    s_mov_b32 s62, 256
    s_mov_b32 s63, 0x00020000
    s_cmp_ge_u32 s2, 37
    s_cbranch_scc1 Lc23_s3
    s_lshl_b32 s26, s2, 3
    s_add_u32 s25, s26, s24
    s_add_u32 s8, s46, 67108864
    s_addc_u32 s9, s47, 0
    s_mov_b32 s10, 2359296
    s_mov_b32 s11, 0x00020000
    s_add_u32 s12, s46, 71303168
    s_addc_u32 s13, s47, 0
    s_mov_b32 s14, 2424832
    s_mov_b32 s15, 0x00020000
    s_mov_b32 s16, s40
    s_mov_b32 s17, s41
    s_mov_b32 s18, 1183744
    s_mov_b32 s19, 0x00020000
    s_mov_b32 s20, s42
    s_mov_b32 s21, s43
    s_mov_b32 s22, 1183744
    s_mov_b32 s23, 0x00020000
    v_and_b32 v232, 63, v0
    v_and_b32 v233, 31, v0
    v_bfe_u32 v234, v0, 5, 1
    v_lshlrev_b32 v236, 4, v232
    s_lshl_b32 s3, s25, 12
    v_mov_b32 v104, 0
    v_mov_b32 v105, 0
    v_mov_b32 v106, 0
    v_mov_b32 v107, 0
    v_mov_b32 v108, 0
    v_mov_b32 v109, 0
    v_mov_b32 v110, 0
    v_mov_b32 v111, 0
    v_mov_b32 v112, 0
    v_mov_b32 v113, 0
    v_mov_b32 v114, 0
    v_mov_b32 v115, 0
    v_mov_b32 v116, 0
    v_mov_b32 v117, 0
    v_mov_b32 v118, 0
    v_mov_b32 v119, 0
    s_cmp_ge_u32 s25, 289
    s_cbranch_scc1 Ls2_noim
    buffer_load_dwordx4 v[88:91], v236, s[8:11], s3 offen offset:0
    buffer_load_dwordx4 v[92:95], v236, s[8:11], s3 offen offset:1024
    buffer_load_dwordx4 v[96:99], v236, s[8:11], s3 offen offset:2048
    buffer_load_dwordx4 v[100:103], v236, s[8:11], s3 offen offset:3072
    s_cmp_eq_u32 s25, 0
    s_cbranch_scc1 Ls2_noim
    s_cmp_eq_u32 s25, 288
    s_cbranch_scc1 Ls2_noim
    s_add_u32 s3, s3, 1179648
    buffer_load_dwordx4 v[104:107], v236, s[8:11], s3 offen offset:0
    buffer_load_dwordx4 v[108:111], v236, s[8:11], s3 offen offset:1024
    buffer_load_dwordx4 v[112:115], v236, s[8:11], s3 offen offset:2048
    buffer_load_dwordx4 v[116:119], v236, s[8:11], s3 offen offset:3072
Ls2_noim:
    s_add_u32 s16, s46, 75497472
    s_addc_u32 s17, s47, 0
    s_mov_b32 s18, 2367488
    s_mov_b32 s19, 0x00020000
    s_mov_b32 s27, s24
    s_cmp_lt_u32 s27, 2
    s_cselect_b32 s6, 31, 63
    s_mov_b32 s7, 1015021568
    s_cselect_b32 s7, 1023410176, s7
    s_sub_u32 s3, s27, 2
    s_cselect_b32 s3, s27, s3
    s_and_b32 s4, s3, 3
    s_lshr_b32 s5, s3, 2
    s_lshl_b32 s5, s5, 5
    v_add_u32 v241, s5, v233
    s_lshl_b32 s4, s4, 4
    v_lshl_add_u32 v242, v234, 2, 0
    v_add_u32 v242, s4, v242
    v_mul_u32_u24 v242, v242, v241
    v_and_b32 v242, s6, v242
    v_cvt_f32_u32 v242, v242
    v_mul_f32 v242, s7, v242
    v_cos_f32 v120, v242
    v_sin_f32 v128, v242
    v_lshl_add_u32 v242, v234, 2, 1
    v_add_u32 v242, s4, v242
    v_mul_u32_u24 v242, v242, v241
    v_and_b32 v242, s6, v242
    v_cvt_f32_u32 v242, v242
    v_mul_f32 v242, s7, v242
    v_cos_f32 v121, v242
    v_sin_f32 v129, v242
    v_lshl_add_u32 v242, v234, 2, 2
    v_add_u32 v242, s4, v242
    v_mul_u32_u24 v242, v242, v241
    v_and_b32 v242, s6, v242
    v_cvt_f32_u32 v242, v242
    v_mul_f32 v242, s7, v242
    v_cos_f32 v122, v242
    v_sin_f32 v130, v242
    v_lshl_add_u32 v242, v234, 2, 3
    v_add_u32 v242, s4, v242
    v_mul_u32_u24 v242, v242, v241
    v_and_b32 v242, s6, v242
    v_cvt_f32_u32 v242, v242
    v_mul_f32 v242, s7, v242
    v_cos_f32 v123, v242
    v_sin_f32 v131, v242
    v_lshl_add_u32 v242, v234, 2, 8
    v_add_u32 v242, s4, v242
    v_mul_u32_u24 v242, v242, v241
    v_and_b32 v242, s6, v242
    v_cvt_f32_u32 v242, v242
    v_mul_f32 v242, s7, v242
    v_cos_f32 v124, v242
    v_sin_f32 v132, v242
    v_lshl_add_u32 v242, v234, 2, 9
    v_add_u32 v242, s4, v242
    v_mul_u32_u24 v242, v242, v241
    v_and_b32 v242, s6, v242
    v_cvt_f32_u32 v242, v242
    v_mul_f32 v242, s7, v242
    v_cos_f32 v125, v242
    v_sin_f32 v133, v242
    v_lshl_add_u32 v242, v234, 2, 10
    v_add_u32 v242, s4, v242
    v_mul_u32_u24 v242, v242, v241
    v_and_b32 v242, s6, v242
    v_cvt_f32_u32 v242, v242
    v_mul_f32 v242, s7, v242
    v_cos_f32 v126, v242
    v_sin_f32 v134, v242
    v_lshl_add_u32 v242, v234, 2, 11
    v_add_u32 v242, s4, v242
    v_mul_u32_u24 v242, v242, v241
    v_and_b32 v242, s6, v242
    v_cvt_f32_u32 v242, v242
    v_mul_f32 v242, s7, v242
    v_cos_f32 v127, v242
    v_sin_f32 v135, v242
    v_cvt_pk_bf16_f32 v136, v120, v121
    v_cvt_pk_bf16_f32 v140, v128, v129
    v_cvt_pk_bf16_f32 v137, v122, v123
    v_cvt_pk_bf16_f32 v141, v130, v131
    v_cvt_pk_bf16_f32 v138, v124, v125
    v_cvt_pk_bf16_f32 v142, v132, v133
    v_cvt_pk_bf16_f32 v139, v126, v127
    v_cvt_pk_bf16_f32 v143, v134, v135
    s_lshl_b32 s3, s27, 11
    s_add_u32 s3, s3, 65536
    v_add_u32 v242, s3, v236
    ds_write_b128 v242, v[136:139]
    ds_write_b128 v242, v[140:143] offset:1024
    s_cmp_ge_u32 s24, 2
    s_cbranch_scc1 Ls2_g2
    s_add_u32 s27, s24, 8
    s_cmp_lt_u32 s27, 2
    s_cselect_b32 s6, 31, 63
    s_mov_b32 s7, 1015021568
    s_cselect_b32 s7, 1023410176, s7
    s_sub_u32 s3, s27, 2
    s_cselect_b32 s3, s27, s3
    s_and_b32 s4, s3, 3
    s_lshr_b32 s5, s3, 2
    s_lshl_b32 s5, s5, 5
    v_add_u32 v241, s5, v233
    s_lshl_b32 s4, s4, 4
    v_lshl_add_u32 v242, v234, 2, 0
    v_add_u32 v242, s4, v242
    v_mul_u32_u24 v242, v242, v241
    v_and_b32 v242, s6, v242
    v_cvt_f32_u32 v242, v242
    v_mul_f32 v242, s7, v242
    v_cos_f32 v120, v242
    v_sin_f32 v128, v242
    v_lshl_add_u32 v242, v234, 2, 1
    v_add_u32 v242, s4, v242
    v_mul_u32_u24 v242, v242, v241
    v_and_b32 v242, s6, v242
    v_cvt_f32_u32 v242, v242
    v_mul_f32 v242, s7, v242
    v_cos_f32 v121, v242
    v_sin_f32 v129, v242
    v_lshl_add_u32 v242, v234, 2, 2
    v_add_u32 v242, s4, v242
    v_mul_u32_u24 v242, v242, v241
    v_and_b32 v242, s6, v242
    v_cvt_f32_u32 v242, v242
    v_mul_f32 v242, s7, v242
    v_cos_f32 v122, v242
    v_sin_f32 v130, v242
    v_lshl_add_u32 v242, v234, 2, 3
    v_add_u32 v242, s4, v242
    v_mul_u32_u24 v242, v242, v241
    v_and_b32 v242, s6, v242
    v_cvt_f32_u32 v242, v242
    v_mul_f32 v242, s7, v242
    v_cos_f32 v123, v242
    v_sin_f32 v131, v242
    v_lshl_add_u32 v242, v234, 2, 8
    v_add_u32 v242, s4, v242
    v_mul_u32_u24 v242, v242, v241
    v_and_b32 v242, s6, v242
    v_cvt_f32_u32 v242, v242
    v_mul_f32 v242, s7, v242
    v_cos_f32 v124, v242
    v_sin_f32 v132, v242
    v_lshl_add_u32 v242, v234, 2, 9
    v_add_u32 v242, s4, v242
    v_mul_u32_u24 v242, v242, v241
    v_and_b32 v242, s6, v242
    v_cvt_f32_u32 v242, v242
    v_mul_f32 v242, s7, v242
    v_cos_f32 v125, v242
    v_sin_f32 v133, v242
    v_lshl_add_u32 v242, v234, 2, 10
    v_add_u32 v242, s4, v242
    v_mul_u32_u24 v242, v242, v241
    v_and_b32 v242, s6, v242
    v_cvt_f32_u32 v242, v242
    v_mul_f32 v242, s7, v242
    v_cos_f32 v126, v242
    v_sin_f32 v134, v242
    v_lshl_add_u32 v242, v234, 2, 11
    v_add_u32 v242, s4, v242
    v_mul_u32_u24 v242, v242, v241
    v_and_b32 v242, s6, v242
    v_cvt_f32_u32 v242, v242
    v_mul_f32 v242, s7, v242
    v_cos_f32 v127, v242
    v_sin_f32 v135, v242
    v_cvt_pk_bf16_f32 v136, v120, v121
    v_cvt_pk_bf16_f32 v140, v128, v129
    v_cvt_pk_bf16_f32 v137, v122, v123
    v_cvt_pk_bf16_f32 v141, v130, v131
    v_cvt_pk_bf16_f32 v138, v124, v125
    v_cvt_pk_bf16_f32 v142, v132, v133
    v_cvt_pk_bf16_f32 v139, v126, v127
    v_cvt_pk_bf16_f32 v143, v134, v135
    s_lshl_b32 s3, s27, 11
    s_add_u32 s3, s3, 65536
    v_add_u32 v242, s3, v236
    ds_write_b128 v242, v[136:139]
    ds_write_b128 v242, v[140:143] offset:1024
Ls2_g2:
    v_add_u32 v238, 32, v233
    s_lshl_b32 s3, s24, 3
    s_add_u32 s3, s3, 0
    s_and_b32 s4, s3, 15
    s_and_b32 s5, s4, 3
    s_lshr_b32 s6, s4, 2
    s_lshl_b32 s6, s6, 3
    s_add_u32 s5, s5, s6
    s_bfe_u32 s6, s3, 0x10004
    s_lshr_b32 s7, s3, 5
    s_lshl_b32 s27, s6, 5
    s_cmp_eq_u32 s7, 0
    s_cselect_b32 s28, s27, 0
    s_cselect_b32 s29, 0, s27
    s_add_u32 s5, s5, s28
    v_lshlrev_b32 v241, 2, v234
    v_add_u32 v241, s5, v241
    v_add_u32 v242, s29, v233
    v_mul_u32_u24 v241, v241, v242
    v_cvt_f32_u32 v241, v241
    v_mul_f32 v241, 0x3a000000, v241
    v_cos_f32 v242, v241
    v_sin_f32 v243, v241
    s_lshl_b32 s3, s3, 9
    s_add_u32 s3, s3, 88064
    v_lshrrev_b32 v241, 1, v236
    v_add_u32 v241, s3, v241
    ds_write_b64 v241, v[242:243]
    s_lshl_b32 s3, s24, 3
    s_add_u32 s3, s3, 1
    s_and_b32 s4, s3, 15
    s_and_b32 s5, s4, 3
    s_lshr_b32 s6, s4, 2
    s_lshl_b32 s6, s6, 3
    s_add_u32 s5, s5, s6
    s_bfe_u32 s6, s3, 0x10004
    s_lshr_b32 s7, s3, 5
    s_lshl_b32 s27, s6, 5
    s_cmp_eq_u32 s7, 0
    s_cselect_b32 s28, s27, 0
    s_cselect_b32 s29, 0, s27
    s_add_u32 s5, s5, s28
    v_lshlrev_b32 v241, 2, v234
    v_add_u32 v241, s5, v241
    v_add_u32 v242, s29, v233
    v_mul_u32_u24 v241, v241, v242
    v_cvt_f32_u32 v241, v241
    v_mul_f32 v241, 0x3a000000, v241
    v_cos_f32 v242, v241
    v_sin_f32 v243, v241
    s_lshl_b32 s3, s3, 9
    s_add_u32 s3, s3, 88064
    v_lshrrev_b32 v241, 1, v236
    v_add_u32 v241, s3, v241
    ds_write_b64 v241, v[242:243]
    s_lshl_b32 s3, s24, 3
    s_add_u32 s3, s3, 2
    s_and_b32 s4, s3, 15
    s_and_b32 s5, s4, 3
    s_lshr_b32 s6, s4, 2
    s_lshl_b32 s6, s6, 3
    s_add_u32 s5, s5, s6
    s_bfe_u32 s6, s3, 0x10004
    s_lshr_b32 s7, s3, 5
    s_lshl_b32 s27, s6, 5
    s_cmp_eq_u32 s7, 0
    s_cselect_b32 s28, s27, 0
    s_cselect_b32 s29, 0, s27
    s_add_u32 s5, s5, s28
    v_lshlrev_b32 v241, 2, v234
    v_add_u32 v241, s5, v241
    v_add_u32 v242, s29, v233
    v_mul_u32_u24 v241, v241, v242
    v_cvt_f32_u32 v241, v241
    v_mul_f32 v241, 0x3a000000, v241
    v_cos_f32 v242, v241
    v_sin_f32 v243, v241
    s_lshl_b32 s3, s3, 9
    s_add_u32 s3, s3, 88064
    v_lshrrev_b32 v241, 1, v236
    v_add_u32 v241, s3, v241
    ds_write_b64 v241, v[242:243]
    s_lshl_b32 s3, s24, 3
    s_add_u32 s3, s3, 3
    s_and_b32 s4, s3, 15
    s_and_b32 s5, s4, 3
    s_lshr_b32 s6, s4, 2
    s_lshl_b32 s6, s6, 3
    s_add_u32 s5, s5, s6
    s_bfe_u32 s6, s3, 0x10004
    s_lshr_b32 s7, s3, 5
    s_lshl_b32 s27, s6, 5
    s_cmp_eq_u32 s7, 0
    s_cselect_b32 s28, s27, 0
    s_cselect_b32 s29, 0, s27
    s_add_u32 s5, s5, s28
    v_lshlrev_b32 v241, 2, v234
    v_add_u32 v241, s5, v241
    v_add_u32 v242, s29, v233
    v_mul_u32_u24 v241, v241, v242
    v_cvt_f32_u32 v241, v241
    v_mul_f32 v241, 0x3a000000, v241
    v_cos_f32 v242, v241
    v_sin_f32 v243, v241
    s_lshl_b32 s3, s3, 9
    s_add_u32 s3, s3, 88064
    v_lshrrev_b32 v241, 1, v236
    v_add_u32 v241, s3, v241
    ds_write_b64 v241, v[242:243]
    s_lshl_b32 s3, s24, 3
    s_add_u32 s3, s3, 4
    s_and_b32 s4, s3, 15
    s_and_b32 s5, s4, 3
    s_lshr_b32 s6, s4, 2
    s_lshl_b32 s6, s6, 3
    s_add_u32 s5, s5, s6
    s_bfe_u32 s6, s3, 0x10004
    s_lshr_b32 s7, s3, 5
    s_lshl_b32 s27, s6, 5
    s_cmp_eq_u32 s7, 0
    s_cselect_b32 s28, s27, 0
    s_cselect_b32 s29, 0, s27
    s_add_u32 s5, s5, s28
    v_lshlrev_b32 v241, 2, v234
    v_add_u32 v241, s5, v241
    v_add_u32 v242, s29, v233
    v_mul_u32_u24 v241, v241, v242
    v_cvt_f32_u32 v241, v241
    v_mul_f32 v241, 0x3a000000, v241
    v_cos_f32 v242, v241
    v_sin_f32 v243, v241
    s_lshl_b32 s3, s3, 9
    s_add_u32 s3, s3, 88064
    v_lshrrev_b32 v241, 1, v236
    v_add_u32 v241, s3, v241
    ds_write_b64 v241, v[242:243]
    s_lshl_b32 s3, s24, 3
    s_add_u32 s3, s3, 5
    s_and_b32 s4, s3, 15
    s_and_b32 s5, s4, 3
    s_lshr_b32 s6, s4, 2
    s_lshl_b32 s6, s6, 3
    s_add_u32 s5, s5, s6
    s_bfe_u32 s6, s3, 0x10004
    s_lshr_b32 s7, s3, 5
    s_lshl_b32 s27, s6, 5
    s_cmp_eq_u32 s7, 0
    s_cselect_b32 s28, s27, 0
    s_cselect_b32 s29, 0, s27
    s_add_u32 s5, s5, s28
    v_lshlrev_b32 v241, 2, v234
    v_add_u32 v241, s5, v241
    v_add_u32 v242, s29, v233
    v_mul_u32_u24 v241, v241, v242
    v_cvt_f32_u32 v241, v241
    v_mul_f32 v241, 0x3a000000, v241
    v_cos_f32 v242, v241
    v_sin_f32 v243, v241
    s_lshl_b32 s3, s3, 9
    s_add_u32 s3, s3, 88064
    v_lshrrev_b32 v241, 1, v236
    v_add_u32 v241, s3, v241
    ds_write_b64 v241, v[242:243]
    s_lshl_b32 s3, s24, 3
    s_add_u32 s3, s3, 6
    s_and_b32 s4, s3, 15
    s_and_b32 s5, s4, 3
    s_lshr_b32 s6, s4, 2
    s_lshl_b32 s6, s6, 3
    s_add_u32 s5, s5, s6
    s_bfe_u32 s6, s3, 0x10004
    s_lshr_b32 s7, s3, 5
    s_lshl_b32 s27, s6, 5
    s_cmp_eq_u32 s7, 0
    s_cselect_b32 s28, s27, 0
    s_cselect_b32 s29, 0, s27
    s_add_u32 s5, s5, s28
    v_lshlrev_b32 v241, 2, v234
    v_add_u32 v241, s5, v241
    v_add_u32 v242, s29, v233
    v_mul_u32_u24 v241, v241, v242
    v_cvt_f32_u32 v241, v241
    v_mul_f32 v241, 0x3a000000, v241
    v_cos_f32 v242, v241
    v_sin_f32 v243, v241
    s_lshl_b32 s3, s3, 9
    s_add_u32 s3, s3, 88064
    v_lshrrev_b32 v241, 1, v236
    v_add_u32 v241, s3, v241
    ds_write_b64 v241, v[242:243]
    s_lshl_b32 s3, s24, 3
    s_add_u32 s3, s3, 7
    s_and_b32 s4, s3, 15
    s_and_b32 s5, s4, 3
    s_lshr_b32 s6, s4, 2
    s_lshl_b32 s6, s6, 3
    s_add_u32 s5, s5, s6
    s_bfe_u32 s6, s3, 0x10004
    s_lshr_b32 s7, s3, 5
    s_lshl_b32 s27, s6, 5
    s_cmp_eq_u32 s7, 0
    s_cselect_b32 s28, s27, 0
    s_cselect_b32 s29, 0, s27
    s_add_u32 s5, s5, s28
    v_lshlrev_b32 v241, 2, v234
    v_add_u32 v241, s5, v241
    v_add_u32 v242, s29, v233
    v_mul_u32_u24 v241, v241, v242
    v_cvt_f32_u32 v241, v241
    v_mul_f32 v241, 0x3a000000, v241
    v_cos_f32 v242, v241
    v_sin_f32 v243, v241
    s_lshl_b32 s3, s3, 9
    s_add_u32 s3, s3, 88064
    v_lshrrev_b32 v241, 1, v236
    v_add_u32 v241, s3, v241
    ds_write_b64 v241, v[242:243]
    s_waitcnt vmcnt(0)
    s_bfe_u32 s4, s24, 0x10002
    s_lshl_b32 s3, s4, 9
    s_and_b32 s4, s24, 3
    s_lshl_b32 s4, s4, 2
    s_add_u32 s3, s3, s4
    v_lshlrev_b32 v235, 13, v234
    v_lshl_add_u32 v235, v233, 4, v235
    v_add_u32 v235, s3, v235
    s_waitcnt lgkmcnt(0)
    s_barrier
    s_cmp_lt_u32 s25, 289
    s_cbranch_scc1 Ls2_go
    v_mov_b32 v88, 0
    v_mov_b32 v89, 0
    v_mov_b32 v90, 0
    v_mov_b32 v91, 0
    v_mov_b32 v92, 0
    v_mov_b32 v93, 0
    v_mov_b32 v94, 0
    v_mov_b32 v95, 0
    v_mov_b32 v96, 0
    v_mov_b32 v97, 0
    v_mov_b32 v98, 0
    v_mov_b32 v99, 0
    v_mov_b32 v100, 0
    v_mov_b32 v101, 0
    v_mov_b32 v102, 0
    v_mov_b32 v103, 0
    v_mov_b32 v104, 0
    v_mov_b32 v105, 0
    v_mov_b32 v106, 0
    v_mov_b32 v107, 0
    v_mov_b32 v108, 0
    v_mov_b32 v109, 0
    v_mov_b32 v110, 0
    v_mov_b32 v111, 0
    v_mov_b32 v112, 0
    v_mov_b32 v113, 0
    v_mov_b32 v114, 0
    v_mov_b32 v115, 0
    v_mov_b32 v116, 0
    v_mov_b32 v117, 0
    v_mov_b32 v118, 0
    v_mov_b32 v119, 0
    s_branch Ls2_fin
Ls2_go:
    v_add_u32 v237, 65536, v236
    ds_read_b128 v[0:3], v237 offset:0
    ds_read_b128 v[8:11], v237 offset:1024
    ds_read_b128 v[4:7], v237 offset:2048
    ds_read_b128 v[12:15], v237 offset:3072
    ds_read_b128 v[24:27], v237 offset:4096
    ds_read_b128 v[56:59], v237 offset:5120
    ds_read_b128 v[28:31], v237 offset:6144
    ds_read_b128 v[60:63], v237 offset:7168
    ds_read_b128 v[32:35], v237 offset:8192
    ds_read_b128 v[64:67], v237 offset:9216
    ds_read_b128 v[36:39], v237 offset:10240
    ds_read_b128 v[68:71], v237 offset:11264
    ds_read_b128 v[40:43], v237 offset:12288
    ds_read_b128 v[72:75], v237 offset:13312
    ds_read_b128 v[44:47], v237 offset:14336
    ds_read_b128 v[76:79], v237 offset:15360
    ds_read_b128 v[48:51], v237 offset:16384
    ds_read_b128 v[80:83], v237 offset:17408
    ds_read_b128 v[52:55], v237 offset:18432
    ds_read_b128 v[84:87], v237 offset:19456
    s_waitcnt lgkmcnt(0)
    v_xor_b32 v16, 0x80008000, v8
    v_xor_b32 v17, 0x80008000, v9
    v_xor_b32 v18, 0x80008000, v10
    v_xor_b32 v19, 0x80008000, v11
    v_xor_b32 v20, 0x80008000, v12
    v_xor_b32 v21, 0x80008000, v13
    v_xor_b32 v22, 0x80008000, v14
    v_xor_b32 v23, 0x80008000, v15
    v_lshrrev_b32 v239, 1, v236
    v_add_u32 v239, 88064, v239
    v_mfma_f32_32x32x16_bf16 v[168:183], v[88:91], v[0:3], 0
    v_mfma_f32_32x32x16_bf16 v[200:215], v[104:107], v[0:3], 0
    v_mfma_f32_32x32x16_bf16 v[168:183], v[92:95], v[4:7], v[168:183]
    v_mfma_f32_32x32x16_bf16 v[200:215], v[108:111], v[4:7], v[200:215]
    v_mfma_f32_32x32x16_bf16 v[168:183], v[104:107], v[8:11], v[168:183]
    v_mfma_f32_32x32x16_bf16 v[200:215], v[88:91], v[16:19], v[200:215]
    v_mfma_f32_32x32x16_bf16 v[168:183], v[108:111], v[12:15], v[168:183]
    v_mfma_f32_32x32x16_bf16 v[200:215], v[92:95], v[20:23], v[200:215]
    v_mfma_f32_32x32x16_bf16 v[184:199], v[96:99], v[0:3], 0
    v_mfma_f32_32x32x16_bf16 v[216:231], v[112:115], v[0:3], 0
    v_mfma_f32_32x32x16_bf16 v[184:199], v[100:103], v[4:7], v[184:199]
    v_mfma_f32_32x32x16_bf16 v[216:231], v[116:119], v[4:7], v[216:231]
    v_mfma_f32_32x32x16_bf16 v[184:199], v[112:115], v[8:11], v[184:199]
    v_mfma_f32_32x32x16_bf16 v[216:231], v[96:99], v[16:19], v[216:231]
    v_mfma_f32_32x32x16_bf16 v[184:199], v[116:119], v[12:15], v[184:199]
    v_mfma_f32_32x32x16_bf16 v[216:231], v[100:103], v[20:23], v[216:231]
    ds_read_b64 v[88:89], v239 offset:0
    ds_read_b64 v[90:91], v239 offset:512
    ds_read_b64 v[92:93], v239 offset:1024
    ds_read_b64 v[94:95], v239 offset:1536
    ds_read_b64 v[96:97], v239 offset:2048
    ds_read_b64 v[98:99], v239 offset:2560
    ds_read_b64 v[100:101], v239 offset:3072
    ds_read_b64 v[102:103], v239 offset:3584
    ds_read_b64 v[104:105], v239 offset:4096
    ds_read_b64 v[106:107], v239 offset:4608
    ds_read_b64 v[108:109], v239 offset:5120
    ds_read_b64 v[110:111], v239 offset:5632
    ds_read_b64 v[112:113], v239 offset:6144
    ds_read_b64 v[114:115], v239 offset:6656
    ds_read_b64 v[116:117], v239 offset:7168
    ds_read_b64 v[118:119], v239 offset:7680
    ds_read_b64 v[120:121], v239 offset:8192
    ds_read_b64 v[122:123], v239 offset:8704
    ds_read_b64 v[124:125], v239 offset:9216
    ds_read_b64 v[126:127], v239 offset:9728
    ds_read_b64 v[128:129], v239 offset:10240
    ds_read_b64 v[130:131], v239 offset:10752
    ds_read_b64 v[132:133], v239 offset:11264
    ds_read_b64 v[134:135], v239 offset:11776
    ds_read_b64 v[136:137], v239 offset:12288
    ds_read_b64 v[138:139], v239 offset:12800
    ds_read_b64 v[140:141], v239 offset:13312
    ds_read_b64 v[142:143], v239 offset:13824
    ds_read_b64 v[144:145], v239 offset:14336
    ds_read_b64 v[146:147], v239 offset:14848
    ds_read_b64 v[148:149], v239 offset:15360
    ds_read_b64 v[150:151], v239 offset:15872
    s_waitcnt lgkmcnt(0)
    v_mul_f32 v240, v168, v88
    v_mul_f32 v241, v200, v88
    v_fma_f32 v240, v200, v89, v240
    v_fma_f32 v200, -v168, v89, v241
    v_mov_b32 v168, v240
    v_mul_f32 v242, v169, v90
    v_mul_f32 v243, v201, v90
    v_fma_f32 v242, v201, v91, v242
    v_fma_f32 v201, -v169, v91, v243
    v_mov_b32 v169, v242
    v_mul_f32 v240, v170, v92
    v_mul_f32 v241, v202, v92
    v_fma_f32 v240, v202, v93, v240
    v_fma_f32 v202, -v170, v93, v241
    v_mov_b32 v170, v240
    v_mul_f32 v242, v171, v94
    v_mul_f32 v243, v203, v94
    v_fma_f32 v242, v203, v95, v242
    v_fma_f32 v203, -v171, v95, v243
    v_mov_b32 v171, v242
    v_mul_f32 v240, v172, v96
    v_mul_f32 v241, v204, v96
    v_fma_f32 v240, v204, v97, v240
    v_fma_f32 v204, -v172, v97, v241
    v_mov_b32 v172, v240
    v_mul_f32 v242, v173, v98
    v_mul_f32 v243, v205, v98
    v_fma_f32 v242, v205, v99, v242
    v_fma_f32 v205, -v173, v99, v243
    v_mov_b32 v173, v242
    v_mul_f32 v240, v174, v100
    v_mul_f32 v241, v206, v100
    v_fma_f32 v240, v206, v101, v240
    v_fma_f32 v206, -v174, v101, v241
    v_mov_b32 v174, v240
    v_mul_f32 v242, v175, v102
    v_mul_f32 v243, v207, v102
    v_fma_f32 v242, v207, v103, v242
    v_fma_f32 v207, -v175, v103, v243
    v_mov_b32 v175, v242
    v_mul_f32 v240, v176, v104
    v_mul_f32 v241, v208, v104
    v_fma_f32 v240, v208, v105, v240
    v_fma_f32 v208, -v176, v105, v241
    v_mov_b32 v176, v240
    v_mul_f32 v242, v177, v106
    v_mul_f32 v243, v209, v106
    v_fma_f32 v242, v209, v107, v242
    v_fma_f32 v209, -v177, v107, v243
    v_mov_b32 v177, v242
    v_mul_f32 v240, v178, v108
    v_mul_f32 v241, v210, v108
    v_fma_f32 v240, v210, v109, v240
    v_fma_f32 v210, -v178, v109, v241
    v_mov_b32 v178, v240
    v_mul_f32 v242, v179, v110
    v_mul_f32 v243, v211, v110
    v_fma_f32 v242, v211, v111, v242
    v_fma_f32 v211, -v179, v111, v243
    v_mov_b32 v179, v242
    v_mul_f32 v240, v180, v112
    v_mul_f32 v241, v212, v112
    v_fma_f32 v240, v212, v113, v240
    v_fma_f32 v212, -v180, v113, v241
    v_mov_b32 v180, v240
    v_mul_f32 v242, v181, v114
    v_mul_f32 v243, v213, v114
    v_fma_f32 v242, v213, v115, v242
    v_fma_f32 v213, -v181, v115, v243
    v_mov_b32 v181, v242
    v_mul_f32 v240, v182, v116
    v_mul_f32 v241, v214, v116
    v_fma_f32 v240, v214, v117, v240
    v_fma_f32 v214, -v182, v117, v241
    v_mov_b32 v182, v240
    v_mul_f32 v242, v183, v118
    v_mul_f32 v243, v215, v118
    v_fma_f32 v242, v215, v119, v242
    v_fma_f32 v215, -v183, v119, v243
    v_mov_b32 v183, v242
    v_mul_f32 v240, v184, v120
    v_mul_f32 v241, v216, v120
    v_fma_f32 v240, v216, v121, v240
    v_fma_f32 v216, -v184, v121, v241
    v_mov_b32 v184, v240
    v_mul_f32 v242, v185, v122
    v_mul_f32 v243, v217, v122
    v_fma_f32 v242, v217, v123, v242
    v_fma_f32 v217, -v185, v123, v243
    v_mov_b32 v185, v242
    v_mul_f32 v240, v186, v124
    v_mul_f32 v241, v218, v124
    v_fma_f32 v240, v218, v125, v240
    v_fma_f32 v218, -v186, v125, v241
    v_mov_b32 v186, v240
    v_mul_f32 v242, v187, v126
    v_mul_f32 v243, v219, v126
    v_fma_f32 v242, v219, v127, v242
    v_fma_f32 v219, -v187, v127, v243
    v_mov_b32 v187, v242
    v_mul_f32 v240, v188, v128
    v_mul_f32 v241, v220, v128
    v_fma_f32 v240, v220, v129, v240
    v_fma_f32 v220, -v188, v129, v241
    v_mov_b32 v188, v240
    v_mul_f32 v242, v189, v130
    v_mul_f32 v243, v221, v130
    v_fma_f32 v242, v221, v131, v242
    v_fma_f32 v221, -v189, v131, v243
    v_mov_b32 v189, v242
    v_mul_f32 v240, v190, v132
    v_mul_f32 v241, v222, v132
    v_fma_f32 v240, v222, v133, v240
    v_fma_f32 v222, -v190, v133, v241
    v_mov_b32 v190, v240
    v_mul_f32 v242, v191, v134
    v_mul_f32 v243, v223, v134
    v_fma_f32 v242, v223, v135, v242
    v_fma_f32 v223, -v191, v135, v243
    v_mov_b32 v191, v242
    v_mul_f32 v240, v192, v136
    v_mul_f32 v241, v224, v136
    v_fma_f32 v240, v224, v137, v240
    v_fma_f32 v224, -v192, v137, v241
    v_mov_b32 v192, v240
    v_mul_f32 v242, v193, v138
    v_mul_f32 v243, v225, v138
    v_fma_f32 v242, v225, v139, v242
    v_fma_f32 v225, -v193, v139, v243
    v_mov_b32 v193, v242
    v_mul_f32 v240, v194, v140
    v_mul_f32 v241, v226, v140
    v_fma_f32 v240, v226, v141, v240
    v_fma_f32 v226, -v194, v141, v241
    v_mov_b32 v194, v240
    v_mul_f32 v242, v195, v142
    v_mul_f32 v243, v227, v142
    v_fma_f32 v242, v227, v143, v242
    v_fma_f32 v227, -v195, v143, v243
    v_mov_b32 v195, v242
    v_mul_f32 v240, v196, v144
    v_mul_f32 v241, v228, v144
    v_fma_f32 v240, v228, v145, v240
    v_fma_f32 v228, -v196, v145, v241
    v_mov_b32 v196, v240
    v_mul_f32 v242, v197, v146
    v_mul_f32 v243, v229, v146
    v_fma_f32 v242, v229, v147, v242
    v_fma_f32 v229, -v197, v147, v243
    v_mov_b32 v197, v242
    v_mul_f32 v240, v198, v148
    v_mul_f32 v241, v230, v148
    v_fma_f32 v240, v230, v149, v240
    v_fma_f32 v230, -v198, v149, v241
    v_mov_b32 v198, v240
    v_mul_f32 v242, v199, v150
    v_mul_f32 v243, v231, v150
    v_fma_f32 v242, v231, v151, v242
    v_fma_f32 v231, -v199, v151, v243
    v_mov_b32 v199, v242
    v_cvt_pk_bf16_f32 v120, v168, v169
    v_cvt_pk_bf16_f32 v136, v200, v201
    v_xor_b32 v152, 0x80008000, v120
    v_cvt_pk_bf16_f32 v121, v170, v171
    v_cvt_pk_bf16_f32 v137, v202, v203
    v_xor_b32 v153, 0x80008000, v121
    v_cvt_pk_bf16_f32 v122, v172, v173
    v_cvt_pk_bf16_f32 v138, v204, v205
    v_xor_b32 v154, 0x80008000, v122
    v_cvt_pk_bf16_f32 v123, v174, v175
    v_cvt_pk_bf16_f32 v139, v206, v207
    v_xor_b32 v155, 0x80008000, v123
    v_cvt_pk_bf16_f32 v124, v176, v177
    v_cvt_pk_bf16_f32 v140, v208, v209
    v_xor_b32 v156, 0x80008000, v124
    v_cvt_pk_bf16_f32 v125, v178, v179
    v_cvt_pk_bf16_f32 v141, v210, v211
    v_xor_b32 v157, 0x80008000, v125
    v_cvt_pk_bf16_f32 v126, v180, v181
    v_cvt_pk_bf16_f32 v142, v212, v213
    v_xor_b32 v158, 0x80008000, v126
    v_cvt_pk_bf16_f32 v127, v182, v183
    v_cvt_pk_bf16_f32 v143, v214, v215
    v_xor_b32 v159, 0x80008000, v127
    v_cvt_pk_bf16_f32 v128, v184, v185
    v_cvt_pk_bf16_f32 v144, v216, v217
    v_xor_b32 v160, 0x80008000, v128
    v_cvt_pk_bf16_f32 v129, v186, v187
    v_cvt_pk_bf16_f32 v145, v218, v219
    v_xor_b32 v161, 0x80008000, v129
    v_cvt_pk_bf16_f32 v130, v188, v189
    v_cvt_pk_bf16_f32 v146, v220, v221
    v_xor_b32 v162, 0x80008000, v130
    v_cvt_pk_bf16_f32 v131, v190, v191
    v_cvt_pk_bf16_f32 v147, v222, v223
    v_xor_b32 v163, 0x80008000, v131
    v_cvt_pk_bf16_f32 v132, v192, v193
    v_cvt_pk_bf16_f32 v148, v224, v225
    v_xor_b32 v164, 0x80008000, v132
    v_cvt_pk_bf16_f32 v133, v194, v195
    v_cvt_pk_bf16_f32 v149, v226, v227
    v_xor_b32 v165, 0x80008000, v133
    v_cvt_pk_bf16_f32 v134, v196, v197
    v_cvt_pk_bf16_f32 v150, v228, v229
    v_xor_b32 v166, 0x80008000, v134
    v_cvt_pk_bf16_f32 v135, v198, v199
    v_cvt_pk_bf16_f32 v151, v230, v231
    v_xor_b32 v167, 0x80008000, v135
    s_lshl_b32 s3, s25, 13
    v_lshlrev_b32 v237, 9, v234
    v_lshl_add_u32 v237, v233, 2, v237
    v_add_u32 v238, 4096, v237
    buffer_load_dword v88, v237, s[16:19], s3 offen offset:0
    buffer_load_dword v89, v237, s[16:19], s3 offen offset:128
    buffer_load_dword v90, v237, s[16:19], s3 offen offset:256
    buffer_load_dword v91, v237, s[16:19], s3 offen offset:384
    buffer_load_dword v92, v237, s[16:19], s3 offen offset:1024
    buffer_load_dword v93, v237, s[16:19], s3 offen offset:1152
    buffer_load_dword v94, v237, s[16:19], s3 offen offset:1280
    buffer_load_dword v95, v237, s[16:19], s3 offen offset:1408
    buffer_load_dword v96, v237, s[16:19], s3 offen offset:2048
    buffer_load_dword v97, v237, s[16:19], s3 offen offset:2176
    buffer_load_dword v98, v237, s[16:19], s3 offen offset:2304
    buffer_load_dword v99, v237, s[16:19], s3 offen offset:2432
    buffer_load_dword v100, v237, s[16:19], s3 offen offset:3072
    buffer_load_dword v101, v237, s[16:19], s3 offen offset:3200
    buffer_load_dword v102, v237, s[16:19], s3 offen offset:3328
    buffer_load_dword v103, v237, s[16:19], s3 offen offset:3456
    buffer_load_dword v104, v238, s[16:19], s3 offen offset:0
    buffer_load_dword v105, v238, s[16:19], s3 offen offset:128
    buffer_load_dword v106, v238, s[16:19], s3 offen offset:256
    buffer_load_dword v107, v238, s[16:19], s3 offen offset:384
    buffer_load_dword v108, v238, s[16:19], s3 offen offset:1024
    buffer_load_dword v109, v238, s[16:19], s3 offen offset:1152
    buffer_load_dword v110, v238, s[16:19], s3 offen offset:1280
    buffer_load_dword v111, v238, s[16:19], s3 offen offset:1408
    buffer_load_dword v112, v238, s[16:19], s3 offen offset:2048
    buffer_load_dword v113, v238, s[16:19], s3 offen offset:2176
    buffer_load_dword v114, v238, s[16:19], s3 offen offset:2304
    buffer_load_dword v115, v238, s[16:19], s3 offen offset:2432
    buffer_load_dword v116, v238, s[16:19], s3 offen offset:3072
    buffer_load_dword v117, v238, s[16:19], s3 offen offset:3200
    buffer_load_dword v118, v238, s[16:19], s3 offen offset:3328
    buffer_load_dword v119, v238, s[16:19], s3 offen offset:3456
    v_mfma_f32_32x32x16_bf16 v[168:183], v[24:27], v[120:123], 0
    v_mfma_f32_32x32x16_bf16 v[200:215], v[24:27], v[136:139], 0
    v_mfma_f32_32x32x16_bf16 v[168:183], v[28:31], v[124:127], v[168:183]
    v_mfma_f32_32x32x16_bf16 v[200:215], v[28:31], v[140:143], v[200:215]
    v_mfma_f32_32x32x16_bf16 v[168:183], v[32:35], v[128:131], v[168:183]
    v_mfma_f32_32x32x16_bf16 v[200:215], v[32:35], v[144:147], v[200:215]
    v_mfma_f32_32x32x16_bf16 v[168:183], v[36:39], v[132:135], v[168:183]
    v_mfma_f32_32x32x16_bf16 v[200:215], v[36:39], v[148:151], v[200:215]
    v_mfma_f32_32x32x16_bf16 v[168:183], v[56:59], v[136:139], v[168:183]
    v_mfma_f32_32x32x16_bf16 v[200:215], v[56:59], v[152:155], v[200:215]
    v_mfma_f32_32x32x16_bf16 v[168:183], v[60:63], v[140:143], v[168:183]
    v_mfma_f32_32x32x16_bf16 v[200:215], v[60:63], v[156:159], v[200:215]
    v_mfma_f32_32x32x16_bf16 v[168:183], v[64:67], v[144:147], v[168:183]
    v_mfma_f32_32x32x16_bf16 v[200:215], v[64:67], v[160:163], v[200:215]
    v_mfma_f32_32x32x16_bf16 v[168:183], v[68:71], v[148:151], v[168:183]
    v_mfma_f32_32x32x16_bf16 v[200:215], v[68:71], v[164:167], v[200:215]
    v_mfma_f32_32x32x16_bf16 v[184:199], v[40:43], v[120:123], 0
    v_mfma_f32_32x32x16_bf16 v[216:231], v[40:43], v[136:139], 0
    v_mfma_f32_32x32x16_bf16 v[184:199], v[44:47], v[124:127], v[184:199]
    v_mfma_f32_32x32x16_bf16 v[216:231], v[44:47], v[140:143], v[216:231]
    v_mfma_f32_32x32x16_bf16 v[184:199], v[48:51], v[128:131], v[184:199]
    v_mfma_f32_32x32x16_bf16 v[216:231], v[48:51], v[144:147], v[216:231]
    v_mfma_f32_32x32x16_bf16 v[184:199], v[52:55], v[132:135], v[184:199]
    v_mfma_f32_32x32x16_bf16 v[216:231], v[52:55], v[148:151], v[216:231]
    v_mfma_f32_32x32x16_bf16 v[184:199], v[72:75], v[136:139], v[184:199]
    v_mfma_f32_32x32x16_bf16 v[216:231], v[72:75], v[152:155], v[216:231]
    v_mfma_f32_32x32x16_bf16 v[184:199], v[76:79], v[140:143], v[184:199]
    v_mfma_f32_32x32x16_bf16 v[216:231], v[76:79], v[156:159], v[216:231]
    v_mfma_f32_32x32x16_bf16 v[184:199], v[80:83], v[144:147], v[184:199]
    v_mfma_f32_32x32x16_bf16 v[216:231], v[80:83], v[160:163], v[216:231]
    v_mfma_f32_32x32x16_bf16 v[184:199], v[84:87], v[148:151], v[184:199]
    v_mfma_f32_32x32x16_bf16 v[216:231], v[84:87], v[164:167], v[216:231]
    s_waitcnt vmcnt(0)
    v_lshlrev_b32 v240, 16, v88
    v_and_b32 v241, 0xffff0000, v88
    v_mul_f32 v242, v168, v240
    v_mul_f32 v243, v200, v240
    v_fma_f32 v242, -v200, v241, v242
    v_fma_f32 v200, v168, v241, v243
    v_mov_b32 v168, v242
    v_lshlrev_b32 v244, 16, v89
    v_and_b32 v245, 0xffff0000, v89
    v_mul_f32 v246, v169, v244
    v_mul_f32 v247, v201, v244
    v_fma_f32 v246, -v201, v245, v246
    v_fma_f32 v201, v169, v245, v247
    v_mov_b32 v169, v246
    v_lshlrev_b32 v240, 16, v90
    v_and_b32 v241, 0xffff0000, v90
    v_mul_f32 v242, v170, v240
    v_mul_f32 v243, v202, v240
    v_fma_f32 v242, -v202, v241, v242
    v_fma_f32 v202, v170, v241, v243
    v_mov_b32 v170, v242
    v_lshlrev_b32 v244, 16, v91
    v_and_b32 v245, 0xffff0000, v91
    v_mul_f32 v246, v171, v244
    v_mul_f32 v247, v203, v244
    v_fma_f32 v246, -v203, v245, v246
    v_fma_f32 v203, v171, v245, v247
    v_mov_b32 v171, v246
    v_lshlrev_b32 v240, 16, v92
    v_and_b32 v241, 0xffff0000, v92
    v_mul_f32 v242, v172, v240
    v_mul_f32 v243, v204, v240
    v_fma_f32 v242, -v204, v241, v242
    v_fma_f32 v204, v172, v241, v243
    v_mov_b32 v172, v242
    v_lshlrev_b32 v244, 16, v93
    v_and_b32 v245, 0xffff0000, v93
    v_mul_f32 v246, v173, v244
    v_mul_f32 v247, v205, v244
    v_fma_f32 v246, -v205, v245, v246
    v_fma_f32 v205, v173, v245, v247
    v_mov_b32 v173, v246
    v_lshlrev_b32 v240, 16, v94
    v_and_b32 v241, 0xffff0000, v94
    v_mul_f32 v242, v174, v240
    v_mul_f32 v243, v206, v240
    v_fma_f32 v242, -v206, v241, v242
    v_fma_f32 v206, v174, v241, v243
    v_mov_b32 v174, v242
    v_lshlrev_b32 v244, 16, v95
    v_and_b32 v245, 0xffff0000, v95
    v_mul_f32 v246, v175, v244
    v_mul_f32 v247, v207, v244
    v_fma_f32 v246, -v207, v245, v246
    v_fma_f32 v207, v175, v245, v247
    v_mov_b32 v175, v246
    v_lshlrev_b32 v240, 16, v96
    v_and_b32 v241, 0xffff0000, v96
    v_mul_f32 v242, v176, v240
    v_mul_f32 v243, v208, v240
    v_fma_f32 v242, -v208, v241, v242
    v_fma_f32 v208, v176, v241, v243
    v_mov_b32 v176, v242
    v_lshlrev_b32 v244, 16, v97
    v_and_b32 v245, 0xffff0000, v97
    v_mul_f32 v246, v177, v244
    v_mul_f32 v247, v209, v244
    v_fma_f32 v246, -v209, v245, v246
    v_fma_f32 v209, v177, v245, v247
    v_mov_b32 v177, v246
    v_lshlrev_b32 v240, 16, v98
    v_and_b32 v241, 0xffff0000, v98
    v_mul_f32 v242, v178, v240
    v_mul_f32 v243, v210, v240
    v_fma_f32 v242, -v210, v241, v242
    v_fma_f32 v210, v178, v241, v243
    v_mov_b32 v178, v242
    v_lshlrev_b32 v244, 16, v99
    v_and_b32 v245, 0xffff0000, v99
    v_mul_f32 v246, v179, v244
    v_mul_f32 v247, v211, v244
    v_fma_f32 v246, -v211, v245, v246
    v_fma_f32 v211, v179, v245, v247
    v_mov_b32 v179, v246
    v_lshlrev_b32 v240, 16, v100
    v_and_b32 v241, 0xffff0000, v100
    v_mul_f32 v242, v180, v240
    v_mul_f32 v243, v212, v240
    v_fma_f32 v242, -v212, v241, v242
    v_fma_f32 v212, v180, v241, v243
    v_mov_b32 v180, v242
    v_lshlrev_b32 v244, 16, v101
    v_and_b32 v245, 0xffff0000, v101
    v_mul_f32 v246, v181, v244
    v_mul_f32 v247, v213, v244
    v_fma_f32 v246, -v213, v245, v246
    v_fma_f32 v213, v181, v245, v247
    v_mov_b32 v181, v246
    v_lshlrev_b32 v240, 16, v102
    v_and_b32 v241, 0xffff0000, v102
    v_mul_f32 v242, v182, v240
    v_mul_f32 v243, v214, v240
    v_fma_f32 v242, -v214, v241, v242
    v_fma_f32 v214, v182, v241, v243
    v_mov_b32 v182, v242
    v_lshlrev_b32 v244, 16, v103
    v_and_b32 v245, 0xffff0000, v103
    v_mul_f32 v246, v183, v244
    v_mul_f32 v247, v215, v244
    v_fma_f32 v246, -v215, v245, v246
    v_fma_f32 v215, v183, v245, v247
    v_mov_b32 v183, v246
    v_lshlrev_b32 v240, 16, v104
    v_and_b32 v241, 0xffff0000, v104
    v_mul_f32 v242, v184, v240
    v_mul_f32 v243, v216, v240
    v_fma_f32 v242, -v216, v241, v242
    v_fma_f32 v216, v184, v241, v243
    v_mov_b32 v184, v242
    v_lshlrev_b32 v244, 16, v105
    v_and_b32 v245, 0xffff0000, v105
    v_mul_f32 v246, v185, v244
    v_mul_f32 v247, v217, v244
    v_fma_f32 v246, -v217, v245, v246
    v_fma_f32 v217, v185, v245, v247
    v_mov_b32 v185, v246
    v_lshlrev_b32 v240, 16, v106
    v_and_b32 v241, 0xffff0000, v106
    v_mul_f32 v242, v186, v240
    v_mul_f32 v243, v218, v240
    v_fma_f32 v242, -v218, v241, v242
    v_fma_f32 v218, v186, v241, v243
    v_mov_b32 v186, v242
    v_lshlrev_b32 v244, 16, v107
    v_and_b32 v245, 0xffff0000, v107
    v_mul_f32 v246, v187, v244
    v_mul_f32 v247, v219, v244
    v_fma_f32 v246, -v219, v245, v246
    v_fma_f32 v219, v187, v245, v247
    v_mov_b32 v187, v246
    v_lshlrev_b32 v240, 16, v108
    v_and_b32 v241, 0xffff0000, v108
    v_mul_f32 v242, v188, v240
    v_mul_f32 v243, v220, v240
    v_fma_f32 v242, -v220, v241, v242
    v_fma_f32 v220, v188, v241, v243
    v_mov_b32 v188, v242
    v_lshlrev_b32 v244, 16, v109
    v_and_b32 v245, 0xffff0000, v109
    v_mul_f32 v246, v189, v244
    v_mul_f32 v247, v221, v244
    v_fma_f32 v246, -v221, v245, v246
    v_fma_f32 v221, v189, v245, v247
    v_mov_b32 v189, v246
    v_lshlrev_b32 v240, 16, v110
    v_and_b32 v241, 0xffff0000, v110
    v_mul_f32 v242, v190, v240
    v_mul_f32 v243, v222, v240
    v_fma_f32 v242, -v222, v241, v242
    v_fma_f32 v222, v190, v241, v243
    v_mov_b32 v190, v242
    v_lshlrev_b32 v244, 16, v111
    v_and_b32 v245, 0xffff0000, v111
    v_mul_f32 v246, v191, v244
    v_mul_f32 v247, v223, v244
    v_fma_f32 v246, -v223, v245, v246
    v_fma_f32 v223, v191, v245, v247
    v_mov_b32 v191, v246
    v_lshlrev_b32 v240, 16, v112
    v_and_b32 v241, 0xffff0000, v112
    v_mul_f32 v242, v192, v240
    v_mul_f32 v243, v224, v240
    v_fma_f32 v242, -v224, v241, v242
    v_fma_f32 v224, v192, v241, v243
    v_mov_b32 v192, v242
    v_lshlrev_b32 v244, 16, v113
    v_and_b32 v245, 0xffff0000, v113
    v_mul_f32 v246, v193, v244
    v_mul_f32 v247, v225, v244
    v_fma_f32 v246, -v225, v245, v246
    v_fma_f32 v225, v193, v245, v247
    v_mov_b32 v193, v246
    v_lshlrev_b32 v240, 16, v114
    v_and_b32 v241, 0xffff0000, v114
    v_mul_f32 v242, v194, v240
    v_mul_f32 v243, v226, v240
    v_fma_f32 v242, -v226, v241, v242
    v_fma_f32 v226, v194, v241, v243
    v_mov_b32 v194, v242
    v_lshlrev_b32 v244, 16, v115
    v_and_b32 v245, 0xffff0000, v115
    v_mul_f32 v246, v195, v244
    v_mul_f32 v247, v227, v244
    v_fma_f32 v246, -v227, v245, v246
    v_fma_f32 v227, v195, v245, v247
    v_mov_b32 v195, v246
    v_lshlrev_b32 v240, 16, v116
    v_and_b32 v241, 0xffff0000, v116
    v_mul_f32 v242, v196, v240
    v_mul_f32 v243, v228, v240
    v_fma_f32 v242, -v228, v241, v242
    v_fma_f32 v228, v196, v241, v243
    v_mov_b32 v196, v242
    v_lshlrev_b32 v244, 16, v117
    v_and_b32 v245, 0xffff0000, v117
    v_mul_f32 v246, v197, v244
    v_mul_f32 v247, v229, v244
    v_fma_f32 v246, -v229, v245, v246
    v_fma_f32 v229, v197, v245, v247
    v_mov_b32 v197, v246
    v_lshlrev_b32 v240, 16, v118
    v_and_b32 v241, 0xffff0000, v118
    v_mul_f32 v242, v198, v240
    v_mul_f32 v243, v230, v240
    v_fma_f32 v242, -v230, v241, v242
    v_fma_f32 v230, v198, v241, v243
    v_mov_b32 v198, v242
    v_lshlrev_b32 v244, 16, v119
    v_and_b32 v245, 0xffff0000, v119
    v_mul_f32 v246, v199, v244
    v_mul_f32 v247, v231, v244
    v_fma_f32 v246, -v231, v245, v246
    v_fma_f32 v231, v199, v245, v247
    v_mov_b32 v199, v246
    v_cvt_pk_bf16_f32 v120, v168, v169
    v_cvt_pk_bf16_f32 v136, v200, v201
    v_xor_b32 v152, 0x80008000, v136
    v_cvt_pk_bf16_f32 v121, v170, v171
    v_cvt_pk_bf16_f32 v137, v202, v203
    v_xor_b32 v153, 0x80008000, v137
    v_cvt_pk_bf16_f32 v122, v172, v173
    v_cvt_pk_bf16_f32 v138, v204, v205
    v_xor_b32 v154, 0x80008000, v138
    v_cvt_pk_bf16_f32 v123, v174, v175
    v_cvt_pk_bf16_f32 v139, v206, v207
    v_xor_b32 v155, 0x80008000, v139
    v_cvt_pk_bf16_f32 v124, v176, v177
    v_cvt_pk_bf16_f32 v140, v208, v209
    v_xor_b32 v156, 0x80008000, v140
    v_cvt_pk_bf16_f32 v125, v178, v179
    v_cvt_pk_bf16_f32 v141, v210, v211
    v_xor_b32 v157, 0x80008000, v141
    v_cvt_pk_bf16_f32 v126, v180, v181
    v_cvt_pk_bf16_f32 v142, v212, v213
    v_xor_b32 v158, 0x80008000, v142
    v_cvt_pk_bf16_f32 v127, v182, v183
    v_cvt_pk_bf16_f32 v143, v214, v215
    v_xor_b32 v159, 0x80008000, v143
    v_cvt_pk_bf16_f32 v128, v184, v185
    v_cvt_pk_bf16_f32 v144, v216, v217
    v_xor_b32 v160, 0x80008000, v144
    v_cvt_pk_bf16_f32 v129, v186, v187
    v_cvt_pk_bf16_f32 v145, v218, v219
    v_xor_b32 v161, 0x80008000, v145
    v_cvt_pk_bf16_f32 v130, v188, v189
    v_cvt_pk_bf16_f32 v146, v220, v221
    v_xor_b32 v162, 0x80008000, v146
    v_cvt_pk_bf16_f32 v131, v190, v191
    v_cvt_pk_bf16_f32 v147, v222, v223
    v_xor_b32 v163, 0x80008000, v147
    v_cvt_pk_bf16_f32 v132, v192, v193
    v_cvt_pk_bf16_f32 v148, v224, v225
    v_xor_b32 v164, 0x80008000, v148
    v_cvt_pk_bf16_f32 v133, v194, v195
    v_cvt_pk_bf16_f32 v149, v226, v227
    v_xor_b32 v165, 0x80008000, v149
    v_cvt_pk_bf16_f32 v134, v196, v197
    v_cvt_pk_bf16_f32 v150, v228, v229
    v_xor_b32 v166, 0x80008000, v150
    v_cvt_pk_bf16_f32 v135, v198, v199
    v_cvt_pk_bf16_f32 v151, v230, v231
    v_xor_b32 v167, 0x80008000, v151
    v_mfma_f32_32x32x16_bf16 v[168:183], v[120:123], v[24:27], 0
    v_mfma_f32_32x32x16_bf16 v[200:215], v[136:139], v[24:27], 0
    v_mfma_f32_32x32x16_bf16 v[168:183], v[124:127], v[28:31], v[168:183]
    v_mfma_f32_32x32x16_bf16 v[200:215], v[140:143], v[28:31], v[200:215]
    v_mfma_f32_32x32x16_bf16 v[168:183], v[128:131], v[32:35], v[168:183]
    v_mfma_f32_32x32x16_bf16 v[200:215], v[144:147], v[32:35], v[200:215]
    v_mfma_f32_32x32x16_bf16 v[168:183], v[132:135], v[36:39], v[168:183]
    v_mfma_f32_32x32x16_bf16 v[200:215], v[148:151], v[36:39], v[200:215]
    v_mfma_f32_32x32x16_bf16 v[168:183], v[152:155], v[56:59], v[168:183]
    v_mfma_f32_32x32x16_bf16 v[200:215], v[120:123], v[56:59], v[200:215]
    v_mfma_f32_32x32x16_bf16 v[168:183], v[156:159], v[60:63], v[168:183]
    v_mfma_f32_32x32x16_bf16 v[200:215], v[124:127], v[60:63], v[200:215]
    v_mfma_f32_32x32x16_bf16 v[168:183], v[160:163], v[64:67], v[168:183]
    v_mfma_f32_32x32x16_bf16 v[200:215], v[128:131], v[64:67], v[200:215]
    v_mfma_f32_32x32x16_bf16 v[168:183], v[164:167], v[68:71], v[168:183]
    v_mfma_f32_32x32x16_bf16 v[200:215], v[132:135], v[68:71], v[200:215]
    v_mfma_f32_32x32x16_bf16 v[184:199], v[120:123], v[40:43], 0
    v_mfma_f32_32x32x16_bf16 v[216:231], v[136:139], v[40:43], 0
    v_mfma_f32_32x32x16_bf16 v[184:199], v[124:127], v[44:47], v[184:199]
    v_mfma_f32_32x32x16_bf16 v[216:231], v[140:143], v[44:47], v[216:231]
    v_mfma_f32_32x32x16_bf16 v[184:199], v[128:131], v[48:51], v[184:199]
    v_mfma_f32_32x32x16_bf16 v[216:231], v[144:147], v[48:51], v[216:231]
    v_mfma_f32_32x32x16_bf16 v[184:199], v[132:135], v[52:55], v[184:199]
    v_mfma_f32_32x32x16_bf16 v[216:231], v[148:151], v[52:55], v[216:231]
    v_mfma_f32_32x32x16_bf16 v[184:199], v[152:155], v[72:75], v[184:199]
    v_mfma_f32_32x32x16_bf16 v[216:231], v[120:123], v[72:75], v[216:231]
    v_mfma_f32_32x32x16_bf16 v[184:199], v[156:159], v[76:79], v[184:199]
    v_mfma_f32_32x32x16_bf16 v[216:231], v[124:127], v[76:79], v[216:231]
    v_mfma_f32_32x32x16_bf16 v[184:199], v[160:163], v[80:83], v[184:199]
    v_mfma_f32_32x32x16_bf16 v[216:231], v[128:131], v[80:83], v[216:231]
    v_mfma_f32_32x32x16_bf16 v[184:199], v[164:167], v[84:87], v[184:199]
    v_mfma_f32_32x32x16_bf16 v[216:231], v[132:135], v[84:87], v[216:231]
    ds_read_b64 v[88:89], v239 offset:16384
    ds_read_b64 v[90:91], v239 offset:16896
    ds_read_b64 v[92:93], v239 offset:17408
    ds_read_b64 v[94:95], v239 offset:17920
    ds_read_b64 v[96:97], v239 offset:18432
    ds_read_b64 v[98:99], v239 offset:18944
    ds_read_b64 v[100:101], v239 offset:19456
    ds_read_b64 v[102:103], v239 offset:19968
    ds_read_b64 v[104:105], v239 offset:20480
    ds_read_b64 v[106:107], v239 offset:20992
    ds_read_b64 v[108:109], v239 offset:21504
    ds_read_b64 v[110:111], v239 offset:22016
    ds_read_b64 v[112:113], v239 offset:22528
    ds_read_b64 v[114:115], v239 offset:23040
    ds_read_b64 v[116:117], v239 offset:23552
    ds_read_b64 v[118:119], v239 offset:24064
    ds_read_b64 v[120:121], v239 offset:24576
    ds_read_b64 v[122:123], v239 offset:25088
    ds_read_b64 v[124:125], v239 offset:25600
    ds_read_b64 v[126:127], v239 offset:26112
    ds_read_b64 v[128:129], v239 offset:26624
    ds_read_b64 v[130:131], v239 offset:27136
    ds_read_b64 v[132:133], v239 offset:27648
    ds_read_b64 v[134:135], v239 offset:28160
    ds_read_b64 v[136:137], v239 offset:28672
    ds_read_b64 v[138:139], v239 offset:29184
    ds_read_b64 v[140:141], v239 offset:29696
    ds_read_b64 v[142:143], v239 offset:30208
    ds_read_b64 v[144:145], v239 offset:30720
    ds_read_b64 v[146:147], v239 offset:31232
    ds_read_b64 v[148:149], v239 offset:31744
    ds_read_b64 v[150:151], v239 offset:32256
    s_waitcnt lgkmcnt(0)
    v_mul_f32 v240, v168, v88
    v_mul_f32 v241, v200, v88
    v_fma_f32 v240, -v200, v89, v240
    v_fma_f32 v200, v168, v89, v241
    v_mov_b32 v168, v240
    v_mul_f32 v242, v169, v90
    v_mul_f32 v243, v201, v90
    v_fma_f32 v242, -v201, v91, v242
    v_fma_f32 v201, v169, v91, v243
    v_mov_b32 v169, v242
    v_mul_f32 v240, v170, v92
    v_mul_f32 v241, v202, v92
    v_fma_f32 v240, -v202, v93, v240
    v_fma_f32 v202, v170, v93, v241
    v_mov_b32 v170, v240
    v_mul_f32 v242, v171, v94
    v_mul_f32 v243, v203, v94
    v_fma_f32 v242, -v203, v95, v242
    v_fma_f32 v203, v171, v95, v243
    v_mov_b32 v171, v242
    v_mul_f32 v240, v172, v96
    v_mul_f32 v241, v204, v96
    v_fma_f32 v240, -v204, v97, v240
    v_fma_f32 v204, v172, v97, v241
    v_mov_b32 v172, v240
    v_mul_f32 v242, v173, v98
    v_mul_f32 v243, v205, v98
    v_fma_f32 v242, -v205, v99, v242
    v_fma_f32 v205, v173, v99, v243
    v_mov_b32 v173, v242
    v_mul_f32 v240, v174, v100
    v_mul_f32 v241, v206, v100
    v_fma_f32 v240, -v206, v101, v240
    v_fma_f32 v206, v174, v101, v241
    v_mov_b32 v174, v240
    v_mul_f32 v242, v175, v102
    v_mul_f32 v243, v207, v102
    v_fma_f32 v242, -v207, v103, v242
    v_fma_f32 v207, v175, v103, v243
    v_mov_b32 v175, v242
    v_mul_f32 v240, v176, v104
    v_mul_f32 v241, v208, v104
    v_fma_f32 v240, -v208, v105, v240
    v_fma_f32 v208, v176, v105, v241
    v_mov_b32 v176, v240
    v_mul_f32 v242, v177, v106
    v_mul_f32 v243, v209, v106
    v_fma_f32 v242, -v209, v107, v242
    v_fma_f32 v209, v177, v107, v243
    v_mov_b32 v177, v242
    v_mul_f32 v240, v178, v108
    v_mul_f32 v241, v210, v108
    v_fma_f32 v240, -v210, v109, v240
    v_fma_f32 v210, v178, v109, v241
    v_mov_b32 v178, v240
    v_mul_f32 v242, v179, v110
    v_mul_f32 v243, v211, v110
    v_fma_f32 v242, -v211, v111, v242
    v_fma_f32 v211, v179, v111, v243
    v_mov_b32 v179, v242
    v_mul_f32 v240, v180, v112
    v_mul_f32 v241, v212, v112
    v_fma_f32 v240, -v212, v113, v240
    v_fma_f32 v212, v180, v113, v241
    v_mov_b32 v180, v240
    v_mul_f32 v242, v181, v114
    v_mul_f32 v243, v213, v114
    v_fma_f32 v242, -v213, v115, v242
    v_fma_f32 v213, v181, v115, v243
    v_mov_b32 v181, v242
    v_mul_f32 v240, v182, v116
    v_mul_f32 v241, v214, v116
    v_fma_f32 v240, -v214, v117, v240
    v_fma_f32 v214, v182, v117, v241
    v_mov_b32 v182, v240
    v_mul_f32 v242, v183, v118
    v_mul_f32 v243, v215, v118
    v_fma_f32 v242, -v215, v119, v242
    v_fma_f32 v215, v183, v119, v243
    v_mov_b32 v183, v242
    v_mul_f32 v240, v184, v120
    v_mul_f32 v241, v216, v120
    v_fma_f32 v240, -v216, v121, v240
    v_fma_f32 v216, v184, v121, v241
    v_mov_b32 v184, v240
    v_mul_f32 v242, v185, v122
    v_mul_f32 v243, v217, v122
    v_fma_f32 v242, -v217, v123, v242
    v_fma_f32 v217, v185, v123, v243
    v_mov_b32 v185, v242
    v_mul_f32 v240, v186, v124
    v_mul_f32 v241, v218, v124
    v_fma_f32 v240, -v218, v125, v240
    v_fma_f32 v218, v186, v125, v241
    v_mov_b32 v186, v240
    v_mul_f32 v242, v187, v126
    v_mul_f32 v243, v219, v126
    v_fma_f32 v242, -v219, v127, v242
    v_fma_f32 v219, v187, v127, v243
    v_mov_b32 v187, v242
    v_mul_f32 v240, v188, v128
    v_mul_f32 v241, v220, v128
    v_fma_f32 v240, -v220, v129, v240
    v_fma_f32 v220, v188, v129, v241
    v_mov_b32 v188, v240
    v_mul_f32 v242, v189, v130
    v_mul_f32 v243, v221, v130
    v_fma_f32 v242, -v221, v131, v242
    v_fma_f32 v221, v189, v131, v243
    v_mov_b32 v189, v242
    v_mul_f32 v240, v190, v132
    v_mul_f32 v241, v222, v132
    v_fma_f32 v240, -v222, v133, v240
    v_fma_f32 v222, v190, v133, v241
    v_mov_b32 v190, v240
    v_mul_f32 v242, v191, v134
    v_mul_f32 v243, v223, v134
    v_fma_f32 v242, -v223, v135, v242
    v_fma_f32 v223, v191, v135, v243
    v_mov_b32 v191, v242
    v_mul_f32 v240, v192, v136
    v_mul_f32 v241, v224, v136
    v_fma_f32 v240, -v224, v137, v240
    v_fma_f32 v224, v192, v137, v241
    v_mov_b32 v192, v240
    v_mul_f32 v242, v193, v138
    v_mul_f32 v243, v225, v138
    v_fma_f32 v242, -v225, v139, v242
    v_fma_f32 v225, v193, v139, v243
    v_mov_b32 v193, v242
    v_mul_f32 v240, v194, v140
    v_mul_f32 v241, v226, v140
    v_fma_f32 v240, -v226, v141, v240
    v_fma_f32 v226, v194, v141, v241
    v_mov_b32 v194, v240
    v_mul_f32 v242, v195, v142
    v_mul_f32 v243, v227, v142
    v_fma_f32 v242, -v227, v143, v242
    v_fma_f32 v227, v195, v143, v243
    v_mov_b32 v195, v242
    v_mul_f32 v240, v196, v144
    v_mul_f32 v241, v228, v144
    v_fma_f32 v240, -v228, v145, v240
    v_fma_f32 v228, v196, v145, v241
    v_mov_b32 v196, v240
    v_mul_f32 v242, v197, v146
    v_mul_f32 v243, v229, v146
    v_fma_f32 v242, -v229, v147, v242
    v_fma_f32 v229, v197, v147, v243
    v_mov_b32 v197, v242
    v_mul_f32 v240, v198, v148
    v_mul_f32 v241, v230, v148
    v_fma_f32 v240, -v230, v149, v240
    v_fma_f32 v230, v198, v149, v241
    v_mov_b32 v198, v240
    v_mul_f32 v242, v199, v150
    v_mul_f32 v243, v231, v150
    v_fma_f32 v242, -v231, v151, v242
    v_fma_f32 v231, v199, v151, v243
    v_mov_b32 v199, v242
    v_cvt_pk_bf16_f32 v120, v168, v169
    v_cvt_pk_bf16_f32 v136, v200, v201
    v_xor_b32 v152, 0x80008000, v136
    v_cvt_pk_bf16_f32 v121, v170, v171
    v_cvt_pk_bf16_f32 v137, v202, v203
    v_xor_b32 v153, 0x80008000, v137
    v_cvt_pk_bf16_f32 v122, v172, v173
    v_cvt_pk_bf16_f32 v138, v204, v205
    v_xor_b32 v154, 0x80008000, v138
    v_cvt_pk_bf16_f32 v123, v174, v175
    v_cvt_pk_bf16_f32 v139, v206, v207
    v_xor_b32 v155, 0x80008000, v139
    v_cvt_pk_bf16_f32 v124, v176, v177
    v_cvt_pk_bf16_f32 v140, v208, v209
    v_xor_b32 v156, 0x80008000, v140
    v_cvt_pk_bf16_f32 v125, v178, v179
    v_cvt_pk_bf16_f32 v141, v210, v211
    v_xor_b32 v157, 0x80008000, v141
    v_cvt_pk_bf16_f32 v126, v180, v181
    v_cvt_pk_bf16_f32 v142, v212, v213
    v_xor_b32 v158, 0x80008000, v142
    v_cvt_pk_bf16_f32 v127, v182, v183
    v_cvt_pk_bf16_f32 v143, v214, v215
    v_xor_b32 v159, 0x80008000, v143
    v_cvt_pk_bf16_f32 v128, v184, v185
    v_cvt_pk_bf16_f32 v144, v216, v217
    v_xor_b32 v160, 0x80008000, v144
    v_cvt_pk_bf16_f32 v129, v186, v187
    v_cvt_pk_bf16_f32 v145, v218, v219
    v_xor_b32 v161, 0x80008000, v145
    v_cvt_pk_bf16_f32 v130, v188, v189
    v_cvt_pk_bf16_f32 v146, v220, v221
    v_xor_b32 v162, 0x80008000, v146
    v_cvt_pk_bf16_f32 v131, v190, v191
    v_cvt_pk_bf16_f32 v147, v222, v223
    v_xor_b32 v163, 0x80008000, v147
    v_cvt_pk_bf16_f32 v132, v192, v193
    v_cvt_pk_bf16_f32 v148, v224, v225
    v_xor_b32 v164, 0x80008000, v148
    v_cvt_pk_bf16_f32 v133, v194, v195
    v_cvt_pk_bf16_f32 v149, v226, v227
    v_xor_b32 v165, 0x80008000, v149
    v_cvt_pk_bf16_f32 v134, v196, v197
    v_cvt_pk_bf16_f32 v150, v228, v229
    v_xor_b32 v166, 0x80008000, v150
    v_cvt_pk_bf16_f32 v135, v198, v199
    v_cvt_pk_bf16_f32 v151, v230, v231
    v_xor_b32 v167, 0x80008000, v151
    v_mfma_f32_32x32x16_bf16 v[168:183], v[0:3], v[120:123], 0
    v_mfma_f32_32x32x16_bf16 v[200:215], v[0:3], v[136:139], 0
    v_mfma_f32_32x32x16_bf16 v[168:183], v[4:7], v[124:127], v[168:183]
    v_mfma_f32_32x32x16_bf16 v[200:215], v[4:7], v[140:143], v[200:215]
    v_mfma_f32_32x32x16_bf16 v[168:183], v[16:19], v[136:139], v[168:183]
    v_mfma_f32_32x32x16_bf16 v[200:215], v[8:11], v[120:123], v[200:215]
    v_mfma_f32_32x32x16_bf16 v[168:183], v[20:23], v[140:143], v[168:183]
    v_mfma_f32_32x32x16_bf16 v[200:215], v[12:15], v[124:127], v[200:215]
    v_mfma_f32_32x32x16_bf16 v[184:199], v[0:3], v[128:131], 0
    v_mfma_f32_32x32x16_bf16 v[216:231], v[0:3], v[144:147], 0
    v_mfma_f32_32x32x16_bf16 v[184:199], v[4:7], v[132:135], v[184:199]
    v_mfma_f32_32x32x16_bf16 v[216:231], v[4:7], v[148:151], v[216:231]
    v_mfma_f32_32x32x16_bf16 v[184:199], v[16:19], v[144:147], v[184:199]
    v_mfma_f32_32x32x16_bf16 v[216:231], v[8:11], v[128:131], v[216:231]
    v_mfma_f32_32x32x16_bf16 v[184:199], v[20:23], v[148:151], v[184:199]
    v_mfma_f32_32x32x16_bf16 v[216:231], v[12:15], v[132:135], v[216:231]
    s_nop 3
    v_cvt_pk_bf16_f32 v88, v168, v200
    v_cvt_pk_bf16_f32 v89, v169, v201
    v_cvt_pk_bf16_f32 v90, v170, v202
    v_cvt_pk_bf16_f32 v91, v171, v203
    v_cvt_pk_bf16_f32 v92, v172, v204
    v_cvt_pk_bf16_f32 v93, v173, v205
    v_cvt_pk_bf16_f32 v94, v174, v206
    v_cvt_pk_bf16_f32 v95, v175, v207
    v_cvt_pk_bf16_f32 v96, v176, v208
    v_cvt_pk_bf16_f32 v97, v177, v209
    v_cvt_pk_bf16_f32 v98, v178, v210
    v_cvt_pk_bf16_f32 v99, v179, v211
    v_cvt_pk_bf16_f32 v100, v180, v212
    v_cvt_pk_bf16_f32 v101, v181, v213
    v_cvt_pk_bf16_f32 v102, v182, v214
    v_cvt_pk_bf16_f32 v103, v183, v215
    v_cvt_pk_bf16_f32 v104, v184, v216
    v_cvt_pk_bf16_f32 v105, v185, v217
    v_cvt_pk_bf16_f32 v106, v186, v218
    v_cvt_pk_bf16_f32 v107, v187, v219
    v_cvt_pk_bf16_f32 v108, v188, v220
    v_cvt_pk_bf16_f32 v109, v189, v221
    v_cvt_pk_bf16_f32 v110, v190, v222
    v_cvt_pk_bf16_f32 v111, v191, v223
    v_cvt_pk_bf16_f32 v112, v192, v224
    v_cvt_pk_bf16_f32 v113, v193, v225
    v_cvt_pk_bf16_f32 v114, v194, v226
    v_cvt_pk_bf16_f32 v115, v195, v227
    v_cvt_pk_bf16_f32 v116, v196, v228
    v_cvt_pk_bf16_f32 v117, v197, v229
    v_cvt_pk_bf16_f32 v118, v198, v230
    v_cvt_pk_bf16_f32 v119, v199, v231
Ls2_fin:
    s_barrier
    ds_write_b32 v235, v88 offset:0
    ds_write_b32 v235, v89 offset:2048
    ds_write_b32 v235, v90 offset:4096
    ds_write_b32 v235, v91 offset:6144
    ds_write_b32 v235, v92 offset:16384
    ds_write_b32 v235, v93 offset:18432
    ds_write_b32 v235, v94 offset:20480
    ds_write_b32 v235, v95 offset:22528
    ds_write_b32 v235, v96 offset:32768
    ds_write_b32 v235, v97 offset:34816
    ds_write_b32 v235, v98 offset:36864
    ds_write_b32 v235, v99 offset:38912
    ds_write_b32 v235, v100 offset:49152
    ds_write_b32 v235, v101 offset:51200
    ds_write_b32 v235, v102 offset:53248
    ds_write_b32 v235, v103 offset:55296
    ds_write_b32 v235, v104 offset:1024
    ds_write_b32 v235, v105 offset:3072
    ds_write_b32 v235, v106 offset:5120
    ds_write_b32 v235, v107 offset:7168
    ds_write_b32 v235, v108 offset:17408
    ds_write_b32 v235, v109 offset:19456
    ds_write_b32 v235, v110 offset:21504
    ds_write_b32 v235, v111 offset:23552
    ds_write_b32 v235, v112 offset:33792
    ds_write_b32 v235, v113 offset:35840
    ds_write_b32 v235, v114 offset:37888
    ds_write_b32 v235, v115 offset:39936
    ds_write_b32 v235, v116 offset:50176
    ds_write_b32 v235, v117 offset:52224
    ds_write_b32 v235, v118 offset:54272
    ds_write_b32 v235, v119 offset:56320
    s_waitcnt lgkmcnt(0)
    s_barrier
    s_lshl_b32 s3, s24, 13
    v_add_u32 v237, s3, v236
    ds_read_b128 v[120:123], v237 offset:0
    ds_read_b128 v[124:127], v237 offset:1024
    ds_read_b128 v[128:131], v237 offset:2048
    ds_read_b128 v[132:135], v237 offset:3072
    ds_read_b128 v[136:139], v237 offset:4096
    ds_read_b128 v[140:143], v237 offset:5120
    ds_read_b128 v[144:147], v237 offset:6144
    ds_read_b128 v[148:151], v237 offset:7168
    s_waitcnt lgkmcnt(0)
    s_lshl_b32 s3, s24, 3
    s_add_u32 s3, s3, 0
    s_mul_i32 s3, s3, 37
    s_add_u32 s3, s3, s2
    s_lshl_b32 s3, s3, 10
    buffer_store_dwordx4 v[120:123], v236, s[12:15], s3 offen sc0 sc1
    s_lshl_b32 s3, s24, 3
    s_add_u32 s3, s3, 1
    s_mul_i32 s3, s3, 37
    s_add_u32 s3, s3, s2
    s_lshl_b32 s3, s3, 10
    buffer_store_dwordx4 v[124:127], v236, s[12:15], s3 offen sc0 sc1
    s_lshl_b32 s3, s24, 3
    s_add_u32 s3, s3, 2
    s_mul_i32 s3, s3, 37
    s_add_u32 s3, s3, s2
    s_lshl_b32 s3, s3, 10
    buffer_store_dwordx4 v[128:131], v236, s[12:15], s3 offen sc0 sc1
    s_lshl_b32 s3, s24, 3
    s_add_u32 s3, s3, 3
    s_mul_i32 s3, s3, 37
    s_add_u32 s3, s3, s2
    s_lshl_b32 s3, s3, 10
    buffer_store_dwordx4 v[132:135], v236, s[12:15], s3 offen sc0 sc1
    s_lshl_b32 s3, s24, 3
    s_add_u32 s3, s3, 4
    s_mul_i32 s3, s3, 37
    s_add_u32 s3, s3, s2
    s_lshl_b32 s3, s3, 10
    buffer_store_dwordx4 v[136:139], v236, s[12:15], s3 offen sc0 sc1
    s_lshl_b32 s3, s24, 3
    s_add_u32 s3, s3, 5
    s_mul_i32 s3, s3, 37
    s_add_u32 s3, s3, s2
    s_lshl_b32 s3, s3, 10
    buffer_store_dwordx4 v[140:143], v236, s[12:15], s3 offen sc0 sc1
    s_lshl_b32 s3, s24, 3
    s_add_u32 s3, s3, 6
    s_mul_i32 s3, s3, 37
    s_add_u32 s3, s3, s2
    s_lshl_b32 s3, s3, 10
    buffer_store_dwordx4 v[144:147], v236, s[12:15], s3 offen sc0 sc1
    s_lshl_b32 s3, s24, 3
    s_add_u32 s3, s3, 7
    s_mul_i32 s3, s3, 37
    s_add_u32 s3, s3, s2
    s_lshl_b32 s3, s3, 10
    buffer_store_dwordx4 v[148:151], v236, s[12:15], s3 offen sc0 sc1
    s_branch Lc23_sig
Lc23_sig:
    s_waitcnt vmcnt(0)
    s_barrier
    s_cmp_lg_u32 s24, 0
    s_cbranch_scc1 Lc23_s3
    v_mov_b32 v250, 1
    v_mov_b32 v251, 0
    s_mov_b64 exec, 1
    buffer_atomic_add v250, v251, s[60:63], 0 offen sc1
    s_mov_b64 exec, -1
Lc23_s3:
    s_mov_b32 s42, s58
    s_mov_b32 s43, s59
    s_and_b32 s25, s2, 7
    s_lshr_b32 s26, s2, 3
    s_add_u32 s8, s46, 71303168
    s_addc_u32 s9, s47, 0
    s_mov_b32 s10, 2424832
    s_mov_b32 s11, 0x00020000
    s_mov_b32 s12, s42
    s_mov_b32 s13, s43
    s_mov_b32 s14, 4718592
    s_mov_b32 s15, 0x00020000
    v_mbcnt_lo_u32_b32 v220, -1, 0
    v_mbcnt_hi_u32_b32 v220, -1, v220
    v_and_b32 v221, 31, v220
    v_bfe_u32 v222, v220, 5, 1
    v_lshlrev_b32 v240, 4, v220
    s_mov_b32 s36, 987991609
    s_movk_i32 s37, 576
    s_mov_b32 s38, 7456541
    s_mov_b32 s39, 904105529
    s_mov_b32 s40, 3051589177
    s_barrier
    s_mul_i32 s6, s26, 96
    s_add_u32 s6, s6, 0
    v_add_u32 v223, s6, v221
    s_lshl_b32 s6, s24, 3
    v_lshl_add_u32 v232, v222, 2, 0
    v_add_u32 v232, s6, v232
    v_mul_u32_u24 v232, v232, v223
    v_mul_hi_u32 v233, v232, s38
    v_mul_lo_u32 v233, v233, s37
    v_sub_u32 v232, v232, v233
    v_cvt_f32_u32 v232, v232
    v_mul_f32 v232, s36, v232
    v_cos_f32 v224, v232
    v_sin_f32 v228, v232
    v_lshl_add_u32 v232, v222, 2, 1
    v_add_u32 v232, s6, v232
    v_mul_u32_u24 v232, v232, v223
    v_mul_hi_u32 v233, v232, s38
    v_mul_lo_u32 v233, v233, s37
    v_sub_u32 v232, v232, v233
    v_cvt_f32_u32 v232, v232
    v_mul_f32 v232, s36, v232
    v_cos_f32 v225, v232
    v_sin_f32 v229, v232
    v_lshl_add_u32 v232, v222, 2, 2
    v_add_u32 v232, s6, v232
    v_mul_u32_u24 v232, v232, v223
    v_mul_hi_u32 v233, v232, s38
    v_mul_lo_u32 v233, v233, s37
    v_sub_u32 v232, v232, v233
    v_cvt_f32_u32 v232, v232
    v_mul_f32 v232, s36, v232
    v_cos_f32 v226, v232
    v_sin_f32 v230, v232
    v_lshl_add_u32 v232, v222, 2, 3
    v_add_u32 v232, s6, v232
    v_mul_u32_u24 v232, v232, v223
    v_mul_hi_u32 v233, v232, s38
    v_mul_lo_u32 v233, v233, s37
    v_sub_u32 v232, v232, v233
    v_cvt_f32_u32 v232, v232
    v_mul_f32 v232, s36, v232
    v_cos_f32 v227, v232
    v_sin_f32 v231, v232
    v_lshlrev_b32 v232, 6, v223
    v_mul_hi_u32 v233, v232, s38
    v_mul_lo_u32 v233, v233, s37
    v_sub_u32 v232, v232, v233
    v_cvt_f32_u32 v232, v232
    v_mul_f32 v232, s36, v232
    v_cos_f32 v241, v232
    v_sin_f32 v242, v232
    v_mul_f32 v232, s39, v224
    v_mul_f32 v233, s40, v228
    v_mul_f32 v234, s39, v225
    v_mul_f32 v235, s40, v229
    v_mul_f32 v236, s39, v226
    v_mul_f32 v237, s40, v230
    v_mul_f32 v238, s39, v227
    v_mul_f32 v239, s40, v231
    s_cmp_lg_u32 s24, 0
    s_cbranch_scc1 Ls3_g00
    v_cmp_eq_u32 vcc, 0, v222
    v_mul_f32 v243, 0.5, v232
    s_nop 0
    v_cndmask_b32 v232, v232, v243, vcc
    v_mov_b32 v243, 0
    v_cndmask_b32 v233, v233, v243, vcc
Ls3_g00:
    v_cvt_pk_bf16_f32 v248, v232, v233
    v_cvt_pk_bf16_f32 v249, v234, v235
    v_cvt_pk_bf16_f32 v250, v236, v237
    v_cvt_pk_bf16_f32 v251, v238, v239
    s_lshl_b32 s3, s24, 10
    s_add_u32 s3, s3, 0
    v_add_u32 v243, s3, v240
    ds_write_b128 v243, v[248:251]
    v_mul_f32 v232, v224, v241
    v_mul_f32 v233, v228, v241
    v_mul_f32 v234, v225, v241
    v_mul_f32 v235, v229, v241
    v_mul_f32 v236, v226, v241
    v_mul_f32 v237, v230, v241
    v_mul_f32 v238, v227, v241
    v_mul_f32 v239, v231, v241
    v_fma_f32 v232, -v228, v242, v232
    v_fma_f32 v233, v224, v242, v233
    v_fma_f32 v234, -v229, v242, v234
    v_fma_f32 v235, v225, v242, v235
    v_fma_f32 v236, -v230, v242, v236
    v_fma_f32 v237, v226, v242, v237
    v_fma_f32 v238, -v231, v242, v238
    v_fma_f32 v239, v227, v242, v239
    v_mov_b32 v224, v232
    v_mov_b32 v228, v233
    v_mov_b32 v225, v234
    v_mov_b32 v229, v235
    v_mov_b32 v226, v236
    v_mov_b32 v230, v237
    v_mov_b32 v227, v238
    v_mov_b32 v231, v239
    v_mul_f32 v232, s39, v224
    v_mul_f32 v233, s40, v228
    v_mul_f32 v234, s39, v225
    v_mul_f32 v235, s40, v229
    v_mul_f32 v236, s39, v226
    v_mul_f32 v237, s40, v230
    v_mul_f32 v238, s39, v227
    v_mul_f32 v239, s40, v231
    v_cvt_pk_bf16_f32 v248, v232, v233
    v_cvt_pk_bf16_f32 v249, v234, v235
    v_cvt_pk_bf16_f32 v250, v236, v237
    v_cvt_pk_bf16_f32 v251, v238, v239
    s_lshl_b32 s3, s24, 10
    s_add_u32 s3, s3, 8192
    v_add_u32 v243, s3, v240
    ds_write_b128 v243, v[248:251]
    v_mul_f32 v232, v224, v241
    v_mul_f32 v233, v228, v241
    v_mul_f32 v234, v225, v241
    v_mul_f32 v235, v229, v241
    v_mul_f32 v236, v226, v241
    v_mul_f32 v237, v230, v241
    v_mul_f32 v238, v227, v241
    v_mul_f32 v239, v231, v241
    v_fma_f32 v232, -v228, v242, v232
    v_fma_f32 v233, v224, v242, v233
    v_fma_f32 v234, -v229, v242, v234
    v_fma_f32 v235, v225, v242, v235
    v_fma_f32 v236, -v230, v242, v236
    v_fma_f32 v237, v226, v242, v237
    v_fma_f32 v238, -v231, v242, v238
    v_fma_f32 v239, v227, v242, v239
    v_mov_b32 v224, v232
    v_mov_b32 v228, v233
    v_mov_b32 v225, v234
    v_mov_b32 v229, v235
    v_mov_b32 v226, v236
    v_mov_b32 v230, v237
    v_mov_b32 v227, v238
    v_mov_b32 v231, v239
    v_mul_f32 v232, s39, v224
    v_mul_f32 v233, s40, v228
    v_mul_f32 v234, s39, v225
    v_mul_f32 v235, s40, v229
    v_mul_f32 v236, s39, v226
    v_mul_f32 v237, s40, v230
    v_mul_f32 v238, s39, v227
    v_mul_f32 v239, s40, v231
    v_cvt_pk_bf16_f32 v248, v232, v233
    v_cvt_pk_bf16_f32 v249, v234, v235
    v_cvt_pk_bf16_f32 v250, v236, v237
    v_cvt_pk_bf16_f32 v251, v238, v239
    s_lshl_b32 s3, s24, 10
    s_add_u32 s3, s3, 16384
    v_add_u32 v243, s3, v240
    ds_write_b128 v243, v[248:251]
    v_mul_f32 v232, v224, v241
    v_mul_f32 v233, v228, v241
    v_mul_f32 v234, v225, v241
    v_mul_f32 v235, v229, v241
    v_mul_f32 v236, v226, v241
    v_mul_f32 v237, v230, v241
    v_mul_f32 v238, v227, v241
    v_mul_f32 v239, v231, v241
    v_fma_f32 v232, -v228, v242, v232
    v_fma_f32 v233, v224, v242, v233
    v_fma_f32 v234, -v229, v242, v234
    v_fma_f32 v235, v225, v242, v235
    v_fma_f32 v236, -v230, v242, v236
    v_fma_f32 v237, v226, v242, v237
    v_fma_f32 v238, -v231, v242, v238
    v_fma_f32 v239, v227, v242, v239
    v_mov_b32 v224, v232
    v_mov_b32 v228, v233
    v_mov_b32 v225, v234
    v_mov_b32 v229, v235
    v_mov_b32 v226, v236
    v_mov_b32 v230, v237
    v_mov_b32 v227, v238
    v_mov_b32 v231, v239
    v_mul_f32 v232, s39, v224
    v_mul_f32 v233, s40, v228
    v_mul_f32 v234, s39, v225
    v_mul_f32 v235, s40, v229
    v_mul_f32 v236, s39, v226
    v_mul_f32 v237, s40, v230
    v_mul_f32 v238, s39, v227
    v_mul_f32 v239, s40, v231
    v_cvt_pk_bf16_f32 v248, v232, v233
    v_cvt_pk_bf16_f32 v249, v234, v235
    v_cvt_pk_bf16_f32 v250, v236, v237
    v_cvt_pk_bf16_f32 v251, v238, v239
    s_lshl_b32 s3, s24, 10
    s_add_u32 s3, s3, 24576
    v_add_u32 v243, s3, v240
    ds_write_b128 v243, v[248:251]
    v_mul_f32 v232, v224, v241
    v_mul_f32 v233, v228, v241
    v_mul_f32 v234, v225, v241
    v_mul_f32 v235, v229, v241
    v_mul_f32 v236, v226, v241
    v_mul_f32 v237, v230, v241
    v_mul_f32 v238, v227, v241
    v_mul_f32 v239, v231, v241
    v_fma_f32 v232, -v228, v242, v232
    v_fma_f32 v233, v224, v242, v233
    v_fma_f32 v234, -v229, v242, v234
    v_fma_f32 v235, v225, v242, v235
    v_fma_f32 v236, -v230, v242, v236
    v_fma_f32 v237, v226, v242, v237
    v_fma_f32 v238, -v231, v242, v238
    v_fma_f32 v239, v227, v242, v239
    v_mov_b32 v224, v232
    v_mov_b32 v228, v233
    v_mov_b32 v225, v234
    v_mov_b32 v229, v235
    v_mov_b32 v226, v236
    v_mov_b32 v230, v237
    v_mov_b32 v227, v238
    v_mov_b32 v231, v239
    s_cmp_ge_u32 s24, 5
    s_cbranch_scc1 Ls3_gn0
    v_mul_f32 v232, s39, v224
    v_mul_f32 v233, s40, v228
    v_mul_f32 v234, s39, v225
    v_mul_f32 v235, s40, v229
    v_mul_f32 v236, s39, v226
    v_mul_f32 v237, s40, v230
    v_mul_f32 v238, s39, v227
    v_mul_f32 v239, s40, v231
    s_cmp_lg_u32 s24, 4
    s_cbranch_scc1 Ls3_g40
    v_cmp_eq_u32 vcc, 0, v222
    v_mul_f32 v243, 0.5, v232
    v_mov_b32 v244, 0
    v_cndmask_b32 v232, v244, v243, vcc
    v_mov_b32 v233, 0
    v_mov_b32 v234, 0
    v_mov_b32 v235, 0
    v_mov_b32 v236, 0
    v_mov_b32 v237, 0
    v_mov_b32 v238, 0
    v_mov_b32 v239, 0
Ls3_g40:
    v_cvt_pk_bf16_f32 v248, v232, v233
    v_cvt_pk_bf16_f32 v249, v234, v235
    v_cvt_pk_bf16_f32 v250, v236, v237
    v_cvt_pk_bf16_f32 v251, v238, v239
    s_lshl_b32 s3, s24, 10
    s_add_u32 s3, s3, 32768
    v_add_u32 v243, s3, v240
    ds_write_b128 v243, v[248:251]
Ls3_gn0:
    s_mul_i32 s6, s26, 96
    s_add_u32 s6, s6, 32
    v_add_u32 v223, s6, v221
    s_lshl_b32 s6, s24, 3
    v_lshl_add_u32 v232, v222, 2, 0
    v_add_u32 v232, s6, v232
    v_mul_u32_u24 v232, v232, v223
    v_mul_hi_u32 v233, v232, s38
    v_mul_lo_u32 v233, v233, s37
    v_sub_u32 v232, v232, v233
    v_cvt_f32_u32 v232, v232
    v_mul_f32 v232, s36, v232
    v_cos_f32 v224, v232
    v_sin_f32 v228, v232
    v_lshl_add_u32 v232, v222, 2, 1
    v_add_u32 v232, s6, v232
    v_mul_u32_u24 v232, v232, v223
    v_mul_hi_u32 v233, v232, s38
    v_mul_lo_u32 v233, v233, s37
    v_sub_u32 v232, v232, v233
    v_cvt_f32_u32 v232, v232
    v_mul_f32 v232, s36, v232
    v_cos_f32 v225, v232
    v_sin_f32 v229, v232
    v_lshl_add_u32 v232, v222, 2, 2
    v_add_u32 v232, s6, v232
    v_mul_u32_u24 v232, v232, v223
    v_mul_hi_u32 v233, v232, s38
    v_mul_lo_u32 v233, v233, s37
    v_sub_u32 v232, v232, v233
    v_cvt_f32_u32 v232, v232
    v_mul_f32 v232, s36, v232
    v_cos_f32 v226, v232
    v_sin_f32 v230, v232
    v_lshl_add_u32 v232, v222, 2, 3
    v_add_u32 v232, s6, v232
    v_mul_u32_u24 v232, v232, v223
    v_mul_hi_u32 v233, v232, s38
    v_mul_lo_u32 v233, v233, s37
    v_sub_u32 v232, v232, v233
    v_cvt_f32_u32 v232, v232
    v_mul_f32 v232, s36, v232
    v_cos_f32 v227, v232
    v_sin_f32 v231, v232
    v_lshlrev_b32 v232, 6, v223
    v_mul_hi_u32 v233, v232, s38
    v_mul_lo_u32 v233, v233, s37
    v_sub_u32 v232, v232, v233
    v_cvt_f32_u32 v232, v232
    v_mul_f32 v232, s36, v232
    v_cos_f32 v241, v232
    v_sin_f32 v242, v232
    v_mul_f32 v232, s39, v224
    v_mul_f32 v233, s40, v228
    v_mul_f32 v234, s39, v225
    v_mul_f32 v235, s40, v229
    v_mul_f32 v236, s39, v226
    v_mul_f32 v237, s40, v230
    v_mul_f32 v238, s39, v227
    v_mul_f32 v239, s40, v231
    s_cmp_lg_u32 s24, 0
    s_cbranch_scc1 Ls3_g01
    v_cmp_eq_u32 vcc, 0, v222
    v_mul_f32 v243, 0.5, v232
    s_nop 0
    v_cndmask_b32 v232, v232, v243, vcc
    v_mov_b32 v243, 0
    v_cndmask_b32 v233, v233, v243, vcc
Ls3_g01:
    v_cvt_pk_bf16_f32 v248, v232, v233
    v_cvt_pk_bf16_f32 v249, v234, v235
    v_cvt_pk_bf16_f32 v250, v236, v237
    v_cvt_pk_bf16_f32 v251, v238, v239
    s_lshl_b32 s3, s24, 10
    s_add_u32 s3, s3, 37888
    v_add_u32 v243, s3, v240
    ds_write_b128 v243, v[248:251]
    v_mul_f32 v232, v224, v241
    v_mul_f32 v233, v228, v241
    v_mul_f32 v234, v225, v241
    v_mul_f32 v235, v229, v241
    v_mul_f32 v236, v226, v241
    v_mul_f32 v237, v230, v241
    v_mul_f32 v238, v227, v241
    v_mul_f32 v239, v231, v241
    v_fma_f32 v232, -v228, v242, v232
    v_fma_f32 v233, v224, v242, v233
    v_fma_f32 v234, -v229, v242, v234
    v_fma_f32 v235, v225, v242, v235
    v_fma_f32 v236, -v230, v242, v236
    v_fma_f32 v237, v226, v242, v237
    v_fma_f32 v238, -v231, v242, v238
    v_fma_f32 v239, v227, v242, v239
    v_mov_b32 v224, v232
    v_mov_b32 v228, v233
    v_mov_b32 v225, v234
    v_mov_b32 v229, v235
    v_mov_b32 v226, v236
    v_mov_b32 v230, v237
    v_mov_b32 v227, v238
    v_mov_b32 v231, v239
    v_mul_f32 v232, s39, v224
    v_mul_f32 v233, s40, v228
    v_mul_f32 v234, s39, v225
    v_mul_f32 v235, s40, v229
    v_mul_f32 v236, s39, v226
    v_mul_f32 v237, s40, v230
    v_mul_f32 v238, s39, v227
    v_mul_f32 v239, s40, v231
    v_cvt_pk_bf16_f32 v248, v232, v233
    v_cvt_pk_bf16_f32 v249, v234, v235
    v_cvt_pk_bf16_f32 v250, v236, v237
    v_cvt_pk_bf16_f32 v251, v238, v239
    s_lshl_b32 s3, s24, 10
    s_add_u32 s3, s3, 46080
    v_add_u32 v243, s3, v240
    ds_write_b128 v243, v[248:251]
    v_mul_f32 v232, v224, v241
    v_mul_f32 v233, v228, v241
    v_mul_f32 v234, v225, v241
    v_mul_f32 v235, v229, v241
    v_mul_f32 v236, v226, v241
    v_mul_f32 v237, v230, v241
    v_mul_f32 v238, v227, v241
    v_mul_f32 v239, v231, v241
    v_fma_f32 v232, -v228, v242, v232
    v_fma_f32 v233, v224, v242, v233
    v_fma_f32 v234, -v229, v242, v234
    v_fma_f32 v235, v225, v242, v235
    v_fma_f32 v236, -v230, v242, v236
    v_fma_f32 v237, v226, v242, v237
    v_fma_f32 v238, -v231, v242, v238
    v_fma_f32 v239, v227, v242, v239
    v_mov_b32 v224, v232
    v_mov_b32 v228, v233
    v_mov_b32 v225, v234
    v_mov_b32 v229, v235
    v_mov_b32 v226, v236
    v_mov_b32 v230, v237
    v_mov_b32 v227, v238
    v_mov_b32 v231, v239
    v_mul_f32 v232, s39, v224
    v_mul_f32 v233, s40, v228
    v_mul_f32 v234, s39, v225
    v_mul_f32 v235, s40, v229
    v_mul_f32 v236, s39, v226
    v_mul_f32 v237, s40, v230
    v_mul_f32 v238, s39, v227
    v_mul_f32 v239, s40, v231
    v_cvt_pk_bf16_f32 v248, v232, v233
    v_cvt_pk_bf16_f32 v249, v234, v235
    v_cvt_pk_bf16_f32 v250, v236, v237
    v_cvt_pk_bf16_f32 v251, v238, v239
    s_lshl_b32 s3, s24, 10
    s_add_u32 s3, s3, 54272
    v_add_u32 v243, s3, v240
    ds_write_b128 v243, v[248:251]
    v_mul_f32 v232, v224, v241
    v_mul_f32 v233, v228, v241
    v_mul_f32 v234, v225, v241
    v_mul_f32 v235, v229, v241
    v_mul_f32 v236, v226, v241
    v_mul_f32 v237, v230, v241
    v_mul_f32 v238, v227, v241
    v_mul_f32 v239, v231, v241
    v_fma_f32 v232, -v228, v242, v232
    v_fma_f32 v233, v224, v242, v233
    v_fma_f32 v234, -v229, v242, v234
    v_fma_f32 v235, v225, v242, v235
    v_fma_f32 v236, -v230, v242, v236
    v_fma_f32 v237, v226, v242, v237
    v_fma_f32 v238, -v231, v242, v238
    v_fma_f32 v239, v227, v242, v239
    v_mov_b32 v224, v232
    v_mov_b32 v228, v233
    v_mov_b32 v225, v234
    v_mov_b32 v229, v235
    v_mov_b32 v226, v236
    v_mov_b32 v230, v237
    v_mov_b32 v227, v238
    v_mov_b32 v231, v239
    v_mul_f32 v232, s39, v224
    v_mul_f32 v233, s40, v228
    v_mul_f32 v234, s39, v225
    v_mul_f32 v235, s40, v229
    v_mul_f32 v236, s39, v226
    v_mul_f32 v237, s40, v230
    v_mul_f32 v238, s39, v227
    v_mul_f32 v239, s40, v231
    v_cvt_pk_bf16_f32 v248, v232, v233
    v_cvt_pk_bf16_f32 v249, v234, v235
    v_cvt_pk_bf16_f32 v250, v236, v237
    v_cvt_pk_bf16_f32 v251, v238, v239
    s_lshl_b32 s3, s24, 10
    s_add_u32 s3, s3, 62464
    v_add_u32 v243, s3, v240
    ds_write_b128 v243, v[248:251]
    v_mul_f32 v232, v224, v241
    v_mul_f32 v233, v228, v241
    v_mul_f32 v234, v225, v241
    v_mul_f32 v235, v229, v241
    v_mul_f32 v236, v226, v241
    v_mul_f32 v237, v230, v241
    v_mul_f32 v238, v227, v241
    v_mul_f32 v239, v231, v241
    v_fma_f32 v232, -v228, v242, v232
    v_fma_f32 v233, v224, v242, v233
    v_fma_f32 v234, -v229, v242, v234
    v_fma_f32 v235, v225, v242, v235
    v_fma_f32 v236, -v230, v242, v236
    v_fma_f32 v237, v226, v242, v237
    v_fma_f32 v238, -v231, v242, v238
    v_fma_f32 v239, v227, v242, v239
    v_mov_b32 v224, v232
    v_mov_b32 v228, v233
    v_mov_b32 v225, v234
    v_mov_b32 v229, v235
    v_mov_b32 v226, v236
    v_mov_b32 v230, v237
    v_mov_b32 v227, v238
    v_mov_b32 v231, v239
    s_cmp_ge_u32 s24, 5
    s_cbranch_scc1 Ls3_gn1
    v_mul_f32 v232, s39, v224
    v_mul_f32 v233, s40, v228
    v_mul_f32 v234, s39, v225
    v_mul_f32 v235, s40, v229
    v_mul_f32 v236, s39, v226
    v_mul_f32 v237, s40, v230
    v_mul_f32 v238, s39, v227
    v_mul_f32 v239, s40, v231
    s_cmp_lg_u32 s24, 4
    s_cbranch_scc1 Ls3_g41
    v_cmp_eq_u32 vcc, 0, v222
    v_mul_f32 v243, 0.5, v232
    v_mov_b32 v244, 0
    v_cndmask_b32 v232, v244, v243, vcc
    v_mov_b32 v233, 0
    v_mov_b32 v234, 0
    v_mov_b32 v235, 0
    v_mov_b32 v236, 0
    v_mov_b32 v237, 0
    v_mov_b32 v238, 0
    v_mov_b32 v239, 0
Ls3_g41:
    v_cvt_pk_bf16_f32 v248, v232, v233
    v_cvt_pk_bf16_f32 v249, v234, v235
    v_cvt_pk_bf16_f32 v250, v236, v237
    v_cvt_pk_bf16_f32 v251, v238, v239
    s_lshl_b32 s3, s24, 10
    s_add_u32 s3, s3, 70656
    v_add_u32 v243, s3, v240
    ds_write_b128 v243, v[248:251]
Ls3_gn1:
    s_mul_i32 s6, s26, 96
    s_add_u32 s6, s6, 64
    v_add_u32 v223, s6, v221
    s_lshl_b32 s6, s24, 3
    v_lshl_add_u32 v232, v222, 2, 0
    v_add_u32 v232, s6, v232
    v_mul_u32_u24 v232, v232, v223
    v_mul_hi_u32 v233, v232, s38
    v_mul_lo_u32 v233, v233, s37
    v_sub_u32 v232, v232, v233
    v_cvt_f32_u32 v232, v232
    v_mul_f32 v232, s36, v232
    v_cos_f32 v224, v232
    v_sin_f32 v228, v232
    v_lshl_add_u32 v232, v222, 2, 1
    v_add_u32 v232, s6, v232
    v_mul_u32_u24 v232, v232, v223
    v_mul_hi_u32 v233, v232, s38
    v_mul_lo_u32 v233, v233, s37
    v_sub_u32 v232, v232, v233
    v_cvt_f32_u32 v232, v232
    v_mul_f32 v232, s36, v232
    v_cos_f32 v225, v232
    v_sin_f32 v229, v232
    v_lshl_add_u32 v232, v222, 2, 2
    v_add_u32 v232, s6, v232
    v_mul_u32_u24 v232, v232, v223
    v_mul_hi_u32 v233, v232, s38
    v_mul_lo_u32 v233, v233, s37
    v_sub_u32 v232, v232, v233
    v_cvt_f32_u32 v232, v232
    v_mul_f32 v232, s36, v232
    v_cos_f32 v226, v232
    v_sin_f32 v230, v232
    v_lshl_add_u32 v232, v222, 2, 3
    v_add_u32 v232, s6, v232
    v_mul_u32_u24 v232, v232, v223
    v_mul_hi_u32 v233, v232, s38
    v_mul_lo_u32 v233, v233, s37
    v_sub_u32 v232, v232, v233
    v_cvt_f32_u32 v232, v232
    v_mul_f32 v232, s36, v232
    v_cos_f32 v227, v232
    v_sin_f32 v231, v232
    v_lshlrev_b32 v232, 6, v223
    v_mul_hi_u32 v233, v232, s38
    v_mul_lo_u32 v233, v233, s37
    v_sub_u32 v232, v232, v233
    v_cvt_f32_u32 v232, v232
    v_mul_f32 v232, s36, v232
    v_cos_f32 v241, v232
    v_sin_f32 v242, v232
    v_mul_f32 v232, s39, v224
    v_mul_f32 v233, s40, v228
    v_mul_f32 v234, s39, v225
    v_mul_f32 v235, s40, v229
    v_mul_f32 v236, s39, v226
    v_mul_f32 v237, s40, v230
    v_mul_f32 v238, s39, v227
    v_mul_f32 v239, s40, v231
    s_cmp_lg_u32 s24, 0
    s_cbranch_scc1 Ls3_g02
    v_cmp_eq_u32 vcc, 0, v222
    v_mul_f32 v243, 0.5, v232
    s_nop 0
    v_cndmask_b32 v232, v232, v243, vcc
    v_mov_b32 v243, 0
    v_cndmask_b32 v233, v233, v243, vcc
Ls3_g02:
    v_cvt_pk_bf16_f32 v248, v232, v233
    v_cvt_pk_bf16_f32 v249, v234, v235
    v_cvt_pk_bf16_f32 v250, v236, v237
    v_cvt_pk_bf16_f32 v251, v238, v239
    s_lshl_b32 s3, s24, 10
    s_add_u32 s3, s3, 75776
    v_add_u32 v243, s3, v240
    ds_write_b128 v243, v[248:251]
    v_mul_f32 v232, v224, v241
    v_mul_f32 v233, v228, v241
    v_mul_f32 v234, v225, v241
    v_mul_f32 v235, v229, v241
    v_mul_f32 v236, v226, v241
    v_mul_f32 v237, v230, v241
    v_mul_f32 v238, v227, v241
    v_mul_f32 v239, v231, v241
    v_fma_f32 v232, -v228, v242, v232
    v_fma_f32 v233, v224, v242, v233
    v_fma_f32 v234, -v229, v242, v234
    v_fma_f32 v235, v225, v242, v235
    v_fma_f32 v236, -v230, v242, v236
    v_fma_f32 v237, v226, v242, v237
    v_fma_f32 v238, -v231, v242, v238
    v_fma_f32 v239, v227, v242, v239
    v_mov_b32 v224, v232
    v_mov_b32 v228, v233
    v_mov_b32 v225, v234
    v_mov_b32 v229, v235
    v_mov_b32 v226, v236
    v_mov_b32 v230, v237
    v_mov_b32 v227, v238
    v_mov_b32 v231, v239
    v_mul_f32 v232, s39, v224
    v_mul_f32 v233, s40, v228
    v_mul_f32 v234, s39, v225
    v_mul_f32 v235, s40, v229
    v_mul_f32 v236, s39, v226
    v_mul_f32 v237, s40, v230
    v_mul_f32 v238, s39, v227
    v_mul_f32 v239, s40, v231
    v_cvt_pk_bf16_f32 v248, v232, v233
    v_cvt_pk_bf16_f32 v249, v234, v235
    v_cvt_pk_bf16_f32 v250, v236, v237
    v_cvt_pk_bf16_f32 v251, v238, v239
    s_lshl_b32 s3, s24, 10
    s_add_u32 s3, s3, 83968
    v_add_u32 v243, s3, v240
    ds_write_b128 v243, v[248:251]
    v_mul_f32 v232, v224, v241
    v_mul_f32 v233, v228, v241
    v_mul_f32 v234, v225, v241
    v_mul_f32 v235, v229, v241
    v_mul_f32 v236, v226, v241
    v_mul_f32 v237, v230, v241
    v_mul_f32 v238, v227, v241
    v_mul_f32 v239, v231, v241
    v_fma_f32 v232, -v228, v242, v232
    v_fma_f32 v233, v224, v242, v233
    v_fma_f32 v234, -v229, v242, v234
    v_fma_f32 v235, v225, v242, v235
    v_fma_f32 v236, -v230, v242, v236
    v_fma_f32 v237, v226, v242, v237
    v_fma_f32 v238, -v231, v242, v238
    v_fma_f32 v239, v227, v242, v239
    v_mov_b32 v224, v232
    v_mov_b32 v228, v233
    v_mov_b32 v225, v234
    v_mov_b32 v229, v235
    v_mov_b32 v226, v236
    v_mov_b32 v230, v237
    v_mov_b32 v227, v238
    v_mov_b32 v231, v239
    v_mul_f32 v232, s39, v224
    v_mul_f32 v233, s40, v228
    v_mul_f32 v234, s39, v225
    v_mul_f32 v235, s40, v229
    v_mul_f32 v236, s39, v226
    v_mul_f32 v237, s40, v230
    v_mul_f32 v238, s39, v227
    v_mul_f32 v239, s40, v231
    v_cvt_pk_bf16_f32 v248, v232, v233
    v_cvt_pk_bf16_f32 v249, v234, v235
    v_cvt_pk_bf16_f32 v250, v236, v237
    v_cvt_pk_bf16_f32 v251, v238, v239
    s_lshl_b32 s3, s24, 10
    s_add_u32 s3, s3, 92160
    v_add_u32 v243, s3, v240
    ds_write_b128 v243, v[248:251]
    v_mul_f32 v232, v224, v241
    v_mul_f32 v233, v228, v241
    v_mul_f32 v234, v225, v241
    v_mul_f32 v235, v229, v241
    v_mul_f32 v236, v226, v241
    v_mul_f32 v237, v230, v241
    v_mul_f32 v238, v227, v241
    v_mul_f32 v239, v231, v241
    v_fma_f32 v232, -v228, v242, v232
    v_fma_f32 v233, v224, v242, v233
    v_fma_f32 v234, -v229, v242, v234
    v_fma_f32 v235, v225, v242, v235
    v_fma_f32 v236, -v230, v242, v236
    v_fma_f32 v237, v226, v242, v237
    v_fma_f32 v238, -v231, v242, v238
    v_fma_f32 v239, v227, v242, v239
    v_mov_b32 v224, v232
    v_mov_b32 v228, v233
    v_mov_b32 v225, v234
    v_mov_b32 v229, v235
    v_mov_b32 v226, v236
    v_mov_b32 v230, v237
    v_mov_b32 v227, v238
    v_mov_b32 v231, v239
    v_mul_f32 v232, s39, v224
    v_mul_f32 v233, s40, v228
    v_mul_f32 v234, s39, v225
    v_mul_f32 v235, s40, v229
    v_mul_f32 v236, s39, v226
    v_mul_f32 v237, s40, v230
    v_mul_f32 v238, s39, v227
    v_mul_f32 v239, s40, v231
    v_cvt_pk_bf16_f32 v248, v232, v233
    v_cvt_pk_bf16_f32 v249, v234, v235
    v_cvt_pk_bf16_f32 v250, v236, v237
    v_cvt_pk_bf16_f32 v251, v238, v239
    s_lshl_b32 s3, s24, 10
    s_add_u32 s3, s3, 100352
    v_add_u32 v243, s3, v240
    ds_write_b128 v243, v[248:251]
    v_mul_f32 v232, v224, v241
    v_mul_f32 v233, v228, v241
    v_mul_f32 v234, v225, v241
    v_mul_f32 v235, v229, v241
    v_mul_f32 v236, v226, v241
    v_mul_f32 v237, v230, v241
    v_mul_f32 v238, v227, v241
    v_mul_f32 v239, v231, v241
    v_fma_f32 v232, -v228, v242, v232
    v_fma_f32 v233, v224, v242, v233
    v_fma_f32 v234, -v229, v242, v234
    v_fma_f32 v235, v225, v242, v235
    v_fma_f32 v236, -v230, v242, v236
    v_fma_f32 v237, v226, v242, v237
    v_fma_f32 v238, -v231, v242, v238
    v_fma_f32 v239, v227, v242, v239
    v_mov_b32 v224, v232
    v_mov_b32 v228, v233
    v_mov_b32 v225, v234
    v_mov_b32 v229, v235
    v_mov_b32 v226, v236
    v_mov_b32 v230, v237
    v_mov_b32 v227, v238
    v_mov_b32 v231, v239
    s_cmp_ge_u32 s24, 5
    s_cbranch_scc1 Ls3_gn2
    v_mul_f32 v232, s39, v224
    v_mul_f32 v233, s40, v228
    v_mul_f32 v234, s39, v225
    v_mul_f32 v235, s40, v229
    v_mul_f32 v236, s39, v226
    v_mul_f32 v237, s40, v230
    v_mul_f32 v238, s39, v227
    v_mul_f32 v239, s40, v231
    s_cmp_lg_u32 s24, 4
    s_cbranch_scc1 Ls3_g42
    v_cmp_eq_u32 vcc, 0, v222
    v_mul_f32 v243, 0.5, v232
    v_mov_b32 v244, 0
    v_cndmask_b32 v232, v244, v243, vcc
    v_mov_b32 v233, 0
    v_mov_b32 v234, 0
    v_mov_b32 v235, 0
    v_mov_b32 v236, 0
    v_mov_b32 v237, 0
    v_mov_b32 v238, 0
    v_mov_b32 v239, 0
Ls3_g42:
    v_cvt_pk_bf16_f32 v248, v232, v233
    v_cvt_pk_bf16_f32 v249, v234, v235
    v_cvt_pk_bf16_f32 v250, v236, v237
    v_cvt_pk_bf16_f32 v251, v238, v239
    s_lshl_b32 s3, s24, 10
    s_add_u32 s3, s3, 108544
    v_add_u32 v243, s3, v240
    ds_write_b128 v243, v[248:251]
Ls3_gn2:
Ls3_gend:
    v_mov_b32 v0, 0
    v_mov_b32 v1, 0
    v_mov_b32 v2, 0
    v_mov_b32 v3, 0
    v_mov_b32 v4, 0
    v_mov_b32 v5, 0
    v_mov_b32 v6, 0
    v_mov_b32 v7, 0
    v_mov_b32 v8, 0
    v_mov_b32 v9, 0
    v_mov_b32 v10, 0
    v_mov_b32 v11, 0
    v_mov_b32 v12, 0
    v_mov_b32 v13, 0
    v_mov_b32 v14, 0
    v_mov_b32 v15, 0
    v_mov_b32 v16, 0
    v_mov_b32 v17, 0
    v_mov_b32 v18, 0
    v_mov_b32 v19, 0
    v_mov_b32 v20, 0
    v_mov_b32 v21, 0
    v_mov_b32 v22, 0
    v_mov_b32 v23, 0
    v_mov_b32 v24, 0
    v_mov_b32 v25, 0
    v_mov_b32 v26, 0
    v_mov_b32 v27, 0
    v_mov_b32 v28, 0
    v_mov_b32 v29, 0
    v_mov_b32 v30, 0
    v_mov_b32 v31, 0
    v_mov_b32 v32, 0
    v_mov_b32 v33, 0
    v_mov_b32 v34, 0
    v_mov_b32 v35, 0
    v_mov_b32 v36, 0
    v_mov_b32 v37, 0
    v_mov_b32 v38, 0
    v_mov_b32 v39, 0
    v_mov_b32 v40, 0
    v_mov_b32 v41, 0
    v_mov_b32 v42, 0
    v_mov_b32 v43, 0
    v_mov_b32 v44, 0
    v_mov_b32 v45, 0
    v_mov_b32 v46, 0
    v_mov_b32 v47, 0
    s_waitcnt lgkmcnt(0)
    s_cmp_lg_u32 s24, 0
    s_cbranch_scc1 Lc23_wd
    v_mov_b32 v223, 0
Lc23_poll:
    buffer_load_dword v224, v223, s[60:63], 0 offen sc0 sc1
    s_waitcnt vmcnt(0)
    v_readfirstlane_b32 s3, v224
    s_nop 2
    s_cmp_ge_u32 s3, 37
    s_cbranch_scc1 Lc23_wd
    s_sleep 2
    s_branch Lc23_poll
Lc23_wd:
    s_barrier
    s_lshl_b32 s27, s25, 3
    s_add_u32 s27, s27, s24
    s_mul_i32 s3, s27, 37888
    v_add_u32 v241, s3, v240
    buffer_load_dwordx4 v[48:51], v241, s[8:11], 0 offen offset:0 sc0 sc1
    buffer_load_dwordx4 v[52:55], v241, s[8:11], 0 offen offset:1024 sc0 sc1
    buffer_load_dwordx4 v[56:59], v241, s[8:11], 0 offen offset:2048 sc0 sc1
    buffer_load_dwordx4 v[60:63], v241, s[8:11], 0 offen offset:3072 sc0 sc1
    v_add_u32 v241, 4096, v241
    buffer_load_dwordx4 v[64:67], v241, s[8:11], 0 offen offset:0 sc0 sc1
    buffer_load_dwordx4 v[68:71], v241, s[8:11], 0 offen offset:1024 sc0 sc1
    buffer_load_dwordx4 v[72:75], v241, s[8:11], 0 offen offset:2048 sc0 sc1
    buffer_load_dwordx4 v[76:79], v241, s[8:11], 0 offen offset:3072 sc0 sc1
    v_add_u32 v241, 4096, v241
    buffer_load_dwordx4 v[80:83], v241, s[8:11], 0 offen offset:0 sc0 sc1
    buffer_load_dwordx4 v[84:87], v241, s[8:11], 0 offen offset:1024 sc0 sc1
    buffer_load_dwordx4 v[88:91], v241, s[8:11], 0 offen offset:2048 sc0 sc1
    buffer_load_dwordx4 v[92:95], v241, s[8:11], 0 offen offset:3072 sc0 sc1
    v_add_u32 v241, 4096, v241
    buffer_load_dwordx4 v[96:99], v241, s[8:11], 0 offen offset:0 sc0 sc1
    buffer_load_dwordx4 v[100:103], v241, s[8:11], 0 offen offset:1024 sc0 sc1
    buffer_load_dwordx4 v[104:107], v241, s[8:11], 0 offen offset:2048 sc0 sc1
    buffer_load_dwordx4 v[108:111], v241, s[8:11], 0 offen offset:3072 sc0 sc1
    v_add_u32 v241, 4096, v241
    buffer_load_dwordx4 v[112:115], v241, s[8:11], 0 offen offset:0 sc0 sc1
    buffer_load_dwordx4 v[116:119], v241, s[8:11], 0 offen offset:1024 sc0 sc1
    buffer_load_dwordx4 v[120:123], v241, s[8:11], 0 offen offset:2048 sc0 sc1
    buffer_load_dwordx4 v[124:127], v241, s[8:11], 0 offen offset:3072 sc0 sc1
    v_add_u32 v241, 4096, v241
    buffer_load_dwordx4 v[128:131], v241, s[8:11], 0 offen offset:0 sc0 sc1
    buffer_load_dwordx4 v[132:135], v241, s[8:11], 0 offen offset:1024 sc0 sc1
    buffer_load_dwordx4 v[136:139], v241, s[8:11], 0 offen offset:2048 sc0 sc1
    buffer_load_dwordx4 v[140:143], v241, s[8:11], 0 offen offset:3072 sc0 sc1
    v_add_u32 v241, 4096, v241
    buffer_load_dwordx4 v[144:147], v241, s[8:11], 0 offen offset:0 sc0 sc1
    buffer_load_dwordx4 v[148:151], v241, s[8:11], 0 offen offset:1024 sc0 sc1
    buffer_load_dwordx4 v[152:155], v241, s[8:11], 0 offen offset:2048 sc0 sc1
    buffer_load_dwordx4 v[156:159], v241, s[8:11], 0 offen offset:3072 sc0 sc1
    v_add_u32 v241, 4096, v241
    buffer_load_dwordx4 v[160:163], v241, s[8:11], 0 offen offset:0 sc0 sc1
    buffer_load_dwordx4 v[164:167], v241, s[8:11], 0 offen offset:1024 sc0 sc1
    buffer_load_dwordx4 v[168:171], v241, s[8:11], 0 offen offset:2048 sc0 sc1
    buffer_load_dwordx4 v[172:175], v241, s[8:11], 0 offen offset:3072 sc0 sc1
    v_add_u32 v241, 4096, v241
    buffer_load_dwordx4 v[176:179], v241, s[8:11], 0 offen offset:0 sc0 sc1
    buffer_load_dwordx4 v[180:183], v241, s[8:11], 0 offen offset:1024 sc0 sc1
    buffer_load_dwordx4 v[184:187], v241, s[8:11], 0 offen offset:2048 sc0 sc1
    buffer_load_dwordx4 v[188:191], v241, s[8:11], 0 offen offset:3072 sc0 sc1
    v_add_u32 v241, 4096, v241
    buffer_load_dwordx4 v[192:195], v241, s[8:11], 0 offen offset:0 sc0 sc1
    v_add_u32 v242, 37888, v240
    v_add_u32 v243, 75776, v240
    ds_read_b128 v[196:199], v240 offset:0
    ds_read_b128 v[200:203], v242 offset:0
    ds_read_b128 v[204:207], v243 offset:0
    ds_read_b128 v[208:211], v240 offset:1024
    ds_read_b128 v[212:215], v242 offset:1024
    ds_read_b128 v[216:219], v243 offset:1024
    s_waitcnt vmcnt(36) lgkmcnt(3)
    v_mfma_f32_32x32x16_bf16 v[0:15], v[196:199], v[48:51], v[0:15]
    v_mfma_f32_32x32x16_bf16 v[16:31], v[200:203], v[48:51], v[16:31]
    v_mfma_f32_32x32x16_bf16 v[32:47], v[204:207], v[48:51], v[32:47]
    ds_read_b128 v[196:199], v240 offset:2048
    ds_read_b128 v[200:203], v242 offset:2048
    ds_read_b128 v[204:207], v243 offset:2048
    s_waitcnt vmcnt(35) lgkmcnt(3)
    v_mfma_f32_32x32x16_bf16 v[0:15], v[208:211], v[52:55], v[0:15]
    v_mfma_f32_32x32x16_bf16 v[16:31], v[212:215], v[52:55], v[16:31]
    v_mfma_f32_32x32x16_bf16 v[32:47], v[216:219], v[52:55], v[32:47]
    ds_read_b128 v[208:211], v240 offset:3072
    ds_read_b128 v[212:215], v242 offset:3072
    ds_read_b128 v[216:219], v243 offset:3072
    s_waitcnt vmcnt(34) lgkmcnt(3)
    v_mfma_f32_32x32x16_bf16 v[0:15], v[196:199], v[56:59], v[0:15]
    v_mfma_f32_32x32x16_bf16 v[16:31], v[200:203], v[56:59], v[16:31]
    v_mfma_f32_32x32x16_bf16 v[32:47], v[204:207], v[56:59], v[32:47]
    ds_read_b128 v[196:199], v240 offset:4096
    ds_read_b128 v[200:203], v242 offset:4096
    ds_read_b128 v[204:207], v243 offset:4096
    s_waitcnt vmcnt(33) lgkmcnt(3)
    v_mfma_f32_32x32x16_bf16 v[0:15], v[208:211], v[60:63], v[0:15]
    v_mfma_f32_32x32x16_bf16 v[16:31], v[212:215], v[60:63], v[16:31]
    v_mfma_f32_32x32x16_bf16 v[32:47], v[216:219], v[60:63], v[32:47]
    ds_read_b128 v[208:211], v240 offset:5120
    ds_read_b128 v[212:215], v242 offset:5120
    ds_read_b128 v[216:219], v243 offset:5120
    s_waitcnt vmcnt(32) lgkmcnt(3)
    v_mfma_f32_32x32x16_bf16 v[0:15], v[196:199], v[64:67], v[0:15]
    v_mfma_f32_32x32x16_bf16 v[16:31], v[200:203], v[64:67], v[16:31]
    v_mfma_f32_32x32x16_bf16 v[32:47], v[204:207], v[64:67], v[32:47]
    ds_read_b128 v[196:199], v240 offset:6144
    ds_read_b128 v[200:203], v242 offset:6144
    ds_read_b128 v[204:207], v243 offset:6144
    s_waitcnt vmcnt(31) lgkmcnt(3)
    v_mfma_f32_32x32x16_bf16 v[0:15], v[208:211], v[68:71], v[0:15]
    v_mfma_f32_32x32x16_bf16 v[16:31], v[212:215], v[68:71], v[16:31]
    v_mfma_f32_32x32x16_bf16 v[32:47], v[216:219], v[68:71], v[32:47]
    ds_read_b128 v[208:211], v240 offset:7168
    ds_read_b128 v[212:215], v242 offset:7168
    ds_read_b128 v[216:219], v243 offset:7168
    s_waitcnt vmcnt(30) lgkmcnt(3)
    v_mfma_f32_32x32x16_bf16 v[0:15], v[196:199], v[72:75], v[0:15]
    v_mfma_f32_32x32x16_bf16 v[16:31], v[200:203], v[72:75], v[16:31]
    v_mfma_f32_32x32x16_bf16 v[32:47], v[204:207], v[72:75], v[32:47]
    ds_read_b128 v[196:199], v240 offset:8192
    ds_read_b128 v[200:203], v242 offset:8192
    ds_read_b128 v[204:207], v243 offset:8192
    s_waitcnt vmcnt(29) lgkmcnt(3)
    v_mfma_f32_32x32x16_bf16 v[0:15], v[208:211], v[76:79], v[0:15]
    v_mfma_f32_32x32x16_bf16 v[16:31], v[212:215], v[76:79], v[16:31]
    v_mfma_f32_32x32x16_bf16 v[32:47], v[216:219], v[76:79], v[32:47]
    ds_read_b128 v[208:211], v240 offset:9216
    ds_read_b128 v[212:215], v242 offset:9216
    ds_read_b128 v[216:219], v243 offset:9216
    s_waitcnt vmcnt(28) lgkmcnt(3)
    v_mfma_f32_32x32x16_bf16 v[0:15], v[196:199], v[80:83], v[0:15]
    v_mfma_f32_32x32x16_bf16 v[16:31], v[200:203], v[80:83], v[16:31]
    v_mfma_f32_32x32x16_bf16 v[32:47], v[204:207], v[80:83], v[32:47]
    ds_read_b128 v[196:199], v240 offset:10240
    ds_read_b128 v[200:203], v242 offset:10240
    ds_read_b128 v[204:207], v243 offset:10240
    s_waitcnt vmcnt(27) lgkmcnt(3)
    v_mfma_f32_32x32x16_bf16 v[0:15], v[208:211], v[84:87], v[0:15]
    v_mfma_f32_32x32x16_bf16 v[16:31], v[212:215], v[84:87], v[16:31]
    v_mfma_f32_32x32x16_bf16 v[32:47], v[216:219], v[84:87], v[32:47]
    ds_read_b128 v[208:211], v240 offset:11264
    ds_read_b128 v[212:215], v242 offset:11264
    ds_read_b128 v[216:219], v243 offset:11264
    s_waitcnt vmcnt(26) lgkmcnt(3)
    v_mfma_f32_32x32x16_bf16 v[0:15], v[196:199], v[88:91], v[0:15]
    v_mfma_f32_32x32x16_bf16 v[16:31], v[200:203], v[88:91], v[16:31]
    v_mfma_f32_32x32x16_bf16 v[32:47], v[204:207], v[88:91], v[32:47]
    ds_read_b128 v[196:199], v240 offset:12288
    ds_read_b128 v[200:203], v242 offset:12288
    ds_read_b128 v[204:207], v243 offset:12288
    s_waitcnt vmcnt(25) lgkmcnt(3)
    v_mfma_f32_32x32x16_bf16 v[0:15], v[208:211], v[92:95], v[0:15]
    v_mfma_f32_32x32x16_bf16 v[16:31], v[212:215], v[92:95], v[16:31]
    v_mfma_f32_32x32x16_bf16 v[32:47], v[216:219], v[92:95], v[32:47]
    ds_read_b128 v[208:211], v240 offset:13312
    ds_read_b128 v[212:215], v242 offset:13312
    ds_read_b128 v[216:219], v243 offset:13312
    s_waitcnt vmcnt(24) lgkmcnt(3)
    v_mfma_f32_32x32x16_bf16 v[0:15], v[196:199], v[96:99], v[0:15]
    v_mfma_f32_32x32x16_bf16 v[16:31], v[200:203], v[96:99], v[16:31]
    v_mfma_f32_32x32x16_bf16 v[32:47], v[204:207], v[96:99], v[32:47]
    ds_read_b128 v[196:199], v240 offset:14336
    ds_read_b128 v[200:203], v242 offset:14336
    ds_read_b128 v[204:207], v243 offset:14336
    s_waitcnt vmcnt(23) lgkmcnt(3)
    v_mfma_f32_32x32x16_bf16 v[0:15], v[208:211], v[100:103], v[0:15]
    v_mfma_f32_32x32x16_bf16 v[16:31], v[212:215], v[100:103], v[16:31]
    v_mfma_f32_32x32x16_bf16 v[32:47], v[216:219], v[100:103], v[32:47]
    ds_read_b128 v[208:211], v240 offset:15360
    ds_read_b128 v[212:215], v242 offset:15360
    ds_read_b128 v[216:219], v243 offset:15360
    s_waitcnt vmcnt(22) lgkmcnt(3)
    v_mfma_f32_32x32x16_bf16 v[0:15], v[196:199], v[104:107], v[0:15]
    v_mfma_f32_32x32x16_bf16 v[16:31], v[200:203], v[104:107], v[16:31]
    v_mfma_f32_32x32x16_bf16 v[32:47], v[204:207], v[104:107], v[32:47]
    ds_read_b128 v[196:199], v240 offset:16384
    ds_read_b128 v[200:203], v242 offset:16384
    ds_read_b128 v[204:207], v243 offset:16384
    s_waitcnt vmcnt(21) lgkmcnt(3)
    v_mfma_f32_32x32x16_bf16 v[0:15], v[208:211], v[108:111], v[0:15]
    v_mfma_f32_32x32x16_bf16 v[16:31], v[212:215], v[108:111], v[16:31]
    v_mfma_f32_32x32x16_bf16 v[32:47], v[216:219], v[108:111], v[32:47]
    ds_read_b128 v[208:211], v240 offset:17408
    ds_read_b128 v[212:215], v242 offset:17408
    ds_read_b128 v[216:219], v243 offset:17408
    s_waitcnt vmcnt(20) lgkmcnt(3)
    v_mfma_f32_32x32x16_bf16 v[0:15], v[196:199], v[112:115], v[0:15]
    v_mfma_f32_32x32x16_bf16 v[16:31], v[200:203], v[112:115], v[16:31]
    v_mfma_f32_32x32x16_bf16 v[32:47], v[204:207], v[112:115], v[32:47]
    ds_read_b128 v[196:199], v240 offset:18432
    ds_read_b128 v[200:203], v242 offset:18432
    ds_read_b128 v[204:207], v243 offset:18432
    s_waitcnt vmcnt(19) lgkmcnt(3)
    v_mfma_f32_32x32x16_bf16 v[0:15], v[208:211], v[116:119], v[0:15]
    v_mfma_f32_32x32x16_bf16 v[16:31], v[212:215], v[116:119], v[16:31]
    v_mfma_f32_32x32x16_bf16 v[32:47], v[216:219], v[116:119], v[32:47]
    ds_read_b128 v[208:211], v240 offset:19456
    ds_read_b128 v[212:215], v242 offset:19456
    ds_read_b128 v[216:219], v243 offset:19456
    s_waitcnt vmcnt(18) lgkmcnt(3)
    v_mfma_f32_32x32x16_bf16 v[0:15], v[196:199], v[120:123], v[0:15]
    v_mfma_f32_32x32x16_bf16 v[16:31], v[200:203], v[120:123], v[16:31]
    v_mfma_f32_32x32x16_bf16 v[32:47], v[204:207], v[120:123], v[32:47]
    ds_read_b128 v[196:199], v240 offset:20480
    ds_read_b128 v[200:203], v242 offset:20480
    ds_read_b128 v[204:207], v243 offset:20480
    s_waitcnt vmcnt(17) lgkmcnt(3)
    v_mfma_f32_32x32x16_bf16 v[0:15], v[208:211], v[124:127], v[0:15]
    v_mfma_f32_32x32x16_bf16 v[16:31], v[212:215], v[124:127], v[16:31]
    v_mfma_f32_32x32x16_bf16 v[32:47], v[216:219], v[124:127], v[32:47]
    ds_read_b128 v[208:211], v240 offset:21504
    ds_read_b128 v[212:215], v242 offset:21504
    ds_read_b128 v[216:219], v243 offset:21504
    s_waitcnt vmcnt(16) lgkmcnt(3)
    v_mfma_f32_32x32x16_bf16 v[0:15], v[196:199], v[128:131], v[0:15]
    v_mfma_f32_32x32x16_bf16 v[16:31], v[200:203], v[128:131], v[16:31]
    v_mfma_f32_32x32x16_bf16 v[32:47], v[204:207], v[128:131], v[32:47]
    ds_read_b128 v[196:199], v240 offset:22528
    ds_read_b128 v[200:203], v242 offset:22528
    ds_read_b128 v[204:207], v243 offset:22528
    s_waitcnt vmcnt(15) lgkmcnt(3)
    v_mfma_f32_32x32x16_bf16 v[0:15], v[208:211], v[132:135], v[0:15]
    v_mfma_f32_32x32x16_bf16 v[16:31], v[212:215], v[132:135], v[16:31]
    v_mfma_f32_32x32x16_bf16 v[32:47], v[216:219], v[132:135], v[32:47]
    ds_read_b128 v[208:211], v240 offset:23552
    ds_read_b128 v[212:215], v242 offset:23552
    ds_read_b128 v[216:219], v243 offset:23552
    s_waitcnt vmcnt(14) lgkmcnt(3)
    v_mfma_f32_32x32x16_bf16 v[0:15], v[196:199], v[136:139], v[0:15]
    v_mfma_f32_32x32x16_bf16 v[16:31], v[200:203], v[136:139], v[16:31]
    v_mfma_f32_32x32x16_bf16 v[32:47], v[204:207], v[136:139], v[32:47]
    ds_read_b128 v[196:199], v240 offset:24576
    ds_read_b128 v[200:203], v242 offset:24576
    ds_read_b128 v[204:207], v243 offset:24576
    s_waitcnt vmcnt(13) lgkmcnt(3)
    v_mfma_f32_32x32x16_bf16 v[0:15], v[208:211], v[140:143], v[0:15]
    v_mfma_f32_32x32x16_bf16 v[16:31], v[212:215], v[140:143], v[16:31]
    v_mfma_f32_32x32x16_bf16 v[32:47], v[216:219], v[140:143], v[32:47]
    ds_read_b128 v[208:211], v240 offset:25600
    ds_read_b128 v[212:215], v242 offset:25600
    ds_read_b128 v[216:219], v243 offset:25600
    s_waitcnt vmcnt(12) lgkmcnt(3)
    v_mfma_f32_32x32x16_bf16 v[0:15], v[196:199], v[144:147], v[0:15]
    v_mfma_f32_32x32x16_bf16 v[16:31], v[200:203], v[144:147], v[16:31]
    v_mfma_f32_32x32x16_bf16 v[32:47], v[204:207], v[144:147], v[32:47]
    ds_read_b128 v[196:199], v240 offset:26624
    ds_read_b128 v[200:203], v242 offset:26624
    ds_read_b128 v[204:207], v243 offset:26624
    s_waitcnt vmcnt(11) lgkmcnt(3)
    v_mfma_f32_32x32x16_bf16 v[0:15], v[208:211], v[148:151], v[0:15]
    v_mfma_f32_32x32x16_bf16 v[16:31], v[212:215], v[148:151], v[16:31]
    v_mfma_f32_32x32x16_bf16 v[32:47], v[216:219], v[148:151], v[32:47]
    ds_read_b128 v[208:211], v240 offset:27648
    ds_read_b128 v[212:215], v242 offset:27648
    ds_read_b128 v[216:219], v243 offset:27648
    s_waitcnt vmcnt(10) lgkmcnt(3)
    v_mfma_f32_32x32x16_bf16 v[0:15], v[196:199], v[152:155], v[0:15]
    v_mfma_f32_32x32x16_bf16 v[16:31], v[200:203], v[152:155], v[16:31]
    v_mfma_f32_32x32x16_bf16 v[32:47], v[204:207], v[152:155], v[32:47]
    ds_read_b128 v[196:199], v240 offset:28672
    ds_read_b128 v[200:203], v242 offset:28672
    ds_read_b128 v[204:207], v243 offset:28672
    s_waitcnt vmcnt(9) lgkmcnt(3)
    v_mfma_f32_32x32x16_bf16 v[0:15], v[208:211], v[156:159], v[0:15]
    v_mfma_f32_32x32x16_bf16 v[16:31], v[212:215], v[156:159], v[16:31]
    v_mfma_f32_32x32x16_bf16 v[32:47], v[216:219], v[156:159], v[32:47]
    ds_read_b128 v[208:211], v240 offset:29696
    ds_read_b128 v[212:215], v242 offset:29696
    ds_read_b128 v[216:219], v243 offset:29696
    s_waitcnt vmcnt(8) lgkmcnt(3)
    v_mfma_f32_32x32x16_bf16 v[0:15], v[196:199], v[160:163], v[0:15]
    v_mfma_f32_32x32x16_bf16 v[16:31], v[200:203], v[160:163], v[16:31]
    v_mfma_f32_32x32x16_bf16 v[32:47], v[204:207], v[160:163], v[32:47]
    ds_read_b128 v[196:199], v240 offset:30720
    ds_read_b128 v[200:203], v242 offset:30720
    ds_read_b128 v[204:207], v243 offset:30720
    s_waitcnt vmcnt(7) lgkmcnt(3)
    v_mfma_f32_32x32x16_bf16 v[0:15], v[208:211], v[164:167], v[0:15]
    v_mfma_f32_32x32x16_bf16 v[16:31], v[212:215], v[164:167], v[16:31]
    v_mfma_f32_32x32x16_bf16 v[32:47], v[216:219], v[164:167], v[32:47]
    ds_read_b128 v[208:211], v240 offset:31744
    ds_read_b128 v[212:215], v242 offset:31744
    ds_read_b128 v[216:219], v243 offset:31744
    s_waitcnt vmcnt(6) lgkmcnt(3)
    v_mfma_f32_32x32x16_bf16 v[0:15], v[196:199], v[168:171], v[0:15]
    v_mfma_f32_32x32x16_bf16 v[16:31], v[200:203], v[168:171], v[16:31]
    v_mfma_f32_32x32x16_bf16 v[32:47], v[204:207], v[168:171], v[32:47]
    ds_read_b128 v[196:199], v240 offset:32768
    ds_read_b128 v[200:203], v242 offset:32768
    ds_read_b128 v[204:207], v243 offset:32768
    s_waitcnt vmcnt(5) lgkmcnt(3)
    v_mfma_f32_32x32x16_bf16 v[0:15], v[208:211], v[172:175], v[0:15]
    v_mfma_f32_32x32x16_bf16 v[16:31], v[212:215], v[172:175], v[16:31]
    v_mfma_f32_32x32x16_bf16 v[32:47], v[216:219], v[172:175], v[32:47]
    ds_read_b128 v[208:211], v240 offset:33792
    ds_read_b128 v[212:215], v242 offset:33792
    ds_read_b128 v[216:219], v243 offset:33792
    s_waitcnt vmcnt(4) lgkmcnt(3)
    v_mfma_f32_32x32x16_bf16 v[0:15], v[196:199], v[176:179], v[0:15]
    v_mfma_f32_32x32x16_bf16 v[16:31], v[200:203], v[176:179], v[16:31]
    v_mfma_f32_32x32x16_bf16 v[32:47], v[204:207], v[176:179], v[32:47]
    ds_read_b128 v[196:199], v240 offset:34816
    ds_read_b128 v[200:203], v242 offset:34816
    ds_read_b128 v[204:207], v243 offset:34816
    s_waitcnt vmcnt(3) lgkmcnt(3)
    v_mfma_f32_32x32x16_bf16 v[0:15], v[208:211], v[180:183], v[0:15]
    v_mfma_f32_32x32x16_bf16 v[16:31], v[212:215], v[180:183], v[16:31]
    v_mfma_f32_32x32x16_bf16 v[32:47], v[216:219], v[180:183], v[32:47]
    ds_read_b128 v[208:211], v240 offset:35840
    ds_read_b128 v[212:215], v242 offset:35840
    ds_read_b128 v[216:219], v243 offset:35840
    s_waitcnt vmcnt(2) lgkmcnt(3)
    v_mfma_f32_32x32x16_bf16 v[0:15], v[196:199], v[184:187], v[0:15]
    v_mfma_f32_32x32x16_bf16 v[16:31], v[200:203], v[184:187], v[16:31]
    v_mfma_f32_32x32x16_bf16 v[32:47], v[204:207], v[184:187], v[32:47]
    ds_read_b128 v[196:199], v240 offset:36864
    ds_read_b128 v[200:203], v242 offset:36864
    ds_read_b128 v[204:207], v243 offset:36864
    s_waitcnt vmcnt(1) lgkmcnt(3)
    v_mfma_f32_32x32x16_bf16 v[0:15], v[208:211], v[188:191], v[0:15]
    v_mfma_f32_32x32x16_bf16 v[16:31], v[212:215], v[188:191], v[16:31]
    v_mfma_f32_32x32x16_bf16 v[32:47], v[216:219], v[188:191], v[32:47]
    s_waitcnt vmcnt(0) lgkmcnt(0)
    v_mfma_f32_32x32x16_bf16 v[0:15], v[196:199], v[192:195], v[0:15]
    v_mfma_f32_32x32x16_bf16 v[16:31], v[200:203], v[192:195], v[16:31]
    v_mfma_f32_32x32x16_bf16 v[32:47], v[204:207], v[192:195], v[32:47]
    s_lshl_b32 s3, s27, 5
    v_add_u32 v223, s3, v221
    s_movk_i32 s4, 2304
    v_mul_lo_u32 v223, v223, s4
    v_lshl_add_u32 v223, v222, 3, v223
    s_mul_i32 s3, s26, 192
    s_add_u32 s3, s3, 1152
    s_nop 2
    v_cvt_pk_bf16_f32 v232, v0, v1
    v_cvt_pk_bf16_f32 v233, v2, v3
    v_cvt_pk_bf16_f32 v234, v4, v5
    v_cvt_pk_bf16_f32 v235, v6, v7
    v_cvt_pk_bf16_f32 v236, v8, v9
    v_cvt_pk_bf16_f32 v237, v10, v11
    v_cvt_pk_bf16_f32 v238, v12, v13
    v_cvt_pk_bf16_f32 v239, v14, v15
    buffer_store_dwordx2 v[232:233], v223, s[12:15], s3 offen offset:0
    buffer_store_dwordx2 v[234:235], v223, s[12:15], s3 offen offset:16
    buffer_store_dwordx2 v[236:237], v223, s[12:15], s3 offen offset:32
    buffer_store_dwordx2 v[238:239], v223, s[12:15], s3 offen offset:48
    v_cvt_pk_bf16_f32 v232, v16, v17
    v_cvt_pk_bf16_f32 v233, v18, v19
    v_cvt_pk_bf16_f32 v234, v20, v21
    v_cvt_pk_bf16_f32 v235, v22, v23
    v_cvt_pk_bf16_f32 v236, v24, v25
    v_cvt_pk_bf16_f32 v237, v26, v27
    v_cvt_pk_bf16_f32 v238, v28, v29
    v_cvt_pk_bf16_f32 v239, v30, v31
    buffer_store_dwordx2 v[232:233], v223, s[12:15], s3 offen offset:64
    buffer_store_dwordx2 v[234:235], v223, s[12:15], s3 offen offset:80
    buffer_store_dwordx2 v[236:237], v223, s[12:15], s3 offen offset:96
    buffer_store_dwordx2 v[238:239], v223, s[12:15], s3 offen offset:112
    v_cvt_pk_bf16_f32 v232, v32, v33
    v_cvt_pk_bf16_f32 v233, v34, v35
    v_cvt_pk_bf16_f32 v234, v36, v37
    v_cvt_pk_bf16_f32 v235, v38, v39
    v_cvt_pk_bf16_f32 v236, v40, v41
    v_cvt_pk_bf16_f32 v237, v42, v43
    v_cvt_pk_bf16_f32 v238, v44, v45
    v_cvt_pk_bf16_f32 v239, v46, v47
    buffer_store_dwordx2 v[232:233], v223, s[12:15], s3 offen offset:128
    buffer_store_dwordx2 v[234:235], v223, s[12:15], s3 offen offset:144
    buffer_store_dwordx2 v[236:237], v223, s[12:15], s3 offen offset:160
    buffer_store_dwordx2 v[238:239], v223, s[12:15], s3 offen offset:176
    s_endpgm
Lm3:
    s_sub_u32 s2, s2, 48
    s_load_dwordx2 s[40:41], s[0:1], 40
    s_load_dwordx2 s[42:43], s[0:1], 72
    s_load_dwordx2 s[46:47], s[0:1], 88
    v_lshrrev_b32 v1, 6, v0
    s_nop 0
    v_readfirstlane_b32 s24, v1
    s_cmp_ge_u32 s2, 192
    s_cbranch_scc1 Loproj_exit
    s_waitcnt lgkmcnt(0)
    s_and_b32 s25, s24, 1
    s_lshr_b32 s26, s24, 1
    s_and_b32 s3, s2, 7
    s_lshr_b32 s4, s2, 3
    s_and_b32 s5, s4, 3
    s_lshl_b32 s27, s3, 2
    s_add_u32 s27, s27, s5
    s_lshr_b32 s28, s4, 2
    s_mul_i32 s28, s28, 96
    s_mov_b32 s8, s40
    s_mov_b32 s9, s41
    s_mov_b32 s10, 4718592
    s_mov_b32 s11, 0x00020000
    s_add_u32 s12, s46, 50331648
    s_addc_u32 s13, s47, 0
    s_mov_b32 s14, 16777216
    s_mov_b32 s15, 0x00020000
    s_mov_b32 s16, s42
    s_mov_b32 s17, s43
    s_mov_b32 s18, 4718592
    s_mov_b32 s19, 0x00020000
    v_and_b32 v116, 63, v0
    v_lshlrev_b32 v113, 4, v116
    s_lshl_b32 s3, s27, 1
    s_add_u32 s3, s3, s25
    s_lshl_b32 s3, s3, 18
    s_lshl_b32 s4, s26, 16
    s_add_u32 s29, s3, s4
    s_mul_i32 s3, s25, 384
    s_mov_b32 s4, 43691
    s_lshl_b32 s5, s26, 10
    s_lshl_b32 s6, s28, 1
    s_movk_i32 s7, 1152
    v_add_u32 v117, s3, v116
    v_add_u32 v117, 0, v117
    v_mul_lo_u32 v118, v117, s4
    v_lshrrev_b32 v118, 19, v118
    v_mul_u32_u24 v119, 12, v118
    v_sub_u32 v119, v117, v119
    v_add_u32 v118, s5, v118
    v_mul_lo_u32 v118, v118, s7
    v_lshl_add_u32 v118, v119, 4, v118
    v_add_u32 v104, s6, v118
    v_add_u32 v117, s3, v116
    v_add_u32 v117, 64, v117
    v_mul_lo_u32 v118, v117, s4
    v_lshrrev_b32 v118, 19, v118
    v_mul_u32_u24 v119, 12, v118
    v_sub_u32 v119, v117, v119
    v_add_u32 v118, s5, v118
    v_mul_lo_u32 v118, v118, s7
    v_lshl_add_u32 v118, v119, 4, v118
    v_add_u32 v105, s6, v118
    v_add_u32 v117, s3, v116
    v_add_u32 v117, 128, v117
    v_mul_lo_u32 v118, v117, s4
    v_lshrrev_b32 v118, 19, v118
    v_mul_u32_u24 v119, 12, v118
    v_sub_u32 v119, v117, v119
    v_add_u32 v118, s5, v118
    v_mul_lo_u32 v118, v118, s7
    v_lshl_add_u32 v118, v119, 4, v118
    v_add_u32 v106, s6, v118
    v_add_u32 v117, s3, v116
    v_add_u32 v117, 192, v117
    v_mul_lo_u32 v118, v117, s4
    v_lshrrev_b32 v118, 19, v118
    v_mul_u32_u24 v119, 12, v118
    v_sub_u32 v119, v117, v119
    v_add_u32 v118, s5, v118
    v_mul_lo_u32 v118, v118, s7
    v_lshl_add_u32 v118, v119, 4, v118
    v_add_u32 v107, s6, v118
    v_add_u32 v117, s3, v116
    v_add_u32 v117, 256, v117
    v_mul_lo_u32 v118, v117, s4
    v_lshrrev_b32 v118, 19, v118
    v_mul_u32_u24 v119, 12, v118
    v_sub_u32 v119, v117, v119
    v_add_u32 v118, s5, v118
    v_mul_lo_u32 v118, v118, s7
    v_lshl_add_u32 v118, v119, 4, v118
    v_add_u32 v108, s6, v118
    v_add_u32 v117, s3, v116
    v_add_u32 v117, 320, v117
    v_mul_lo_u32 v118, v117, s4
    v_lshrrev_b32 v118, 19, v118
    v_mul_u32_u24 v119, 12, v118
    v_sub_u32 v119, v117, v119
    v_add_u32 v118, s5, v118
    v_mul_lo_u32 v118, v118, s7
    v_lshl_add_u32 v118, v119, 4, v118
    v_add_u32 v109, s6, v118
    s_mul_i32 s30, s26, 12288
    s_mul_i32 s3, s25, 6144
    s_add_u32 s30, s30, s3
    v_bfe_u32 v117, v0, 2, 2
    v_bfe_u32 v118, v0, 5, 1
    v_lshl_add_u32 v117, v118, 2, v117
    v_mul_u32_u24 v117, 192, v117
    v_bfe_u32 v118, v0, 4, 1
    v_lshl_add_u32 v117, v118, 5, v117
    v_and_b32 v118, 3, v0
    v_lshl_add_u32 v117, v118, 3, v117
    s_mul_i32 s3, s26, 12288
    v_add_u32 v111, s3, v117
    v_mov_b32 v0, 0
    v_mov_b32 v1, 0
    v_mov_b32 v2, 0
    v_mov_b32 v3, 0
    v_mov_b32 v4, 0
    v_mov_b32 v5, 0
    v_mov_b32 v6, 0
    v_mov_b32 v7, 0
    v_mov_b32 v8, 0
    v_mov_b32 v9, 0
    v_mov_b32 v10, 0
    v_mov_b32 v11, 0
    v_mov_b32 v12, 0
    v_mov_b32 v13, 0
    v_mov_b32 v14, 0
    v_mov_b32 v15, 0
    v_mov_b32 v16, 0
    v_mov_b32 v17, 0
    v_mov_b32 v18, 0
    v_mov_b32 v19, 0
    v_mov_b32 v20, 0
    v_mov_b32 v21, 0
    v_mov_b32 v22, 0
    v_mov_b32 v23, 0
    v_mov_b32 v24, 0
    v_mov_b32 v25, 0
    v_mov_b32 v26, 0
    v_mov_b32 v27, 0
    v_mov_b32 v28, 0
    v_mov_b32 v29, 0
    v_mov_b32 v30, 0
    v_mov_b32 v31, 0
    v_mov_b32 v32, 0
    v_mov_b32 v33, 0
    v_mov_b32 v34, 0
    v_mov_b32 v35, 0
    v_mov_b32 v36, 0
    v_mov_b32 v37, 0
    v_mov_b32 v38, 0
    v_mov_b32 v39, 0
    v_mov_b32 v40, 0
    v_mov_b32 v41, 0
    v_mov_b32 v42, 0
    v_mov_b32 v43, 0
    v_mov_b32 v44, 0
    v_mov_b32 v45, 0
    v_mov_b32 v46, 0
    v_mov_b32 v47, 0
    s_mov_b32 s31, 0
    s_mov_b32 s32, 0
    s_mov_b32 s33, 0
    buffer_load_dwordx4 v[72:75], v113, s[12:15], s29 offen offset:0
    buffer_load_dwordx4 v[76:79], v113, s[12:15], s29 offen offset:1024
    buffer_load_dwordx4 v[80:83], v113, s[12:15], s29 offen offset:2048
    buffer_load_dwordx4 v[84:87], v113, s[12:15], s29 offen offset:3072
    s_add_u32 s29, s29, 4096
    s_add_u32 m0, s30, s32
    s_nop 0
    buffer_load_dwordx4 v104, s[8:11], s31 offen lds
    s_add_u32 m0, s30, s32
    s_add_u32 m0, m0, 1024
    s_nop 0
    buffer_load_dwordx4 v105, s[8:11], s31 offen lds
    s_add_u32 m0, s30, s32
    s_add_u32 m0, m0, 2048
    s_nop 0
    buffer_load_dwordx4 v106, s[8:11], s31 offen lds
    s_add_u32 m0, s30, s32
    s_add_u32 m0, m0, 3072
    s_nop 0
    buffer_load_dwordx4 v107, s[8:11], s31 offen lds
    s_add_u32 m0, s30, s32
    s_add_u32 m0, m0, 4096
    s_nop 0
    buffer_load_dwordx4 v108, s[8:11], s31 offen lds
    s_add_u32 m0, s30, s32
    s_add_u32 m0, m0, 5120
    s_nop 0
    buffer_load_dwordx4 v109, s[8:11], s31 offen lds
    s_add_u32 s31, s31, 73728
    s_add_u32 s32, s32, 49152
    s_cmp_eq_u32 s32, 147456
    s_cselect_b32 s32, 0, s32
    s_add_u32 m0, s30, s32
    s_nop 0
    buffer_load_dwordx4 v104, s[8:11], s31 offen lds
    s_add_u32 m0, s30, s32
    s_add_u32 m0, m0, 1024
    s_nop 0
    buffer_load_dwordx4 v105, s[8:11], s31 offen lds
    s_add_u32 m0, s30, s32
    s_add_u32 m0, m0, 2048
    s_nop 0
    buffer_load_dwordx4 v106, s[8:11], s31 offen lds
    s_add_u32 m0, s30, s32
    s_add_u32 m0, m0, 3072
    s_nop 0
    buffer_load_dwordx4 v107, s[8:11], s31 offen lds
    s_add_u32 m0, s30, s32
    s_add_u32 m0, m0, 4096
    s_nop 0
    buffer_load_dwordx4 v108, s[8:11], s31 offen lds
    s_add_u32 m0, s30, s32
    s_add_u32 m0, m0, 5120
    s_nop 0
    buffer_load_dwordx4 v109, s[8:11], s31 offen lds
    s_add_u32 s31, s31, 73728
    s_add_u32 s32, s32, 49152
    s_cmp_eq_u32 s32, 147456
    s_cselect_b32 s32, 0, s32
    s_mov_b32 s34, 7
Loproj_loop:
    s_waitcnt vmcnt(6)
    s_barrier
    v_add_u32 v112, s33, v111
    buffer_load_dwordx4 v[88:91], v113, s[12:15], s29 offen offset:0
    buffer_load_dwordx4 v[92:95], v113, s[12:15], s29 offen offset:1024
    buffer_load_dwordx4 v[96:99], v113, s[12:15], s29 offen offset:2048
    buffer_load_dwordx4 v[100:103], v113, s[12:15], s29 offen offset:3072
    s_add_u32 s29, s29, 4096
    s_add_u32 m0, s30, s32
    s_nop 0
    buffer_load_dwordx4 v104, s[8:11], s31 offen lds
    s_add_u32 m0, s30, s32
    s_add_u32 m0, m0, 1024
    s_nop 0
    buffer_load_dwordx4 v105, s[8:11], s31 offen lds
    s_add_u32 m0, s30, s32
    s_add_u32 m0, m0, 2048
    s_nop 0
    buffer_load_dwordx4 v106, s[8:11], s31 offen lds
    s_add_u32 m0, s30, s32
    s_add_u32 m0, m0, 3072
    s_nop 0
    buffer_load_dwordx4 v107, s[8:11], s31 offen lds
    s_add_u32 m0, s30, s32
    s_add_u32 m0, m0, 4096
    s_nop 0
    buffer_load_dwordx4 v108, s[8:11], s31 offen lds
    s_add_u32 m0, s30, s32
    s_add_u32 m0, m0, 5120
    s_nop 0
    buffer_load_dwordx4 v109, s[8:11], s31 offen lds
    s_add_u32 s31, s31, 73728
    s_add_u32 s32, s32, 49152
    s_cmp_eq_u32 s32, 147456
    s_cselect_b32 s32, 0, s32
    ds_read_b64_tr_b16 v[48:49], v112 offset:0
    ds_read_b64_tr_b16 v[50:51], v112 offset:1536
    ds_read_b64_tr_b16 v[52:53], v112 offset:64
    ds_read_b64_tr_b16 v[54:55], v112 offset:1600
    ds_read_b64_tr_b16 v[56:57], v112 offset:128
    ds_read_b64_tr_b16 v[58:59], v112 offset:1664
    ds_read_b64_tr_b16 v[60:61], v112 offset:3072
    ds_read_b64_tr_b16 v[62:63], v112 offset:4608
    ds_read_b64_tr_b16 v[64:65], v112 offset:3136
    ds_read_b64_tr_b16 v[66:67], v112 offset:4672
    ds_read_b64_tr_b16 v[68:69], v112 offset:3200
    ds_read_b64_tr_b16 v[70:71], v112 offset:4736
    s_waitcnt lgkmcnt(6)
    v_mfma_f32_32x32x16_bf16 v[0:15], v[48:51], v[72:75], v[0:15]
    v_mfma_f32_32x32x16_bf16 v[16:31], v[52:55], v[72:75], v[16:31]
    v_mfma_f32_32x32x16_bf16 v[32:47], v[56:59], v[72:75], v[32:47]
    ds_read_b64_tr_b16 v[48:49], v112 offset:6144
    ds_read_b64_tr_b16 v[50:51], v112 offset:7680
    ds_read_b64_tr_b16 v[52:53], v112 offset:6208
    ds_read_b64_tr_b16 v[54:55], v112 offset:7744
    ds_read_b64_tr_b16 v[56:57], v112 offset:6272
    ds_read_b64_tr_b16 v[58:59], v112 offset:7808
    s_waitcnt lgkmcnt(6)
    v_mfma_f32_32x32x16_bf16 v[0:15], v[60:63], v[76:79], v[0:15]
    v_mfma_f32_32x32x16_bf16 v[16:31], v[64:67], v[76:79], v[16:31]
    v_mfma_f32_32x32x16_bf16 v[32:47], v[68:71], v[76:79], v[32:47]
    ds_read_b64_tr_b16 v[60:61], v112 offset:9216
    ds_read_b64_tr_b16 v[62:63], v112 offset:10752
    ds_read_b64_tr_b16 v[64:65], v112 offset:9280
    ds_read_b64_tr_b16 v[66:67], v112 offset:10816
    ds_read_b64_tr_b16 v[68:69], v112 offset:9344
    ds_read_b64_tr_b16 v[70:71], v112 offset:10880
    s_waitcnt lgkmcnt(6)
    v_mfma_f32_32x32x16_bf16 v[0:15], v[48:51], v[80:83], v[0:15]
    v_mfma_f32_32x32x16_bf16 v[16:31], v[52:55], v[80:83], v[16:31]
    v_mfma_f32_32x32x16_bf16 v[32:47], v[56:59], v[80:83], v[32:47]
    s_waitcnt lgkmcnt(0)
    v_mfma_f32_32x32x16_bf16 v[0:15], v[60:63], v[84:87], v[0:15]
    v_mfma_f32_32x32x16_bf16 v[16:31], v[64:67], v[84:87], v[16:31]
    v_mfma_f32_32x32x16_bf16 v[32:47], v[68:71], v[84:87], v[32:47]
    s_add_u32 s33, s33, 49152
    s_cmp_eq_u32 s33, 147456
    s_cselect_b32 s33, 0, s33
    s_waitcnt vmcnt(6)
    s_barrier
    v_add_u32 v112, s33, v111
    buffer_load_dwordx4 v[72:75], v113, s[12:15], s29 offen offset:0
    buffer_load_dwordx4 v[76:79], v113, s[12:15], s29 offen offset:1024
    buffer_load_dwordx4 v[80:83], v113, s[12:15], s29 offen offset:2048
    buffer_load_dwordx4 v[84:87], v113, s[12:15], s29 offen offset:3072
    s_add_u32 s29, s29, 4096
    s_add_u32 m0, s30, s32
    s_nop 0
    buffer_load_dwordx4 v104, s[8:11], s31 offen lds
    s_add_u32 m0, s30, s32
    s_add_u32 m0, m0, 1024
    s_nop 0
    buffer_load_dwordx4 v105, s[8:11], s31 offen lds
    s_add_u32 m0, s30, s32
    s_add_u32 m0, m0, 2048
    s_nop 0
    buffer_load_dwordx4 v106, s[8:11], s31 offen lds
    s_add_u32 m0, s30, s32
    s_add_u32 m0, m0, 3072
    s_nop 0
    buffer_load_dwordx4 v107, s[8:11], s31 offen lds
    s_add_u32 m0, s30, s32
    s_add_u32 m0, m0, 4096
    s_nop 0
    buffer_load_dwordx4 v108, s[8:11], s31 offen lds
    s_add_u32 m0, s30, s32
    s_add_u32 m0, m0, 5120
    s_nop 0
    buffer_load_dwordx4 v109, s[8:11], s31 offen lds
    s_add_u32 s31, s31, 73728
    s_add_u32 s32, s32, 49152
    s_cmp_eq_u32 s32, 147456
    s_cselect_b32 s32, 0, s32
    ds_read_b64_tr_b16 v[48:49], v112 offset:0
    ds_read_b64_tr_b16 v[50:51], v112 offset:1536
    ds_read_b64_tr_b16 v[52:53], v112 offset:64
    ds_read_b64_tr_b16 v[54:55], v112 offset:1600
    ds_read_b64_tr_b16 v[56:57], v112 offset:128
    ds_read_b64_tr_b16 v[58:59], v112 offset:1664
    ds_read_b64_tr_b16 v[60:61], v112 offset:3072
    ds_read_b64_tr_b16 v[62:63], v112 offset:4608
    ds_read_b64_tr_b16 v[64:65], v112 offset:3136
    ds_read_b64_tr_b16 v[66:67], v112 offset:4672
    ds_read_b64_tr_b16 v[68:69], v112 offset:3200
    ds_read_b64_tr_b16 v[70:71], v112 offset:4736
    s_waitcnt lgkmcnt(6)
    v_mfma_f32_32x32x16_bf16 v[0:15], v[48:51], v[88:91], v[0:15]
    v_mfma_f32_32x32x16_bf16 v[16:31], v[52:55], v[88:91], v[16:31]
    v_mfma_f32_32x32x16_bf16 v[32:47], v[56:59], v[88:91], v[32:47]
    ds_read_b64_tr_b16 v[48:49], v112 offset:6144
    ds_read_b64_tr_b16 v[50:51], v112 offset:7680
    ds_read_b64_tr_b16 v[52:53], v112 offset:6208
    ds_read_b64_tr_b16 v[54:55], v112 offset:7744
    ds_read_b64_tr_b16 v[56:57], v112 offset:6272
    ds_read_b64_tr_b16 v[58:59], v112 offset:7808
    s_waitcnt lgkmcnt(6)
    v_mfma_f32_32x32x16_bf16 v[0:15], v[60:63], v[92:95], v[0:15]
    v_mfma_f32_32x32x16_bf16 v[16:31], v[64:67], v[92:95], v[16:31]
    v_mfma_f32_32x32x16_bf16 v[32:47], v[68:71], v[92:95], v[32:47]
    ds_read_b64_tr_b16 v[60:61], v112 offset:9216
    ds_read_b64_tr_b16 v[62:63], v112 offset:10752
    ds_read_b64_tr_b16 v[64:65], v112 offset:9280
    ds_read_b64_tr_b16 v[66:67], v112 offset:10816
    ds_read_b64_tr_b16 v[68:69], v112 offset:9344
    ds_read_b64_tr_b16 v[70:71], v112 offset:10880
    s_waitcnt lgkmcnt(6)
    v_mfma_f32_32x32x16_bf16 v[0:15], v[48:51], v[96:99], v[0:15]
    v_mfma_f32_32x32x16_bf16 v[16:31], v[52:55], v[96:99], v[16:31]
    v_mfma_f32_32x32x16_bf16 v[32:47], v[56:59], v[96:99], v[32:47]
    s_waitcnt lgkmcnt(0)
    v_mfma_f32_32x32x16_bf16 v[0:15], v[60:63], v[100:103], v[0:15]
    v_mfma_f32_32x32x16_bf16 v[16:31], v[64:67], v[100:103], v[16:31]
    v_mfma_f32_32x32x16_bf16 v[32:47], v[68:71], v[100:103], v[32:47]
    s_add_u32 s33, s33, 49152
    s_cmp_eq_u32 s33, 147456
    s_cselect_b32 s33, 0, s33
    s_sub_u32 s34, s34, 1
    s_cmp_lg_u32 s34, 0
    s_cbranch_scc1 Loproj_loop
    s_waitcnt vmcnt(6)
    s_barrier
    v_add_u32 v112, s33, v111
    buffer_load_dwordx4 v[88:91], v113, s[12:15], s29 offen offset:0
    buffer_load_dwordx4 v[92:95], v113, s[12:15], s29 offen offset:1024
    buffer_load_dwordx4 v[96:99], v113, s[12:15], s29 offen offset:2048
    buffer_load_dwordx4 v[100:103], v113, s[12:15], s29 offen offset:3072
    s_add_u32 s29, s29, 4096
    ds_read_b64_tr_b16 v[48:49], v112 offset:0
    ds_read_b64_tr_b16 v[50:51], v112 offset:1536
    ds_read_b64_tr_b16 v[52:53], v112 offset:64
    ds_read_b64_tr_b16 v[54:55], v112 offset:1600
    ds_read_b64_tr_b16 v[56:57], v112 offset:128
    ds_read_b64_tr_b16 v[58:59], v112 offset:1664
    ds_read_b64_tr_b16 v[60:61], v112 offset:3072
    ds_read_b64_tr_b16 v[62:63], v112 offset:4608
    ds_read_b64_tr_b16 v[64:65], v112 offset:3136
    ds_read_b64_tr_b16 v[66:67], v112 offset:4672
    ds_read_b64_tr_b16 v[68:69], v112 offset:3200
    ds_read_b64_tr_b16 v[70:71], v112 offset:4736
    s_waitcnt lgkmcnt(6)
    v_mfma_f32_32x32x16_bf16 v[0:15], v[48:51], v[72:75], v[0:15]
    v_mfma_f32_32x32x16_bf16 v[16:31], v[52:55], v[72:75], v[16:31]
    v_mfma_f32_32x32x16_bf16 v[32:47], v[56:59], v[72:75], v[32:47]
    ds_read_b64_tr_b16 v[48:49], v112 offset:6144
    ds_read_b64_tr_b16 v[50:51], v112 offset:7680
    ds_read_b64_tr_b16 v[52:53], v112 offset:6208
    ds_read_b64_tr_b16 v[54:55], v112 offset:7744
    ds_read_b64_tr_b16 v[56:57], v112 offset:6272
    ds_read_b64_tr_b16 v[58:59], v112 offset:7808
    s_waitcnt lgkmcnt(6)
    v_mfma_f32_32x32x16_bf16 v[0:15], v[60:63], v[76:79], v[0:15]
    v_mfma_f32_32x32x16_bf16 v[16:31], v[64:67], v[76:79], v[16:31]
    v_mfma_f32_32x32x16_bf16 v[32:47], v[68:71], v[76:79], v[32:47]
    ds_read_b64_tr_b16 v[60:61], v112 offset:9216
    ds_read_b64_tr_b16 v[62:63], v112 offset:10752
    ds_read_b64_tr_b16 v[64:65], v112 offset:9280
    ds_read_b64_tr_b16 v[66:67], v112 offset:10816
    ds_read_b64_tr_b16 v[68:69], v112 offset:9344
    ds_read_b64_tr_b16 v[70:71], v112 offset:10880
    s_waitcnt lgkmcnt(6)
    v_mfma_f32_32x32x16_bf16 v[0:15], v[48:51], v[80:83], v[0:15]
    v_mfma_f32_32x32x16_bf16 v[16:31], v[52:55], v[80:83], v[16:31]
    v_mfma_f32_32x32x16_bf16 v[32:47], v[56:59], v[80:83], v[32:47]
    s_waitcnt lgkmcnt(0)
    v_mfma_f32_32x32x16_bf16 v[0:15], v[60:63], v[84:87], v[0:15]
    v_mfma_f32_32x32x16_bf16 v[16:31], v[64:67], v[84:87], v[16:31]
    v_mfma_f32_32x32x16_bf16 v[32:47], v[68:71], v[84:87], v[32:47]
    s_add_u32 s33, s33, 49152
    s_cmp_eq_u32 s33, 147456
    s_cselect_b32 s33, 0, s33
    s_waitcnt vmcnt(0)
    s_barrier
    v_add_u32 v112, s33, v111
    ds_read_b64_tr_b16 v[48:49], v112 offset:0
    ds_read_b64_tr_b16 v[50:51], v112 offset:1536
    ds_read_b64_tr_b16 v[52:53], v112 offset:64
    ds_read_b64_tr_b16 v[54:55], v112 offset:1600
    ds_read_b64_tr_b16 v[56:57], v112 offset:128
    ds_read_b64_tr_b16 v[58:59], v112 offset:1664
    ds_read_b64_tr_b16 v[60:61], v112 offset:3072
    ds_read_b64_tr_b16 v[62:63], v112 offset:4608
    ds_read_b64_tr_b16 v[64:65], v112 offset:3136
    ds_read_b64_tr_b16 v[66:67], v112 offset:4672
    ds_read_b64_tr_b16 v[68:69], v112 offset:3200
    ds_read_b64_tr_b16 v[70:71], v112 offset:4736
    s_waitcnt lgkmcnt(6)
    v_mfma_f32_32x32x16_bf16 v[0:15], v[48:51], v[88:91], v[0:15]
    v_mfma_f32_32x32x16_bf16 v[16:31], v[52:55], v[88:91], v[16:31]
    v_mfma_f32_32x32x16_bf16 v[32:47], v[56:59], v[88:91], v[32:47]
    ds_read_b64_tr_b16 v[48:49], v112 offset:6144
    ds_read_b64_tr_b16 v[50:51], v112 offset:7680
    ds_read_b64_tr_b16 v[52:53], v112 offset:6208
    ds_read_b64_tr_b16 v[54:55], v112 offset:7744
    ds_read_b64_tr_b16 v[56:57], v112 offset:6272
    ds_read_b64_tr_b16 v[58:59], v112 offset:7808
    s_waitcnt lgkmcnt(6)
    v_mfma_f32_32x32x16_bf16 v[0:15], v[60:63], v[92:95], v[0:15]
    v_mfma_f32_32x32x16_bf16 v[16:31], v[64:67], v[92:95], v[16:31]
    v_mfma_f32_32x32x16_bf16 v[32:47], v[68:71], v[92:95], v[32:47]
    ds_read_b64_tr_b16 v[60:61], v112 offset:9216
    ds_read_b64_tr_b16 v[62:63], v112 offset:10752
    ds_read_b64_tr_b16 v[64:65], v112 offset:9280
    ds_read_b64_tr_b16 v[66:67], v112 offset:10816
    ds_read_b64_tr_b16 v[68:69], v112 offset:9344
    ds_read_b64_tr_b16 v[70:71], v112 offset:10880
    s_waitcnt lgkmcnt(6)
    v_mfma_f32_32x32x16_bf16 v[0:15], v[48:51], v[96:99], v[0:15]
    v_mfma_f32_32x32x16_bf16 v[16:31], v[52:55], v[96:99], v[16:31]
    v_mfma_f32_32x32x16_bf16 v[32:47], v[56:59], v[96:99], v[32:47]
    s_waitcnt lgkmcnt(0)
    v_mfma_f32_32x32x16_bf16 v[0:15], v[60:63], v[100:103], v[0:15]
    v_mfma_f32_32x32x16_bf16 v[16:31], v[64:67], v[100:103], v[16:31]
    v_mfma_f32_32x32x16_bf16 v[32:47], v[68:71], v[100:103], v[32:47]
    s_add_u32 s33, s33, 49152
    s_cmp_eq_u32 s33, 147456
    s_cselect_b32 s33, 0, s33
    s_barrier
    s_mul_i32 s3, s24, 12288
    v_add_u32 v117, s3, v113
    s_nop 3
    ds_write_b128 v117, v[0:3] offset:0
    ds_write_b128 v117, v[4:7] offset:1024
    ds_write_b128 v117, v[8:11] offset:2048
    ds_write_b128 v117, v[12:15] offset:3072
    ds_write_b128 v117, v[16:19] offset:4096
    ds_write_b128 v117, v[20:23] offset:5120
    ds_write_b128 v117, v[24:27] offset:6144
    ds_write_b128 v117, v[28:31] offset:7168
    ds_write_b128 v117, v[32:35] offset:8192
    ds_write_b128 v117, v[36:39] offset:9216
    ds_write_b128 v117, v[40:43] offset:10240
    ds_write_b128 v117, v[44:47] offset:11264
    s_waitcnt lgkmcnt(0)
    s_barrier
    s_cmp_ge_u32 s24, 6
    s_cbranch_scc1 Loproj_exit
    s_mul_i32 s3, s25, 12288
    s_lshl_b32 s4, s26, 12
    s_add_u32 s3, s3, s4
    v_add_u32 v117, s3, v113
    v_add_u32 v120, 49152, v117
    ds_read_b128 v[0:3], v117 offset:0
    ds_read_b128 v[4:7], v117 offset:1024
    ds_read_b128 v[8:11], v117 offset:2048
    ds_read_b128 v[12:15], v117 offset:3072
    ds_read_b128 v[16:19], v117 offset:24576
    ds_read_b128 v[20:23], v117 offset:25600
    ds_read_b128 v[24:27], v117 offset:26624
    ds_read_b128 v[28:31], v117 offset:27648
    ds_read_b128 v[32:35], v120 offset:0
    ds_read_b128 v[36:39], v120 offset:1024
    ds_read_b128 v[40:43], v120 offset:2048
    ds_read_b128 v[44:47], v120 offset:3072
    ds_read_b128 v[48:51], v120 offset:24576
    ds_read_b128 v[52:55], v120 offset:25600
    ds_read_b128 v[56:59], v120 offset:26624
    ds_read_b128 v[60:63], v120 offset:27648
    s_waitcnt lgkmcnt(0)
    v_add_f32 v0, v0, v16
    v_add_f32 v32, v32, v48
    v_add_f32 v1, v1, v17
    v_add_f32 v33, v33, v49
    v_add_f32 v2, v2, v18
    v_add_f32 v34, v34, v50
    v_add_f32 v3, v3, v19
    v_add_f32 v35, v35, v51
    v_add_f32 v4, v4, v20
    v_add_f32 v36, v36, v52
    v_add_f32 v5, v5, v21
    v_add_f32 v37, v37, v53
    v_add_f32 v6, v6, v22
    v_add_f32 v38, v38, v54
    v_add_f32 v7, v7, v23
    v_add_f32 v39, v39, v55
    v_add_f32 v8, v8, v24
    v_add_f32 v40, v40, v56
    v_add_f32 v9, v9, v25
    v_add_f32 v41, v41, v57
    v_add_f32 v10, v10, v26
    v_add_f32 v42, v42, v58
    v_add_f32 v11, v11, v27
    v_add_f32 v43, v43, v59
    v_add_f32 v12, v12, v28
    v_add_f32 v44, v44, v60
    v_add_f32 v13, v13, v29
    v_add_f32 v45, v45, v61
    v_add_f32 v14, v14, v30
    v_add_f32 v46, v46, v62
    v_add_f32 v15, v15, v31
    v_add_f32 v47, v47, v63
    v_add_f32 v0, v0, v32
    v_add_f32 v1, v1, v33
    v_add_f32 v2, v2, v34
    v_add_f32 v3, v3, v35
    v_add_f32 v4, v4, v36
    v_add_f32 v5, v5, v37
    v_add_f32 v6, v6, v38
    v_add_f32 v7, v7, v39
    v_add_f32 v8, v8, v40
    v_add_f32 v9, v9, v41
    v_add_f32 v10, v10, v42
    v_add_f32 v11, v11, v43
    v_add_f32 v12, v12, v44
    v_add_f32 v13, v13, v45
    v_add_f32 v14, v14, v46
    v_add_f32 v15, v15, v47
    v_cvt_pk_bf16_f32 v64, v0, v1
    v_cvt_pk_bf16_f32 v65, v2, v3
    v_cvt_pk_bf16_f32 v66, v4, v5
    v_cvt_pk_bf16_f32 v67, v6, v7
    v_cvt_pk_bf16_f32 v68, v8, v9
    v_cvt_pk_bf16_f32 v69, v10, v11
    v_cvt_pk_bf16_f32 v70, v12, v13
    v_cvt_pk_bf16_f32 v71, v14, v15
    s_lshl_b32 s3, s27, 1
    s_add_u32 s3, s3, s25
    s_lshl_b32 s3, s3, 5
    v_and_b32 v118, 31, v116
    v_add_u32 v118, s3, v118
    s_movk_i32 s4, 2304
    v_mul_lo_u32 v118, v118, s4
    v_bfe_u32 v119, v116, 5, 1
    v_lshl_add_u32 v118, v119, 3, v118
    s_lshl_b32 s4, s26, 5
    s_add_u32 s4, s4, s28
    s_lshl_b32 s4, s4, 1
    buffer_store_dwordx2 v[64:65], v118, s[16:19], s4 offen offset:0
    buffer_store_dwordx2 v[66:67], v118, s[16:19], s4 offen offset:16
    buffer_store_dwordx2 v[68:69], v118, s[16:19], s4 offen offset:32
    buffer_store_dwordx2 v[70:71], v118, s[16:19], s4 offen offset:48
Loproj_exit:
    s_endpgm
.section .rodata,"a"
.p2align 6
.amdhsa_kernel l1_kernel
  .amdhsa_next_free_vgpr 256
  .amdhsa_next_free_sgpr 102
  .amdhsa_accum_offset 256
  .amdhsa_group_segment_fixed_size 0
  .amdhsa_kernarg_size 96
  .amdhsa_user_sgpr_count 2
  .amdhsa_user_sgpr_kernarg_segment_ptr 1
  .amdhsa_system_sgpr_workgroup_id_x 1
.end_amdhsa_kernel
.p2align 6
.amdhsa_kernel l2_kernel
  .amdhsa_next_free_vgpr 256
  .amdhsa_next_free_sgpr 102
  .amdhsa_accum_offset 256
  .amdhsa_group_segment_fixed_size 0
  .amdhsa_kernarg_size 96
  .amdhsa_user_sgpr_count 2
  .amdhsa_user_sgpr_kernarg_segment_ptr 1
  .amdhsa_system_sgpr_workgroup_id_x 1
.end_amdhsa_kernel
.p2align 6
.amdhsa_kernel l3_kernel
  .amdhsa_next_free_vgpr 256
  .amdhsa_next_free_sgpr 102
  .amdhsa_accum_offset 256
  .amdhsa_group_segment_fixed_size 0
  .amdhsa_kernarg_size 96
  .amdhsa_user_sgpr_count 2
  .amdhsa_user_sgpr_kernarg_segment_ptr 1
  .amdhsa_system_sgpr_workgroup_id_x 1
.end_amdhsa_kernel
```
